```python
import torch

def _softmax(x, axis=-1):
    return torch.softmax(x, dim=axis)

def _gelu(x):
    return torch.nn.functional.gelu(x, approximate='tanh')

def _silu(x):
    return torch.nn.functional.silu(x)

def _sigmoid(x):
    return torch.sigmoid(x)

def _layernorm(x, axis=-1, eps=1e-05):
    m = x.mean(dim=axis, keepdim=True)
    v = x.var(dim=axis, keepdim=True, unbiased=False)
    return (x - m) / torch.sqrt(v + eps)

def _scatter_add(tgt, idx, src, axis=0):
    return tgt.clone().index_add_(axis, idx, src)

def _segment_sum(src, seg, n):
    out = torch.zeros((n,) + src.shape[1:], dtype=src.dtype)
    return out.index_add_(0, seg, src)

def _pad(x, pw):
    flat = tuple((v for pair in reversed(pw) for v in pair))
    return torch.nn.functional.pad(x, flat)
kernel_name = 'adaLN_cond__memory_aug_recurrent_mem_tr__glu_gated_bilinear__prompt'

def setup_inputs():

    _w = lambda a: (lambda t: t.to(torch.bfloat16) if t.is_floating_point() else t)(torch.as_tensor(a))

    def _A_setup():
        B, S, Dm = (1, 2048, 640)
        H, Dh = (32, 192)
        M, seg = (8, 32)
        seg = min(seg, S)
        S = S // seg * seg
        return {'x': _w((lambda *s: torch.randn(*s, dtype=torch.bfloat16) * 0.05)(B, S, Dm)), 'mem0': _w((lambda *s: torch.randn(*s, dtype=torch.bfloat16) * 0.8)(B, M, Dm)), 'Wq': _w((lambda *s: torch.randn(*s, dtype=torch.bfloat16) * 0.8)(Dm, H, Dh) * Dm ** (-0.5)), 'Wk': _w((lambda *s: torch.randn(*s, dtype=torch.bfloat16) * 0.8)(Dm, H, Dh) * Dm ** (-0.5)), 'Wv': _w((lambda *s: torch.randn(*s, dtype=torch.bfloat16) * 0.8)(Dm, H, Dh) * Dm ** (-0.5)), 'Wo': _w((lambda *s: torch.randn(*s, dtype=torch.bfloat16) * 0.8)(H, Dh, Dm) * (H * Dh) ** (-0.5)), 'seg_len': seg}
    _A_in = _A_setup()

    def _B_setup():
        B, S, D, F = (1, 2048, 640, 1536)
        return {'x': _w((lambda *s: torch.randn(*s, dtype=torch.bfloat16) * 0.05)(B, S, D)), 'w_gate': _w((lambda *s: torch.randn(*s, dtype=torch.bfloat16) * 0.4)(D, F) * D ** (-0.5)), 'w_up': _w((lambda *s: torch.randn(*s, dtype=torch.bfloat16) * 0.4)(D, F) * D ** (-0.5)), 'w_down': _w((lambda *s: torch.randn(*s, dtype=torch.bfloat16) * 0.4)(F, D) * F ** (-0.5))}
    _B_in = _B_setup()
    return {'A_x': _A_in['x'], 'A_mem0': _A_in['mem0'], 'A_Wq': _A_in['Wq'], 'A_Wk': _A_in['Wk'], 'A_Wv': _A_in['Wv'], 'A_Wo': _A_in['Wo'], 'A_seg_len': _A_in['seg_len'], 'B_x': _B_in['x'], 'B_w_gate': _B_in['w_gate'], 'B_w_up': _B_in['w_up'], 'B_w_down': _B_in['w_down'], 'c': _w((lambda *s: torch.randn(*s, dtype=torch.bfloat16) * 0.1)(1, 640) * 8.0), 'w_mod': _w((lambda *s: torch.randn(*s, dtype=torch.bfloat16) * 0.1)(640, 6 * 640) * 640 ** (-0.5) * 8.0)}

def reference(A_x, A_mem0, A_Wq, A_Wk, A_Wv, A_Wo, A_seg_len, B_x, B_w_gate, B_w_up, B_w_down, c, w_mod):

    def _A_ref(x, mem0, Wq, Wk, Wv, Wo, seg_len):
        B, S, Dm = x.shape
        H, Dh = (Wq.shape[1], Wq.shape[2])
        M = mem0.shape[1]
        scale = Dh ** (-0.5)
        n_seg = S // seg_len
        L = M + seg_len
        idx = torch.arange(L)
        mask = (idx[:, None] < M) | (idx[:, None] >= idx[None, :])
        mem = mem0
        outs = []
        for s in range(n_seg):
            xs = x[:, s * seg_len:(s + 1) * seg_len, :].clone()
            h = torch.concatenate([mem, xs], axis=1)
            q = torch.einsum('btd,dhe->bhte', h, Wq)
            k = torch.einsum('btd,dhe->bhte', h, Wk)
            v = torch.einsum('btd,dhe->bhte', h, Wv)
            scores = torch.einsum('bhqe,bhke->bhqk', q, k) * scale
            scores = torch.where(mask[None, None], scores, -1000000000.0)
            p = _softmax(scores, axis=-1)
            o = torch.einsum('bhqk,bhke->bhqe', p, v)
            o = torch.einsum('bhte,hed->btd', o, Wo)
            mem = o[:, :M, :].clone()
            outs.append(o[:, M:, :])
        return torch.concatenate(outs, axis=1)

    def _B_ref(x, w_gate, w_up, w_down):
        g = torch.einsum('bsd,df->bsf', x, w_gate)
        u = torch.einsum('bsd,df->bsf', x, w_up)
        h = g * u
        return torch.einsum('bsf,fd->bsd', h, w_down)
    x = A_x
    mod = (_silu(c) @ w_mod).reshape(c.shape[0], 6, 1, -1)
    sa, ca, ga, sb, cb, gb = (mod[:, 0].clone(), mod[:, 1].clone(), mod[:, 2].clone(), mod[:, 3].clone(), mod[:, 4].clone(), mod[:, 5].clone())
    h = _layernorm(x, axis=-1) * (1 + ca) + sa
    x = x + ga * _A_ref(h, A_mem0, A_Wq, A_Wk, A_Wv, A_Wo, A_seg_len)
    h = _layernorm(x, axis=-1) * (1 + cb) + sb
    x = x + gb * _B_ref(h, B_w_gate, B_w_up, B_w_down)
    return x
```

```asm
; @launch grid=(256,1,1) block=(256,1,1) lds=163840
.amdgcn_target "amdgcn-amd-amdhsa--gfx950"
.text
.globl adaLN_cond__memory_aug_recurrent_mem_tr__glu_gated_bilinear__prompt_kernel
.p2align 8
.type adaLN_cond__memory_aug_recurrent_mem_tr__glu_gated_bilinear__prompt_kernel,@function
adaLN_cond__memory_aug_recurrent_mem_tr__glu_gated_bilinear__prompt_kernel:
  s_cmp_ge_u32 s2, 256
  s_cbranch_scc1 L_exit
  s_load_dwordx2 s[4:5], s[0:1], 120
  s_load_dwordx2 s[32:33], s[0:1], 112
  s_mov_b32 s31, 64
  s_waitcnt lgkmcnt(0)
  s_sub_u32 s20, 0, s4
  s_and_b32 s20, s20, 0x1fffff
  s_add_u32 s4, s4, s20
  s_addc_u32 s5, s5, 0
  s_sub_u32 s6, 0x10000000, s20
  s_mov_b32 s7, 0x00020000
  s_mov_b32 s43, 2097152
  s_mov_b32 s39, 4194304
  s_mov_b32 s52, s32
  s_mov_b32 s53, s33
  s_mov_b32 s54, 256
  s_mov_b32 s55, 0x00020000
  s_getreg_b32 s20, hwreg(HW_REG_XCC_ID)
  s_and_b32 s20, s20, 7
  v_lshrrev_b32 v3, 6, v0
  s_nop 0
  v_readfirstlane_b32 s16, v3
  s_nop 3
  s_cmp_lg_u32 s16, 0
  s_cbranch_scc1 L_tk_other
  v_mov_b32 v4, 0x7ff00000
  v_mov_b32 v5, 0
  v_cmp_eq_u32 vcc, 0, v0
  s_nop 1
  v_cndmask_b32 v4, v4, v5, vcc
  s_lshl_b32 s21, s20, 2
  s_add_u32 s21, s21, 32
  v_mov_b32 v6, 1
  buffer_atomic_add v6, v4, s[52:55], s21 offen sc0 sc1
  v_mov_b32 v9, 128
  s_cmp_lg_u32 s2, 0
  s_cbranch_scc1 L_nonce_rd
  s_memrealtime s[70:71]
  s_waitcnt lgkmcnt(0)
  s_or_b32 s70, s70, 1
  v_mov_b32 v8, s70
  s_movk_i32 s23, 128
  buffer_store_dword v8, v4, s[52:55], s23 offen sc1
L_nonce_rd:
  v_mov_b32 v9, 128
  s_mov_b32 s26, 400000
L_nonce_poll:
  buffer_load_dword v8, v9, s[52:55], 0 offen sc1
  s_waitcnt vmcnt(0)
  v_readfirstlane_b32 s70, v8
  s_nop 3
  s_cmp_lg_u32 s70, 0
  s_cbranch_scc1 L_nonce_ok
  s_sub_u32 s26, s26, 1
  s_cmp_lg_u32 s26, 0
  s_cbranch_scc1 L_nonce_poll
L_nonce_ok:
  v_readfirstlane_b32 s22, v6
  s_nop 3
  s_cmp_lt_u32 s22, 32
  s_cbranch_scc1 L_tk_ok
  v_mov_b32 v6, 1
  s_mov_b32 s21, 64
  buffer_atomic_add v6, v4, s[52:55], s21 offen sc0 sc1
  s_waitcnt vmcnt(0)
  v_readfirstlane_b32 s23, v6
  v_lshlrev_b32 v7, 2, v0
  v_min_u32 v7, 28, v7
  s_mov_b32 s26, 400000
L_tk_wait:
  buffer_load_dword v8, v7, s[52:55], 0 offen offset:32 sc1
  s_waitcnt vmcnt(0)
  s_mov_b32 s24, 0
  v_readlane_b32 s25, v8, 0
  s_nop 3
  s_add_u32 s24, s24, s25
  v_readlane_b32 s25, v8, 1
  s_nop 3
  s_add_u32 s24, s24, s25
  v_readlane_b32 s25, v8, 2
  s_nop 3
  s_add_u32 s24, s24, s25
  v_readlane_b32 s25, v8, 3
  s_nop 3
  s_add_u32 s24, s24, s25
  v_readlane_b32 s25, v8, 4
  s_nop 3
  s_add_u32 s24, s24, s25
  v_readlane_b32 s25, v8, 5
  s_nop 3
  s_add_u32 s24, s24, s25
  v_readlane_b32 s25, v8, 6
  s_nop 3
  s_add_u32 s24, s24, s25
  v_readlane_b32 s25, v8, 7
  s_nop 3
  s_add_u32 s24, s24, s25
  s_cmp_ge_u32 s24, 256
  s_cbranch_scc1 L_tk_all
  s_sleep 8
  s_sub_u32 s26, s26, 1
  s_cmp_lg_u32 s26, 0
  s_cbranch_scc1 L_tk_wait
L_tk_all:
  v_readlane_b32 s25, v8, 0
  s_nop 3
  s_min_u32 s25, s25, 32
  s_sub_u32 s24, 32, s25
  s_cmp_lt_u32 s23, s24
  s_cbranch_scc0 L_tk_n0
  s_mov_b32 s20, 0
  s_add_u32 s22, s25, s23
  s_branch L_tk_ok
L_tk_n0:
  s_sub_u32 s23, s23, s24
  v_readlane_b32 s25, v8, 1
  s_nop 3
  s_min_u32 s25, s25, 32
  s_sub_u32 s24, 32, s25
  s_cmp_lt_u32 s23, s24
  s_cbranch_scc0 L_tk_n1
  s_mov_b32 s20, 1
  s_add_u32 s22, s25, s23
  s_branch L_tk_ok
L_tk_n1:
  s_sub_u32 s23, s23, s24
  v_readlane_b32 s25, v8, 2
  s_nop 3
  s_min_u32 s25, s25, 32
  s_sub_u32 s24, 32, s25
  s_cmp_lt_u32 s23, s24
  s_cbranch_scc0 L_tk_n2
  s_mov_b32 s20, 2
  s_add_u32 s22, s25, s23
  s_branch L_tk_ok
L_tk_n2:
  s_sub_u32 s23, s23, s24
  v_readlane_b32 s25, v8, 3
  s_nop 3
  s_min_u32 s25, s25, 32
  s_sub_u32 s24, 32, s25
  s_cmp_lt_u32 s23, s24
  s_cbranch_scc0 L_tk_n3
  s_mov_b32 s20, 3
  s_add_u32 s22, s25, s23
  s_branch L_tk_ok
L_tk_n3:
  s_sub_u32 s23, s23, s24
  v_readlane_b32 s25, v8, 4
  s_nop 3
  s_min_u32 s25, s25, 32
  s_sub_u32 s24, 32, s25
  s_cmp_lt_u32 s23, s24
  s_cbranch_scc0 L_tk_n4
  s_mov_b32 s20, 4
  s_add_u32 s22, s25, s23
  s_branch L_tk_ok
L_tk_n4:
  s_sub_u32 s23, s23, s24
  v_readlane_b32 s25, v8, 5
  s_nop 3
  s_min_u32 s25, s25, 32
  s_sub_u32 s24, 32, s25
  s_cmp_lt_u32 s23, s24
  s_cbranch_scc0 L_tk_n5
  s_mov_b32 s20, 5
  s_add_u32 s22, s25, s23
  s_branch L_tk_ok
L_tk_n5:
  s_sub_u32 s23, s23, s24
  v_readlane_b32 s25, v8, 6
  s_nop 3
  s_min_u32 s25, s25, 32
  s_sub_u32 s24, 32, s25
  s_cmp_lt_u32 s23, s24
  s_cbranch_scc0 L_tk_n6
  s_mov_b32 s20, 6
  s_add_u32 s22, s25, s23
  s_branch L_tk_ok
L_tk_n6:
  s_sub_u32 s23, s23, s24
  v_readlane_b32 s25, v8, 7
  s_nop 3
  s_min_u32 s25, s25, 32
  s_sub_u32 s24, 32, s25
  s_cmp_lt_u32 s23, s24
  s_cbranch_scc0 L_tk_n7
  s_mov_b32 s20, 7
  s_add_u32 s22, s25, s23
  s_branch L_tk_ok
L_tk_n7:
  s_sub_u32 s23, s23, s24
  s_mov_b32 s20, 16
  s_mov_b32 s22, 0
L_tk_ok:
  s_nop 1
  s_lshl_b32 s22, s22, 2
  s_and_b32 s21, s20, 3
  s_add_u32 s22, s22, s21
  s_lshr_b32 s20, s20, 2
  s_lshl_b32 s20, s20, 7
  s_add_u32 s22, s22, s20
  v_mov_b32 v6, s22
  v_mov_b32 v7, s70
  v_mov_b32 v8, 0
  ds_write_b64 v8, v[6:7]
  s_waitcnt lgkmcnt(0)
L_tk_other:
  s_barrier
  v_mov_b32 v8, 0
  ds_read_b64 v[6:7], v8
  s_waitcnt lgkmcnt(0)
  v_readfirstlane_b32 s2, v6
  v_readfirstlane_b32 s70, v7
  s_barrier
  s_nop 1
  s_cmp_ge_u32 s2, 256
  s_cbranch_scc1 L_exit
  s_cmp_lt_u32 s2, 64
  s_cbranch_scc1 L_pro_skip
  s_cmp_lt_u32 s2, 124
  s_cbranch_scc0 L_wk_a
  s_sub_u32 s45, s2, 64
  s_branch L_wk_ok
L_wk_a:
  s_cmp_lt_u32 s2, 128
  s_cbranch_scc0 L_wk_b
  s_sub_u32 s45, s2, 4
  s_branch L_wk_ok
L_wk_b:
  s_cmp_lt_u32 s2, 192
  s_cbranch_scc1 L_pro_skip
  s_cmp_lt_u32 s2, 252
  s_cbranch_scc0 L_wk_c
  s_sub_u32 s45, s2, 132
  s_branch L_wk_ok
L_wk_c:
  s_sub_u32 s45, s2, 128
L_wk_ok:
  s_load_dwordx2 s[8:9], s[0:1], 96
  s_mov_b32 s10, 0x4b0000
  s_mov_b32 s11, 0x00020000
  s_load_dwordx2 s[12:13], s[0:1], 88
  s_mov_b32 s14, 0x500
  s_mov_b32 s15, 0x00020000
  v_lshrrev_b32 v3, 6, v0
  v_and_b32 v1, 63, v0
  v_readfirstlane_b32 s16, v3
  s_mov_b32 s19, 400000
  s_waitcnt lgkmcnt(0)
  s_cmp_ge_u32 s45, 120
  s_cbranch_scc1 Lnm_2
  v_and_b32 v8, 3, v0
  v_lshrrev_b32 v9, 2, v0
  v_mul_u32_u24 v10, 7680, v9
  v_lshlrev_b32 v11, 4, v8
  v_add_u32 v10, v10, v11
  s_lshl_b32 s20, s45, 6
  v_add_u32 v10, s20, v10
  v_lshlrev_b32 v11, 1, v9
  s_mov_b32 s21, 0
  buffer_load_dwordx4 v[40:43], v10, s[8:11], s21 offen
  buffer_load_ushort v24, v11, s[12:15], 0 offen offset:0
  s_mov_b32 s21, 491520
  buffer_load_dwordx4 v[44:47], v10, s[8:11], s21 offen
  buffer_load_ushort v25, v11, s[12:15], 0 offen offset:128
  s_mov_b32 s21, 983040
  buffer_load_dwordx4 v[48:51], v10, s[8:11], s21 offen
  buffer_load_ushort v26, v11, s[12:15], 0 offen offset:256
  s_mov_b32 s21, 1474560
  buffer_load_dwordx4 v[52:55], v10, s[8:11], s21 offen
  buffer_load_ushort v27, v11, s[12:15], 0 offen offset:384
  s_mov_b32 s21, 1966080
  buffer_load_dwordx4 v[56:59], v10, s[8:11], s21 offen
  buffer_load_ushort v28, v11, s[12:15], 0 offen offset:512
  s_mov_b32 s21, 2457600
  buffer_load_dwordx4 v[60:63], v10, s[8:11], s21 offen
  buffer_load_ushort v29, v11, s[12:15], 0 offen offset:640
  s_mov_b32 s21, 2949120
  buffer_load_dwordx4 v[64:67], v10, s[8:11], s21 offen
  buffer_load_ushort v30, v11, s[12:15], 0 offen offset:768
  s_mov_b32 s21, 3440640
  buffer_load_dwordx4 v[68:71], v10, s[8:11], s21 offen
  buffer_load_ushort v31, v11, s[12:15], 0 offen offset:896
  s_mov_b32 s21, 3932160
  buffer_load_dwordx4 v[72:75], v10, s[8:11], s21 offen
  buffer_load_ushort v32, v11, s[12:15], 0 offen offset:1024
  s_mov_b32 s21, 4423680
  buffer_load_dwordx4 v[76:79], v10, s[8:11], s21 offen
  buffer_load_ushort v33, v11, s[12:15], 0 offen offset:1152
Lnm_2:
  s_load_dwordx2 s[56:57], s[0:1], 0
  s_mov_b32 s58, 0x280000
  s_mov_b32 s59, 0x00020000
  s_waitcnt lgkmcnt(0)
  v_and_b32 v18, 15, v1
  v_mul_u32_u24 v18, 1280, v18
  v_lshrrev_b32 v19, 4, v1
  v_lshlrev_b32 v19, 4, v19
  s_mul_i32 s20, s16, 320
  v_add_u32 v19, s20, v19
  v_add_u32 v18, v18, v19
  v_and_b32 v20, 15, v1
  v_lshlrev_b32 v20, 2, v20
  s_mul_i32 s24, s45, 20480
  buffer_load_dwordx4 v[84:87], v18, s[56:59], s24 offen offset:0
  buffer_load_dwordx4 v[88:91], v18, s[56:59], s24 offen offset:64
  buffer_load_dwordx4 v[92:95], v18, s[56:59], s24 offen offset:128
  buffer_load_dwordx4 v[96:99], v18, s[56:59], s24 offen offset:192
  buffer_load_dwordx4 v[100:103], v18, s[56:59], s24 offen offset:256
  s_cmp_lt_u32 s45, 120
  s_cbranch_scc1 Lmod_3
  s_cmp_lg_u32 s45, 120
  s_cbranch_scc1 Lmodd_4
  s_waitcnt vmcnt(0)
  s_cmp_lg_u32 s16, 0
  s_cbranch_scc1 Lprs_5
  v_mov_b32 v36, 0
  v_mov_b32 v37, -1
  s_mov_b32 s54, 0
  s_mov_b32 s56, -1
  s_mov_b32 s57, -1
  s_mov_b32 s58, -1
  s_mov_b32 s59, -1
Lprb_6:
  s_and_b32 s55, s54, 2
  s_lshl_b32 s20, s55, 20
  s_and_b32 s55, s54, 1
  s_lshl_b32 s55, s55, 13
  s_add_u32 s20, s20, s55
  s_lshr_b32 s55, s54, 2
  s_lshl_b32 s55, s55, 14
  s_add_u32 s20, s20, s55
  s_add_u32 s20, s20, s43
  s_add_u32 s20, s20, 1835008
  buffer_store_dword v37, v36, s[4:7], s20 offen sc1
  s_waitcnt vmcnt(0)
  s_memtime s[50:51]
  s_waitcnt lgkmcnt(0)
  buffer_load_dword v38, v36, s[4:7], s20 offen sc1
  s_waitcnt vmcnt(0)
  s_memtime s[52:53]
  s_waitcnt lgkmcnt(0)
  s_sub_u32 s50, s52, s50
  s_and_b32 s55, s54, 3
  s_cmp_eq_u32 s55, 0
  s_cselect_b32 s55, s50, -1
  s_min_u32 s56, s56, s55
  s_and_b32 s55, s54, 3
  s_cmp_eq_u32 s55, 1
  s_cselect_b32 s55, s50, -1
  s_min_u32 s57, s57, s55
  s_and_b32 s55, s54, 3
  s_cmp_eq_u32 s55, 2
  s_cselect_b32 s55, s50, -1
  s_min_u32 s58, s58, s55
  s_and_b32 s55, s54, 3
  s_cmp_eq_u32 s55, 3
  s_cselect_b32 s55, s50, -1
  s_min_u32 s59, s59, s55
  s_add_u32 s54, s54, 1
  s_cmp_lt_u32 s54, 12
  s_cbranch_scc1 Lprb_6
  s_cmp_lt_u32 s57, s56
  s_cselect_b32 s50, 5, 4
  s_cmp_lt_u32 s59, s58
  s_cselect_b32 s51, 2, 0
  s_add_u32 s50, s50, s51
  v_mov_b32 v37, s50
  s_mov_b32 s52, s32
  s_mov_b32 s53, s33
  s_mov_b32 s54, 256
  s_mov_b32 s55, 0x00020000
  v_mov_b32 v38, 0x7ff00000
  v_mov_b32 v36, 196
  v_cmp_eq_u32 vcc, 0, v0
  s_nop 1
  v_cndmask_b32 v36, v38, v36, vcc
  buffer_store_dword v37, v36, s[52:55], 0 offen sc1
Lprs_5:
  s_branch Lmodd_4
Lmod_3:
  v_mov_b32 v228, 0
  v_mov_b32 v229, 0
  v_mov_b32 v230, 0
  v_mov_b32 v231, 0
  v_mov_b32 v232, 0
  v_mov_b32 v233, 0
  v_mov_b32 v234, 0
  v_mov_b32 v235, 0
  s_waitcnt vmcnt(0)
  v_lshlrev_b32 v24, 16, v24
  v_mul_f32 v6, 0xbfb8aa3b, v24
  v_exp_f32 v6, v6
  s_nop 0
  v_add_f32 v6, 1.0, v6
  v_rcp_f32 v6, v6
  s_nop 0
  v_mul_f32 v6, v24, v6
  v_cvt_pk_bf16_f32 v6, v6, v6
  v_and_b32 v6, 0xffff0000, v6
  v_lshlrev_b32 v7, 16, v40
  v_fmac_f32 v228, v6, v7
  v_and_b32 v7, 0xffff0000, v40
  v_fmac_f32 v229, v6, v7
  v_lshlrev_b32 v7, 16, v41
  v_fmac_f32 v230, v6, v7
  v_and_b32 v7, 0xffff0000, v41
  v_fmac_f32 v231, v6, v7
  v_lshlrev_b32 v7, 16, v42
  v_fmac_f32 v232, v6, v7
  v_and_b32 v7, 0xffff0000, v42
  v_fmac_f32 v233, v6, v7
  v_lshlrev_b32 v7, 16, v43
  v_fmac_f32 v234, v6, v7
  v_and_b32 v7, 0xffff0000, v43
  v_fmac_f32 v235, v6, v7
  v_lshlrev_b32 v25, 16, v25
  v_mul_f32 v6, 0xbfb8aa3b, v25
  v_exp_f32 v6, v6
  s_nop 0
  v_add_f32 v6, 1.0, v6
  v_rcp_f32 v6, v6
  s_nop 0
  v_mul_f32 v6, v25, v6
  v_cvt_pk_bf16_f32 v6, v6, v6
  v_and_b32 v6, 0xffff0000, v6
  v_lshlrev_b32 v7, 16, v44
  v_fmac_f32 v228, v6, v7
  v_and_b32 v7, 0xffff0000, v44
  v_fmac_f32 v229, v6, v7
  v_lshlrev_b32 v7, 16, v45
  v_fmac_f32 v230, v6, v7
  v_and_b32 v7, 0xffff0000, v45
  v_fmac_f32 v231, v6, v7
  v_lshlrev_b32 v7, 16, v46
  v_fmac_f32 v232, v6, v7
  v_and_b32 v7, 0xffff0000, v46
  v_fmac_f32 v233, v6, v7
  v_lshlrev_b32 v7, 16, v47
  v_fmac_f32 v234, v6, v7
  v_and_b32 v7, 0xffff0000, v47
  v_fmac_f32 v235, v6, v7
  v_lshlrev_b32 v26, 16, v26
  v_mul_f32 v6, 0xbfb8aa3b, v26
  v_exp_f32 v6, v6
  s_nop 0
  v_add_f32 v6, 1.0, v6
  v_rcp_f32 v6, v6
  s_nop 0
  v_mul_f32 v6, v26, v6
  v_cvt_pk_bf16_f32 v6, v6, v6
  v_and_b32 v6, 0xffff0000, v6
  v_lshlrev_b32 v7, 16, v48
  v_fmac_f32 v228, v6, v7
  v_and_b32 v7, 0xffff0000, v48
  v_fmac_f32 v229, v6, v7
  v_lshlrev_b32 v7, 16, v49
  v_fmac_f32 v230, v6, v7
  v_and_b32 v7, 0xffff0000, v49
  v_fmac_f32 v231, v6, v7
  v_lshlrev_b32 v7, 16, v50
  v_fmac_f32 v232, v6, v7
  v_and_b32 v7, 0xffff0000, v50
  v_fmac_f32 v233, v6, v7
  v_lshlrev_b32 v7, 16, v51
  v_fmac_f32 v234, v6, v7
  v_and_b32 v7, 0xffff0000, v51
  v_fmac_f32 v235, v6, v7
  v_lshlrev_b32 v27, 16, v27
  v_mul_f32 v6, 0xbfb8aa3b, v27
  v_exp_f32 v6, v6
  s_nop 0
  v_add_f32 v6, 1.0, v6
  v_rcp_f32 v6, v6
  s_nop 0
  v_mul_f32 v6, v27, v6
  v_cvt_pk_bf16_f32 v6, v6, v6
  v_and_b32 v6, 0xffff0000, v6
  v_lshlrev_b32 v7, 16, v52
  v_fmac_f32 v228, v6, v7
  v_and_b32 v7, 0xffff0000, v52
  v_fmac_f32 v229, v6, v7
  v_lshlrev_b32 v7, 16, v53
  v_fmac_f32 v230, v6, v7
  v_and_b32 v7, 0xffff0000, v53
  v_fmac_f32 v231, v6, v7
  v_lshlrev_b32 v7, 16, v54
  v_fmac_f32 v232, v6, v7
  v_and_b32 v7, 0xffff0000, v54
  v_fmac_f32 v233, v6, v7
  v_lshlrev_b32 v7, 16, v55
  v_fmac_f32 v234, v6, v7
  v_and_b32 v7, 0xffff0000, v55
  v_fmac_f32 v235, v6, v7
  v_lshlrev_b32 v28, 16, v28
  v_mul_f32 v6, 0xbfb8aa3b, v28
  v_exp_f32 v6, v6
  s_nop 0
  v_add_f32 v6, 1.0, v6
  v_rcp_f32 v6, v6
  s_nop 0
  v_mul_f32 v6, v28, v6
  v_cvt_pk_bf16_f32 v6, v6, v6
  v_and_b32 v6, 0xffff0000, v6
  v_lshlrev_b32 v7, 16, v56
  v_fmac_f32 v228, v6, v7
  v_and_b32 v7, 0xffff0000, v56
  v_fmac_f32 v229, v6, v7
  v_lshlrev_b32 v7, 16, v57
  v_fmac_f32 v230, v6, v7
  v_and_b32 v7, 0xffff0000, v57
  v_fmac_f32 v231, v6, v7
  v_lshlrev_b32 v7, 16, v58
  v_fmac_f32 v232, v6, v7
  v_and_b32 v7, 0xffff0000, v58
  v_fmac_f32 v233, v6, v7
  v_lshlrev_b32 v7, 16, v59
  v_fmac_f32 v234, v6, v7
  v_and_b32 v7, 0xffff0000, v59
  v_fmac_f32 v235, v6, v7
  v_lshlrev_b32 v29, 16, v29
  v_mul_f32 v6, 0xbfb8aa3b, v29
  v_exp_f32 v6, v6
  s_nop 0
  v_add_f32 v6, 1.0, v6
  v_rcp_f32 v6, v6
  s_nop 0
  v_mul_f32 v6, v29, v6
  v_cvt_pk_bf16_f32 v6, v6, v6
  v_and_b32 v6, 0xffff0000, v6
  v_lshlrev_b32 v7, 16, v60
  v_fmac_f32 v228, v6, v7
  v_and_b32 v7, 0xffff0000, v60
  v_fmac_f32 v229, v6, v7
  v_lshlrev_b32 v7, 16, v61
  v_fmac_f32 v230, v6, v7
  v_and_b32 v7, 0xffff0000, v61
  v_fmac_f32 v231, v6, v7
  v_lshlrev_b32 v7, 16, v62
  v_fmac_f32 v232, v6, v7
  v_and_b32 v7, 0xffff0000, v62
  v_fmac_f32 v233, v6, v7
  v_lshlrev_b32 v7, 16, v63
  v_fmac_f32 v234, v6, v7
  v_and_b32 v7, 0xffff0000, v63
  v_fmac_f32 v235, v6, v7
  v_lshlrev_b32 v30, 16, v30
  v_mul_f32 v6, 0xbfb8aa3b, v30
  v_exp_f32 v6, v6
  s_nop 0
  v_add_f32 v6, 1.0, v6
  v_rcp_f32 v6, v6
  s_nop 0
  v_mul_f32 v6, v30, v6
  v_cvt_pk_bf16_f32 v6, v6, v6
  v_and_b32 v6, 0xffff0000, v6
  v_lshlrev_b32 v7, 16, v64
  v_fmac_f32 v228, v6, v7
  v_and_b32 v7, 0xffff0000, v64
  v_fmac_f32 v229, v6, v7
  v_lshlrev_b32 v7, 16, v65
  v_fmac_f32 v230, v6, v7
  v_and_b32 v7, 0xffff0000, v65
  v_fmac_f32 v231, v6, v7
  v_lshlrev_b32 v7, 16, v66
  v_fmac_f32 v232, v6, v7
  v_and_b32 v7, 0xffff0000, v66
  v_fmac_f32 v233, v6, v7
  v_lshlrev_b32 v7, 16, v67
  v_fmac_f32 v234, v6, v7
  v_and_b32 v7, 0xffff0000, v67
  v_fmac_f32 v235, v6, v7
  v_lshlrev_b32 v31, 16, v31
  v_mul_f32 v6, 0xbfb8aa3b, v31
  v_exp_f32 v6, v6
  s_nop 0
  v_add_f32 v6, 1.0, v6
  v_rcp_f32 v6, v6
  s_nop 0
  v_mul_f32 v6, v31, v6
  v_cvt_pk_bf16_f32 v6, v6, v6
  v_and_b32 v6, 0xffff0000, v6
  v_lshlrev_b32 v7, 16, v68
  v_fmac_f32 v228, v6, v7
  v_and_b32 v7, 0xffff0000, v68
  v_fmac_f32 v229, v6, v7
  v_lshlrev_b32 v7, 16, v69
  v_fmac_f32 v230, v6, v7
  v_and_b32 v7, 0xffff0000, v69
  v_fmac_f32 v231, v6, v7
  v_lshlrev_b32 v7, 16, v70
  v_fmac_f32 v232, v6, v7
  v_and_b32 v7, 0xffff0000, v70
  v_fmac_f32 v233, v6, v7
  v_lshlrev_b32 v7, 16, v71
  v_fmac_f32 v234, v6, v7
  v_and_b32 v7, 0xffff0000, v71
  v_fmac_f32 v235, v6, v7
  v_lshlrev_b32 v32, 16, v32
  v_mul_f32 v6, 0xbfb8aa3b, v32
  v_exp_f32 v6, v6
  s_nop 0
  v_add_f32 v6, 1.0, v6
  v_rcp_f32 v6, v6
  s_nop 0
  v_mul_f32 v6, v32, v6
  v_cvt_pk_bf16_f32 v6, v6, v6
  v_and_b32 v6, 0xffff0000, v6
  v_lshlrev_b32 v7, 16, v72
  v_fmac_f32 v228, v6, v7
  v_and_b32 v7, 0xffff0000, v72
  v_fmac_f32 v229, v6, v7
  v_lshlrev_b32 v7, 16, v73
  v_fmac_f32 v230, v6, v7
  v_and_b32 v7, 0xffff0000, v73
  v_fmac_f32 v231, v6, v7
  v_lshlrev_b32 v7, 16, v74
  v_fmac_f32 v232, v6, v7
  v_and_b32 v7, 0xffff0000, v74
  v_fmac_f32 v233, v6, v7
  v_lshlrev_b32 v7, 16, v75
  v_fmac_f32 v234, v6, v7
  v_and_b32 v7, 0xffff0000, v75
  v_fmac_f32 v235, v6, v7
  v_lshlrev_b32 v33, 16, v33
  v_mul_f32 v6, 0xbfb8aa3b, v33
  v_exp_f32 v6, v6
  s_nop 0
  v_add_f32 v6, 1.0, v6
  v_rcp_f32 v6, v6
  s_nop 0
  v_mul_f32 v6, v33, v6
  v_cvt_pk_bf16_f32 v6, v6, v6
  v_and_b32 v6, 0xffff0000, v6
  v_lshlrev_b32 v7, 16, v76
  v_fmac_f32 v228, v6, v7
  v_and_b32 v7, 0xffff0000, v76
  v_fmac_f32 v229, v6, v7
  v_lshlrev_b32 v7, 16, v77
  v_fmac_f32 v230, v6, v7
  v_and_b32 v7, 0xffff0000, v77
  v_fmac_f32 v231, v6, v7
  v_lshlrev_b32 v7, 16, v78
  v_fmac_f32 v232, v6, v7
  v_and_b32 v7, 0xffff0000, v78
  v_fmac_f32 v233, v6, v7
  v_lshlrev_b32 v7, 16, v79
  v_fmac_f32 v234, v6, v7
  v_and_b32 v7, 0xffff0000, v79
  v_fmac_f32 v235, v6, v7
  v_lshlrev_b32 v16, 7, v9
  v_lshlrev_b32 v17, 5, v8
  v_add_u32 v16, v16, v17
  ds_write_b128 v16, v[228:231]
  ds_write_b128 v16, v[232:235] offset:16
  s_waitcnt lgkmcnt(0)
  s_barrier
  v_and_b32 v8, 31, v0
  v_lshrrev_b32 v9, 5, v0
  v_lshlrev_b32 v10, 10, v9
  v_lshlrev_b32 v11, 2, v8
  v_add_u32 v10, v10, v11
  ds_read_b32 v228, v10 offset:0
  ds_read_b32 v229, v10 offset:128
  ds_read_b32 v230, v10 offset:256
  ds_read_b32 v231, v10 offset:384
  ds_read_b32 v232, v10 offset:512
  ds_read_b32 v233, v10 offset:640
  ds_read_b32 v234, v10 offset:768
  ds_read_b32 v235, v10 offset:896
  s_waitcnt lgkmcnt(0)
  v_add_f32 v228, v228, v229
  v_add_f32 v228, v228, v230
  v_add_f32 v228, v228, v231
  v_add_f32 v228, v228, v232
  v_add_f32 v228, v228, v233
  v_add_f32 v228, v228, v234
  v_add_f32 v228, v228, v235
  s_barrier
  v_lshlrev_b32 v10, 7, v9
  v_add_u32 v10, v10, v11
  ds_write_b32 v10, v228
  s_waitcnt lgkmcnt(0)
  s_barrier
  ds_read_b32 v228, v11 offset:0
  ds_read_b32 v229, v11 offset:128
  ds_read_b32 v230, v11 offset:256
  ds_read_b32 v231, v11 offset:384
  ds_read_b32 v232, v11 offset:512
  ds_read_b32 v233, v11 offset:640
  ds_read_b32 v234, v11 offset:768
  ds_read_b32 v235, v11 offset:896
  s_waitcnt lgkmcnt(0)
  v_add_f32 v228, v228, v229
  v_add_f32 v228, v228, v230
  v_add_f32 v228, v228, v231
  v_add_f32 v228, v228, v232
  v_add_f32 v228, v228, v233
  v_add_f32 v228, v228, v234
  v_add_f32 v228, v228, v235
  v_cvt_pk_bf16_f32 v228, v228, v228
  v_and_b32 v228, 0xffff0000, v228
  s_mul_hi_u32 s21, s45, 214748365
  s_cmp_eq_u32 s21, 1
  s_cbranch_scc1 Lad_8
  s_cmp_eq_u32 s21, 4
  s_cbranch_scc0 Lna_7
Lad_8:
  v_add_f32 v228, 1.0, v228
  v_cvt_pk_bf16_f32 v228, v228, v228
  v_and_b32 v228, 0xffff0000, v228
Lna_7:
  v_lshrrev_b32 v228, 16, v228
  s_cmp_ge_u32 s45, 40
  s_cbranch_scc1 Lmp_9
  v_mov_b32_dpp v229, v228 quad_perm:[1,0,3,2] row_mask:0xf bank_mask:0xf
  v_lshlrev_b32 v229, 16, v229
  v_or_b32 v229, v228, v229
  v_lshrrev_b32 v5, 1, v0
  v_lshlrev_b32 v5, 2, v5
  v_mov_b32 v6, 0x7ff00000
  v_and_b32 v7, 1, v0
  v_cmp_eq_u32 vcc, 0, v7
  s_nop 1
  v_cndmask_b32 v5, v6, v5, vcc
  v_cmp_gt_u32 vcc, 32, v0
  s_nop 1
  v_cndmask_b32 v5, v6, v5, vcc
  s_lshl_b32 s22, s45, 7
  s_add_u32 s22, s22, 81920
  buffer_store_dword v229, v5, s[4:7], s22 offen sc1
  s_waitcnt vmcnt(0)
  v_mov_b32 v7, 64
  v_mov_b32 v230, s70
  v_cmp_eq_u32 vcc, 0, v0
  s_nop 1
  v_cndmask_b32 v5, v6, v7, vcc
  buffer_store_dword v230, v5, s[4:7], s22 offen sc1
  s_branch Lmpd_10
Lmp_9:
  s_lshl_b32 s20, s45, 6
  v_lshlrev_b32 v5, 1, v0
  v_add_u32 v5, s20, v5
  v_mov_b32 v6, 0x7ff00000
  v_cmp_gt_u32 vcc, 32, v0
  s_nop 1
  v_cndmask_b32 v5, v6, v5, vcc
  s_mov_b32 s22, 65536
  buffer_store_short v228, v5, s[4:7], s22 offen sc1
Lmpd_10:
Lmodd_4:
  s_cmp_lt_u32 s45, 120
  s_cbranch_scc1 Lie_11
  s_sub_u32 s25, s45, 120
  s_cmp_ge_u32 s25, 2
  s_cbranch_scc1 Lb1_12
  s_add_u32 s23, s25, 105
  s_cmp_lt_u32 s25, 23
  s_cselect_b32 s23, s25, s23
  s_lshl_b32 s23, s23, 14
  s_add_u32 s23, s23, s43
  s_cmp_lt_u32 s25, 2
  s_cbranch_scc1 Lpk_13
  v_lshlrev_b32 v12, 4, v0
  s_sub_u32 s24, s25, 20
  s_cmp_lt_u32 s24, 3
  s_cselect_b32 s24, 0, -1
  v_mov_b32 v4, s24
  v_mov_b32 v5, s24
  v_mov_b32 v6, s24
  v_mov_b32 v7, s24
  buffer_store_dwordx4 v[4:7], v12, s[4:7], s23 offen sc1
  s_add_u32 s23, s23, 4096
  buffer_store_dwordx4 v[4:7], v12, s[4:7], s23 offen sc1
  s_add_u32 s23, s23, 4096
  buffer_store_dwordx4 v[4:7], v12, s[4:7], s23 offen sc1
  s_add_u32 s23, s23, 4096
  buffer_store_dwordx4 v[4:7], v12, s[4:7], s23 offen sc1
  s_branch Lpkd_14
Lpk_13:
  s_load_dwordx2 s[56:57], s[0:1], 8
  s_mov_b32 s58, 0x2800
  s_mov_b32 s59, 0x00020000
  s_waitcnt lgkmcnt(0)
  v_add_u32 v13, 0, v3
  s_and_b32 s24, s25, 1
  s_lshl_b32 s24, s24, 3
  v_add_u32 v14, s24, v13
  v_bfe_u32 v15, v1, 1, 3
  v_mul_u32_u24 v15, 1280, v15
  v_lshlrev_b32 v16, 7, v14
  v_add_u32 v15, v15, v16
  v_lshrrev_b32 v16, 4, v1
  v_lshlrev_b32 v16, 5, v16
  v_add_u32 v15, v15, v16
  v_and_b32 v16, 1, v1
  v_lshlrev_b32 v16, 2, v16
  v_add_u32 v15, v15, v16
  v_mov_b32 v17, 0x7ff00000
  v_cmp_gt_u32 vcc, 10, v14
  s_nop 1
  v_cndmask_b32 v15, v17, v15, vcc
  buffer_load_dword v4, v15, s[56:59], 0 offen offset:0
  buffer_load_dword v5, v15, s[56:59], 0 offen offset:8
  buffer_load_dword v6, v15, s[56:59], 0 offen offset:16
  buffer_load_dword v7, v15, s[56:59], 0 offen offset:24
  v_lshlrev_b32 v12, 10, v13
  v_lshlrev_b32 v16, 4, v1
  v_add_u32 v12, v12, v16
  v_cndmask_b32 v12, v17, v12, vcc
  s_waitcnt vmcnt(0)
  buffer_store_dwordx4 v[4:7], v12, s[4:7], s23 offen sc1
  s_add_u32 s24, s23, 8192
  buffer_store_dwordx4 v[4:7], v12, s[4:7], s24 offen sc1
  s_waitcnt vmcnt(0)
  v_add_u32 v13, 4, v3
  s_and_b32 s24, s25, 1
  s_lshl_b32 s24, s24, 3
  v_add_u32 v14, s24, v13
  v_bfe_u32 v15, v1, 1, 3
  v_mul_u32_u24 v15, 1280, v15
  v_lshlrev_b32 v16, 7, v14
  v_add_u32 v15, v15, v16
  v_lshrrev_b32 v16, 4, v1
  v_lshlrev_b32 v16, 5, v16
  v_add_u32 v15, v15, v16
  v_and_b32 v16, 1, v1
  v_lshlrev_b32 v16, 2, v16
  v_add_u32 v15, v15, v16
  v_mov_b32 v17, 0x7ff00000
  v_cmp_gt_u32 vcc, 10, v14
  s_nop 1
  v_cndmask_b32 v15, v17, v15, vcc
  buffer_load_dword v4, v15, s[56:59], 0 offen offset:0
  buffer_load_dword v5, v15, s[56:59], 0 offen offset:8
  buffer_load_dword v6, v15, s[56:59], 0 offen offset:16
  buffer_load_dword v7, v15, s[56:59], 0 offen offset:24
  v_lshlrev_b32 v12, 10, v13
  v_lshlrev_b32 v16, 4, v1
  v_add_u32 v12, v12, v16
  v_cndmask_b32 v12, v17, v12, vcc
  s_waitcnt vmcnt(0)
  buffer_store_dwordx4 v[4:7], v12, s[4:7], s23 offen sc1
  s_add_u32 s24, s23, 8192
  buffer_store_dwordx4 v[4:7], v12, s[4:7], s24 offen sc1
  s_waitcnt vmcnt(0)
Lpkd_14:
Lb1_12:
Lie_11:
  s_waitcnt vmcnt(0)
  v_lshlrev_b32 v104, 16, v84
  v_and_b32 v105, 0xffff0000, v84
  v_lshlrev_b32 v106, 16, v85
  v_and_b32 v107, 0xffff0000, v85
  v_lshlrev_b32 v108, 16, v86
  v_and_b32 v109, 0xffff0000, v86
  v_lshlrev_b32 v110, 16, v87
  v_and_b32 v111, 0xffff0000, v87
  v_lshlrev_b32 v112, 16, v88
  v_and_b32 v113, 0xffff0000, v88
  v_lshlrev_b32 v114, 16, v89
  v_and_b32 v115, 0xffff0000, v89
  v_lshlrev_b32 v116, 16, v90
  v_and_b32 v117, 0xffff0000, v90
  v_lshlrev_b32 v118, 16, v91
  v_and_b32 v119, 0xffff0000, v91
  v_lshlrev_b32 v120, 16, v92
  v_and_b32 v121, 0xffff0000, v92
  v_lshlrev_b32 v122, 16, v93
  v_and_b32 v123, 0xffff0000, v93
  v_lshlrev_b32 v124, 16, v94
  v_and_b32 v125, 0xffff0000, v94
  v_lshlrev_b32 v126, 16, v95
  v_and_b32 v127, 0xffff0000, v95
  v_lshlrev_b32 v128, 16, v96
  v_and_b32 v129, 0xffff0000, v96
  v_lshlrev_b32 v130, 16, v97
  v_and_b32 v131, 0xffff0000, v97
  v_lshlrev_b32 v132, 16, v98
  v_and_b32 v133, 0xffff0000, v98
  v_lshlrev_b32 v134, 16, v99
  v_and_b32 v135, 0xffff0000, v99
  v_lshlrev_b32 v136, 16, v100
  v_and_b32 v137, 0xffff0000, v100
  v_lshlrev_b32 v138, 16, v101
  v_and_b32 v139, 0xffff0000, v101
  v_lshlrev_b32 v140, 16, v102
  v_and_b32 v141, 0xffff0000, v102
  v_lshlrev_b32 v142, 16, v103
  v_and_b32 v143, 0xffff0000, v103
  v_add_f32 v228, v104, v105
  v_add_f32 v229, v106, v107
  v_add_f32 v228, v228, v108
  v_add_f32 v229, v229, v109
  v_add_f32 v228, v228, v110
  v_add_f32 v229, v229, v111
  v_add_f32 v228, v228, v112
  v_add_f32 v229, v229, v113
  v_add_f32 v228, v228, v114
  v_add_f32 v229, v229, v115
  v_add_f32 v228, v228, v116
  v_add_f32 v229, v229, v117
  v_add_f32 v228, v228, v118
  v_add_f32 v229, v229, v119
  v_add_f32 v228, v228, v120
  v_add_f32 v229, v229, v121
  v_add_f32 v228, v228, v122
  v_add_f32 v229, v229, v123
  v_add_f32 v228, v228, v124
  v_add_f32 v229, v229, v125
  v_add_f32 v228, v228, v126
  v_add_f32 v229, v229, v127
  v_add_f32 v228, v228, v128
  v_add_f32 v229, v229, v129
  v_add_f32 v228, v228, v130
  v_add_f32 v229, v229, v131
  v_add_f32 v228, v228, v132
  v_add_f32 v229, v229, v133
  v_add_f32 v228, v228, v134
  v_add_f32 v229, v229, v135
  v_add_f32 v228, v228, v136
  v_add_f32 v229, v229, v137
  v_add_f32 v228, v228, v138
  v_add_f32 v229, v229, v139
  v_add_f32 v228, v228, v140
  v_add_f32 v229, v229, v141
  v_add_f32 v228, v228, v142
  v_add_f32 v229, v229, v143
  v_add_f32 v228, v228, v229
  v_mov_b32 v225, v228
  s_nop 1
  v_permlane16_swap_b32 v228, v225
  v_add_f32 v228, v228, v225
  v_mov_b32 v225, v228
  s_nop 1
  v_permlane32_swap_b32 v228, v225
  v_add_f32 v228, v228, v225
  s_lshl_b32 s20, s16, 6
  v_add_u32 v225, s20, v20
  ds_write_b32 v225, v228 offset:8192
  s_waitcnt lgkmcnt(0)
  s_barrier
  ds_read_b32 v224, v20 offset:8192
  ds_read_b32 v225, v20 offset:8256
  ds_read_b32 v226, v20 offset:8320
  ds_read_b32 v227, v20 offset:8384
  s_waitcnt lgkmcnt(0)
  v_add_f32 v224, v224, v225
  v_add_f32 v226, v226, v227
  v_add_f32 v228, v224, v226
  v_mul_f32 v228, 0x3acccccd, v228
  v_sub_f32 v104, v104, v228
  v_sub_f32 v105, v105, v228
  v_sub_f32 v106, v106, v228
  v_sub_f32 v107, v107, v228
  v_sub_f32 v108, v108, v228
  v_sub_f32 v109, v109, v228
  v_sub_f32 v110, v110, v228
  v_sub_f32 v111, v111, v228
  v_sub_f32 v112, v112, v228
  v_sub_f32 v113, v113, v228
  v_sub_f32 v114, v114, v228
  v_sub_f32 v115, v115, v228
  v_sub_f32 v116, v116, v228
  v_sub_f32 v117, v117, v228
  v_sub_f32 v118, v118, v228
  v_sub_f32 v119, v119, v228
  v_sub_f32 v120, v120, v228
  v_sub_f32 v121, v121, v228
  v_sub_f32 v122, v122, v228
  v_sub_f32 v123, v123, v228
  v_sub_f32 v124, v124, v228
  v_sub_f32 v125, v125, v228
  v_sub_f32 v126, v126, v228
  v_sub_f32 v127, v127, v228
  v_sub_f32 v128, v128, v228
  v_sub_f32 v129, v129, v228
  v_sub_f32 v130, v130, v228
  v_sub_f32 v131, v131, v228
  v_sub_f32 v132, v132, v228
  v_sub_f32 v133, v133, v228
  v_sub_f32 v134, v134, v228
  v_sub_f32 v135, v135, v228
  v_sub_f32 v136, v136, v228
  v_sub_f32 v137, v137, v228
  v_sub_f32 v138, v138, v228
  v_sub_f32 v139, v139, v228
  v_sub_f32 v140, v140, v228
  v_sub_f32 v141, v141, v228
  v_sub_f32 v142, v142, v228
  v_sub_f32 v143, v143, v228
  v_mul_f32 v228, v104, v104
  v_mul_f32 v229, v105, v105
  v_fmac_f32 v228, v106, v106
  v_fmac_f32 v229, v107, v107
  v_fmac_f32 v228, v108, v108
  v_fmac_f32 v229, v109, v109
  v_fmac_f32 v228, v110, v110
  v_fmac_f32 v229, v111, v111
  v_fmac_f32 v228, v112, v112
  v_fmac_f32 v229, v113, v113
  v_fmac_f32 v228, v114, v114
  v_fmac_f32 v229, v115, v115
  v_fmac_f32 v228, v116, v116
  v_fmac_f32 v229, v117, v117
  v_fmac_f32 v228, v118, v118
  v_fmac_f32 v229, v119, v119
  v_fmac_f32 v228, v120, v120
  v_fmac_f32 v229, v121, v121
  v_fmac_f32 v228, v122, v122
  v_fmac_f32 v229, v123, v123
  v_fmac_f32 v228, v124, v124
  v_fmac_f32 v229, v125, v125
  v_fmac_f32 v228, v126, v126
  v_fmac_f32 v229, v127, v127
  v_fmac_f32 v228, v128, v128
  v_fmac_f32 v229, v129, v129
  v_fmac_f32 v228, v130, v130
  v_fmac_f32 v229, v131, v131
  v_fmac_f32 v228, v132, v132
  v_fmac_f32 v229, v133, v133
  v_fmac_f32 v228, v134, v134
  v_fmac_f32 v229, v135, v135
  v_fmac_f32 v228, v136, v136
  v_fmac_f32 v229, v137, v137
  v_fmac_f32 v228, v138, v138
  v_fmac_f32 v229, v139, v139
  v_fmac_f32 v228, v140, v140
  v_fmac_f32 v229, v141, v141
  v_fmac_f32 v228, v142, v142
  v_fmac_f32 v229, v143, v143
  v_add_f32 v228, v228, v229
  v_mov_b32 v225, v228
  s_nop 1
  v_permlane16_swap_b32 v228, v225
  v_add_f32 v228, v228, v225
  v_mov_b32 v225, v228
  s_nop 1
  v_permlane32_swap_b32 v228, v225
  v_add_f32 v228, v228, v225
  s_lshl_b32 s20, s16, 6
  v_add_u32 v225, s20, v20
  ds_write_b32 v225, v228 offset:8448
  s_waitcnt lgkmcnt(0)
  s_barrier
  ds_read_b32 v224, v20 offset:8448
  ds_read_b32 v225, v20 offset:8512
  ds_read_b32 v226, v20 offset:8576
  ds_read_b32 v227, v20 offset:8640
  s_waitcnt lgkmcnt(0)
  v_add_f32 v224, v224, v225
  v_add_f32 v226, v226, v227
  v_add_f32 v228, v224, v226
  v_mov_b32 v229, 0x3727c5ac
  v_fmac_f32 v229, 0x3acccccd, v228
  v_rsq_f32 v229, v229
  s_nop 0
  v_mul_f32 v104, v104, v229
  v_mul_f32 v105, v105, v229
  v_mul_f32 v106, v106, v229
  v_mul_f32 v107, v107, v229
  v_mul_f32 v108, v108, v229
  v_mul_f32 v109, v109, v229
  v_mul_f32 v110, v110, v229
  v_mul_f32 v111, v111, v229
  v_mul_f32 v112, v112, v229
  v_mul_f32 v113, v113, v229
  v_mul_f32 v114, v114, v229
  v_mul_f32 v115, v115, v229
  v_mul_f32 v116, v116, v229
  v_mul_f32 v117, v117, v229
  v_mul_f32 v118, v118, v229
  v_mul_f32 v119, v119, v229
  v_mul_f32 v120, v120, v229
  v_mul_f32 v121, v121, v229
  v_mul_f32 v122, v122, v229
  v_mul_f32 v123, v123, v229
  v_mul_f32 v124, v124, v229
  v_mul_f32 v125, v125, v229
  v_mul_f32 v126, v126, v229
  v_mul_f32 v127, v127, v229
  v_mul_f32 v128, v128, v229
  v_mul_f32 v129, v129, v229
  v_mul_f32 v130, v130, v229
  v_mul_f32 v131, v131, v229
  v_mul_f32 v132, v132, v229
  v_mul_f32 v133, v133, v229
  v_mul_f32 v134, v134, v229
  v_mul_f32 v135, v135, v229
  v_mul_f32 v136, v136, v229
  v_mul_f32 v137, v137, v229
  v_mul_f32 v138, v138, v229
  v_mul_f32 v139, v139, v229
  v_mul_f32 v140, v140, v229
  v_mul_f32 v141, v141, v229
  v_mul_f32 v142, v142, v229
  v_mul_f32 v143, v143, v229
  s_mul_i32 s20, s16, 640
  v_lshrrev_b32 v21, 4, v1
  v_lshlrev_b32 v21, 4, v21
  v_add_u32 v21, s20, v21
  v_min_u32 v22, 9, v1
  v_cmp_le_u32 vcc, 5, v22
  v_add_u32 v23, 15, v22
  s_nop 0
  v_cndmask_b32 v22, v22, v23, vcc
  v_lshlrev_b32 v22, 7, v22
  v_add_u32 v22, s20, v22
  v_add_u32 v22, 64, v22
  s_mov_b32 s21, 81920
Lml_15:
  buffer_load_dword v23, v22, s[4:7], s21 offen sc1
  s_waitcnt vmcnt(0)
  v_cmp_ne_u32 vcc, s70, v23
  s_cbranch_vccz Lmlok_16
  s_sleep 1
  s_cmp_eq_u32 s19, 0
  s_cbranch_scc1 Lmlok_16
  s_sub_u32 s19, s19, 1
  s_branch Lml_15
Lmlok_16:
  s_add_u32 s22, s21, 2560
  buffer_load_dwordx4 v[36:39], v21, s[4:7], s22 offen offset:0 sc1
  buffer_load_dwordx4 v[40:43], v21, s[4:7], s22 offen offset:128 sc1
  buffer_load_dwordx4 v[44:47], v21, s[4:7], s22 offen offset:256 sc1
  buffer_load_dwordx4 v[48:51], v21, s[4:7], s22 offen offset:384 sc1
  buffer_load_dwordx4 v[52:55], v21, s[4:7], s22 offen offset:512 sc1
  s_add_u32 s22, s21, 0
  buffer_load_dwordx4 v[56:59], v21, s[4:7], s22 offen offset:0 sc1
  buffer_load_dwordx4 v[60:63], v21, s[4:7], s22 offen offset:128 sc1
  buffer_load_dwordx4 v[64:67], v21, s[4:7], s22 offen offset:256 sc1
  buffer_load_dwordx4 v[68:71], v21, s[4:7], s22 offen offset:384 sc1
  buffer_load_dwordx4 v[72:75], v21, s[4:7], s22 offen offset:512 sc1
  s_waitcnt vmcnt(0)
  v_lshlrev_b32 v144, 16, v36
  v_and_b32 v145, 0xffff0000, v36
  v_lshlrev_b32 v146, 16, v37
  v_and_b32 v147, 0xffff0000, v37
  v_lshlrev_b32 v148, 16, v38
  v_and_b32 v149, 0xffff0000, v38
  v_lshlrev_b32 v150, 16, v39
  v_and_b32 v151, 0xffff0000, v39
  v_lshlrev_b32 v152, 16, v40
  v_and_b32 v153, 0xffff0000, v40
  v_lshlrev_b32 v154, 16, v41
  v_and_b32 v155, 0xffff0000, v41
  v_lshlrev_b32 v156, 16, v42
  v_and_b32 v157, 0xffff0000, v42
  v_lshlrev_b32 v158, 16, v43
  v_and_b32 v159, 0xffff0000, v43
  v_lshlrev_b32 v160, 16, v44
  v_and_b32 v161, 0xffff0000, v44
  v_lshlrev_b32 v162, 16, v45
  v_and_b32 v163, 0xffff0000, v45
  v_lshlrev_b32 v164, 16, v46
  v_and_b32 v165, 0xffff0000, v46
  v_lshlrev_b32 v166, 16, v47
  v_and_b32 v167, 0xffff0000, v47
  v_lshlrev_b32 v168, 16, v48
  v_and_b32 v169, 0xffff0000, v48
  v_lshlrev_b32 v170, 16, v49
  v_and_b32 v171, 0xffff0000, v49
  v_lshlrev_b32 v172, 16, v50
  v_and_b32 v173, 0xffff0000, v50
  v_lshlrev_b32 v174, 16, v51
  v_and_b32 v175, 0xffff0000, v51
  v_lshlrev_b32 v176, 16, v52
  v_and_b32 v177, 0xffff0000, v52
  v_lshlrev_b32 v178, 16, v53
  v_and_b32 v179, 0xffff0000, v53
  v_lshlrev_b32 v180, 16, v54
  v_and_b32 v181, 0xffff0000, v54
  v_lshlrev_b32 v182, 16, v55
  v_and_b32 v183, 0xffff0000, v55
  v_lshlrev_b32 v184, 16, v56
  v_and_b32 v185, 0xffff0000, v56
  v_lshlrev_b32 v186, 16, v57
  v_and_b32 v187, 0xffff0000, v57
  v_lshlrev_b32 v188, 16, v58
  v_and_b32 v189, 0xffff0000, v58
  v_lshlrev_b32 v190, 16, v59
  v_and_b32 v191, 0xffff0000, v59
  v_lshlrev_b32 v192, 16, v60
  v_and_b32 v193, 0xffff0000, v60
  v_lshlrev_b32 v194, 16, v61
  v_and_b32 v195, 0xffff0000, v61
  v_lshlrev_b32 v196, 16, v62
  v_and_b32 v197, 0xffff0000, v62
  v_lshlrev_b32 v198, 16, v63
  v_and_b32 v199, 0xffff0000, v63
  v_lshlrev_b32 v200, 16, v64
  v_and_b32 v201, 0xffff0000, v64
  v_lshlrev_b32 v202, 16, v65
  v_and_b32 v203, 0xffff0000, v65
  v_lshlrev_b32 v204, 16, v66
  v_and_b32 v205, 0xffff0000, v66
  v_lshlrev_b32 v206, 16, v67
  v_and_b32 v207, 0xffff0000, v67
  v_lshlrev_b32 v208, 16, v68
  v_and_b32 v209, 0xffff0000, v68
  v_lshlrev_b32 v210, 16, v69
  v_and_b32 v211, 0xffff0000, v69
  v_lshlrev_b32 v212, 16, v70
  v_and_b32 v213, 0xffff0000, v70
  v_lshlrev_b32 v214, 16, v71
  v_and_b32 v215, 0xffff0000, v71
  v_lshlrev_b32 v216, 16, v72
  v_and_b32 v217, 0xffff0000, v72
  v_lshlrev_b32 v218, 16, v73
  v_and_b32 v219, 0xffff0000, v73
  v_lshlrev_b32 v220, 16, v74
  v_and_b32 v221, 0xffff0000, v74
  v_lshlrev_b32 v222, 16, v75
  v_and_b32 v223, 0xffff0000, v75
  v_fma_f32 v104, v104, v144, v184
  v_fma_f32 v105, v105, v145, v185
  v_fma_f32 v106, v106, v146, v186
  v_fma_f32 v107, v107, v147, v187
  v_fma_f32 v108, v108, v148, v188
  v_fma_f32 v109, v109, v149, v189
  v_fma_f32 v110, v110, v150, v190
  v_fma_f32 v111, v111, v151, v191
  v_fma_f32 v112, v112, v152, v192
  v_fma_f32 v113, v113, v153, v193
  v_fma_f32 v114, v114, v154, v194
  v_fma_f32 v115, v115, v155, v195
  v_fma_f32 v116, v116, v156, v196
  v_fma_f32 v117, v117, v157, v197
  v_fma_f32 v118, v118, v158, v198
  v_fma_f32 v119, v119, v159, v199
  v_fma_f32 v120, v120, v160, v200
  v_fma_f32 v121, v121, v161, v201
  v_fma_f32 v122, v122, v162, v202
  v_fma_f32 v123, v123, v163, v203
  v_fma_f32 v124, v124, v164, v204
  v_fma_f32 v125, v125, v165, v205
  v_fma_f32 v126, v126, v166, v206
  v_fma_f32 v127, v127, v167, v207
  v_fma_f32 v128, v128, v168, v208
  v_fma_f32 v129, v129, v169, v209
  v_fma_f32 v130, v130, v170, v210
  v_fma_f32 v131, v131, v171, v211
  v_fma_f32 v132, v132, v172, v212
  v_fma_f32 v133, v133, v173, v213
  v_fma_f32 v134, v134, v174, v214
  v_fma_f32 v135, v135, v175, v215
  v_fma_f32 v136, v136, v176, v216
  v_fma_f32 v137, v137, v177, v217
  v_fma_f32 v138, v138, v178, v218
  v_fma_f32 v139, v139, v179, v219
  v_fma_f32 v140, v140, v180, v220
  v_fma_f32 v141, v141, v181, v221
  v_fma_f32 v142, v142, v182, v222
  v_fma_f32 v143, v143, v183, v223
  v_cvt_pk_bf16_f32 v84, v104, v105
  v_cvt_pk_bf16_f32 v85, v106, v107
  v_cvt_pk_bf16_f32 v86, v108, v109
  v_cvt_pk_bf16_f32 v87, v110, v111
  v_cvt_pk_bf16_f32 v88, v112, v113
  v_cvt_pk_bf16_f32 v89, v114, v115
  v_cvt_pk_bf16_f32 v90, v116, v117
  v_cvt_pk_bf16_f32 v91, v118, v119
  v_cvt_pk_bf16_f32 v92, v120, v121
  v_cvt_pk_bf16_f32 v93, v122, v123
  v_cvt_pk_bf16_f32 v94, v124, v125
  v_cvt_pk_bf16_f32 v95, v126, v127
  v_cvt_pk_bf16_f32 v96, v128, v129
  v_cvt_pk_bf16_f32 v97, v130, v131
  v_cvt_pk_bf16_f32 v98, v132, v133
  v_cvt_pk_bf16_f32 v99, v134, v135
  v_cvt_pk_bf16_f32 v100, v136, v137
  v_cvt_pk_bf16_f32 v101, v138, v139
  v_cvt_pk_bf16_f32 v102, v140, v141
  v_cvt_pk_bf16_f32 v103, v142, v143
  s_mul_i32 s24, s45, 20480
  s_mul_i32 s25, s16, 5120
  s_add_u32 s24, s24, s25
  s_add_u32 s24, s24, 6291456
  v_lshlrev_b32 v2, 4, v1
  buffer_store_dwordx4 v[84:87], v2, s[4:7], s24 offen offset:0 sc1
  buffer_store_dwordx4 v[88:91], v2, s[4:7], s24 offen offset:1024 sc1
  buffer_store_dwordx4 v[92:95], v2, s[4:7], s24 offen offset:2048 sc1
  buffer_store_dwordx4 v[96:99], v2, s[4:7], s24 offen offset:3072 sc1
  s_add_u32 s24, s24, 4096
  buffer_store_dwordx4 v[100:103], v2, s[4:7], s24 offen offset:0 sc1
  s_waitcnt vmcnt(0)
  s_barrier
  v_mov_b32 v4, 0x7ff00000
  v_mov_b32 v5, 0
  v_cmp_eq_u32 vcc, 0, v0
  s_nop 1
  v_cndmask_b32 v4, v4, v5, vcc
  v_mov_b32 v6, s70
  s_lshl_b32 s24, s45, 7
  s_add_u32 s24, s24, 90112
  buffer_store_dword v6, v4, s[4:7], s24 offen sc1
  s_add_u32 s25, s45, 2
  s_cmp_ge_u32 s25, 103
  s_cbranch_scc1 Lb2_17
  s_add_u32 s23, s25, 105
  s_cmp_lt_u32 s25, 23
  s_cselect_b32 s23, s25, s23
  s_lshl_b32 s23, s23, 14
  s_add_u32 s23, s23, s43
  s_cmp_lt_u32 s25, 2
  s_cbranch_scc1 Lpk_18
  v_lshlrev_b32 v12, 4, v0
  s_sub_u32 s24, s25, 20
  s_cmp_lt_u32 s24, 3
  s_cselect_b32 s24, 0, -1
  v_mov_b32 v4, s24
  v_mov_b32 v5, s24
  v_mov_b32 v6, s24
  v_mov_b32 v7, s24
  buffer_store_dwordx4 v[4:7], v12, s[4:7], s23 offen sc1
  s_add_u32 s23, s23, 4096
  buffer_store_dwordx4 v[4:7], v12, s[4:7], s23 offen sc1
  s_add_u32 s23, s23, 4096
  buffer_store_dwordx4 v[4:7], v12, s[4:7], s23 offen sc1
  s_add_u32 s23, s23, 4096
  buffer_store_dwordx4 v[4:7], v12, s[4:7], s23 offen sc1
  s_branch Lpkd_19
Lpk_18:
  s_load_dwordx2 s[56:57], s[0:1], 8
  s_mov_b32 s58, 0x2800
  s_mov_b32 s59, 0x00020000
  s_waitcnt lgkmcnt(0)
  v_add_u32 v13, 0, v3
  s_and_b32 s24, s25, 1
  s_lshl_b32 s24, s24, 3
  v_add_u32 v14, s24, v13
  v_bfe_u32 v15, v1, 1, 3
  v_mul_u32_u24 v15, 1280, v15
  v_lshlrev_b32 v16, 7, v14
  v_add_u32 v15, v15, v16
  v_lshrrev_b32 v16, 4, v1
  v_lshlrev_b32 v16, 5, v16
  v_add_u32 v15, v15, v16
  v_and_b32 v16, 1, v1
  v_lshlrev_b32 v16, 2, v16
  v_add_u32 v15, v15, v16
  v_mov_b32 v17, 0x7ff00000
  v_cmp_gt_u32 vcc, 10, v14
  s_nop 1
  v_cndmask_b32 v15, v17, v15, vcc
  buffer_load_dword v4, v15, s[56:59], 0 offen offset:0
  buffer_load_dword v5, v15, s[56:59], 0 offen offset:8
  buffer_load_dword v6, v15, s[56:59], 0 offen offset:16
  buffer_load_dword v7, v15, s[56:59], 0 offen offset:24
  v_lshlrev_b32 v12, 10, v13
  v_lshlrev_b32 v16, 4, v1
  v_add_u32 v12, v12, v16
  v_cndmask_b32 v12, v17, v12, vcc
  s_waitcnt vmcnt(0)
  buffer_store_dwordx4 v[4:7], v12, s[4:7], s23 offen sc1
  s_add_u32 s24, s23, 8192
  buffer_store_dwordx4 v[4:7], v12, s[4:7], s24 offen sc1
  s_waitcnt vmcnt(0)
  v_add_u32 v13, 4, v3
  s_and_b32 s24, s25, 1
  s_lshl_b32 s24, s24, 3
  v_add_u32 v14, s24, v13
  v_bfe_u32 v15, v1, 1, 3
  v_mul_u32_u24 v15, 1280, v15
  v_lshlrev_b32 v16, 7, v14
  v_add_u32 v15, v15, v16
  v_lshrrev_b32 v16, 4, v1
  v_lshlrev_b32 v16, 5, v16
  v_add_u32 v15, v15, v16
  v_and_b32 v16, 1, v1
  v_lshlrev_b32 v16, 2, v16
  v_add_u32 v15, v15, v16
  v_mov_b32 v17, 0x7ff00000
  v_cmp_gt_u32 vcc, 10, v14
  s_nop 1
  v_cndmask_b32 v15, v17, v15, vcc
  buffer_load_dword v4, v15, s[56:59], 0 offen offset:0
  buffer_load_dword v5, v15, s[56:59], 0 offen offset:8
  buffer_load_dword v6, v15, s[56:59], 0 offen offset:16
  buffer_load_dword v7, v15, s[56:59], 0 offen offset:24
  v_lshlrev_b32 v12, 10, v13
  v_lshlrev_b32 v16, 4, v1
  v_add_u32 v12, v12, v16
  v_cndmask_b32 v12, v17, v12, vcc
  s_waitcnt vmcnt(0)
  buffer_store_dwordx4 v[4:7], v12, s[4:7], s23 offen sc1
  s_add_u32 s24, s23, 8192
  buffer_store_dwordx4 v[4:7], v12, s[4:7], s24 offen sc1
  s_waitcnt vmcnt(0)
Lpkd_19:
Lb2_17:
  s_cmp_lt_u32 s45, 104
  s_cbranch_scc1 Lb3_20
  s_cmp_ge_u32 s45, 111
  s_cbranch_scc1 Lb3_20
  s_sub_u32 s23, s45, 104
  s_lshl_b32 s23, s23, 12
  s_add_u32 s23, s23, 0
  v_lshlrev_b32 v12, 4, v0
  v_mov_b32 v4, 0
  v_mov_b32 v5, 0
  v_mov_b32 v6, 0
  v_mov_b32 v7, 0
  buffer_store_dwordx4 v[4:7], v12, s[4:7], s23 offen sc1
Lb3_20:
  s_waitcnt vmcnt(0)
  s_barrier
  v_mov_b32 v4, 0x7ff00000
  v_mov_b32 v5, 0
  v_cmp_eq_u32 vcc, 0, v0
  s_nop 1
  v_cndmask_b32 v4, v4, v5, vcc
  v_mov_b32 v6, s70
  s_lshl_b32 s24, s45, 7
  s_add_u32 s24, s24, 106496
  buffer_store_dword v6, v4, s[4:7], s24 offen sc1
  s_barrier
L_pro_skip:
  s_cmp_lt_u32 s2, 0
  s_cbranch_scc1 L_notA
  s_cmp_ge_u32 s2, 32
  s_cbranch_scc1 L_notA
  s_sub_u32 s17, s2, 0
  s_branch L_goA
L_notA:
  s_cmp_lt_u32 s2, 32
  s_cbranch_scc1 L_notB
  s_cmp_ge_u32 s2, 64
  s_cbranch_scc1 L_notB
  s_sub_u32 s17, s2, 32
  s_branch L_goB
L_notB:
  s_cmp_lt_u32 s2, 64
  s_cbranch_scc1 L_notR
  s_cmp_ge_u32 s2, 104
  s_cbranch_scc1 L_notR
  s_sub_u32 s17, s2, 64
  s_branch L_goR
L_notR:
  s_cmp_lt_u32 s2, 128
  s_cbranch_scc1 L_notAP
  s_cmp_ge_u32 s2, 160
  s_cbranch_scc1 L_notAP
  s_sub_u32 s17, s2, 128
  s_branch L_goAP
L_notAP:
  s_cmp_lt_u32 s2, 160
  s_cbranch_scc1 L_notBP
  s_cmp_ge_u32 s2, 192
  s_cbranch_scc1 L_notBP
  s_sub_u32 s17, s2, 160
  s_branch L_goBP
L_notBP:
  s_cmp_lt_u32 s2, 104
  s_cbranch_scc1 L_notF2
  s_cmp_ge_u32 s2, 124
  s_cbranch_scc1 L_notF2
  s_sub_u32 s17, s2, 104
  s_branch L_goF2
L_notF2:
  s_cmp_lt_u32 s2, 124
  s_cbranch_scc1 L_notL2
  s_cmp_ge_u32 s2, 128
  s_cbranch_scc1 L_notL2
  s_sub_u32 s17, s2, 124
  s_branch L_goL2
L_notL2:
  s_cmp_lt_u32 s2, 192
  s_cbranch_scc1 L_notF1
  s_cmp_ge_u32 s2, 240
  s_cbranch_scc1 L_notF1
  s_sub_u32 s17, s2, 192
  s_branch L_goF1
L_notF1:
L_exit:
  s_endpgm
L_goA:
  s_load_dwordx2 s[8:9], s[0:1], 16
  s_mov_b32 s10, 0x780000
  s_mov_b32 s11, 0x00020000
  s_load_dwordx2 s[12:13], s[0:1], 24
  s_mov_b32 s14, 0x780000
  s_mov_b32 s15, 0x00020000
  v_lshrrev_b32 v3, 6, v0
  v_and_b32 v1, 63, v0
  v_readfirstlane_b32 s16, v3
  v_lshlrev_b32 v2, 4, v1
  s_mov_b32 s19, 400000
  s_waitcnt lgkmcnt(0)
  s_nop 0
  s_mul_i32 s20, s16, 3
  s_add_u32 s21, s20, 0
  s_sub_u32 s22, s21, 10
  s_cmp_ge_u32 s21, 10
  s_cselect_b32 s21, s22, s21
  s_lshl_b32 s21, s21, 10
  s_add_u32 s22, s21, 8192
  s_cmp_ge_u32 s21, 8192
  s_cselect_b32 s21, s22, s21
  v_add_u32 v4, s21, v2
  s_add_u32 s21, s20, 1
  s_sub_u32 s22, s21, 10
  s_cmp_ge_u32 s21, 10
  s_cselect_b32 s21, s22, s21
  s_lshl_b32 s21, s21, 10
  s_add_u32 s22, s21, 8192
  s_cmp_ge_u32 s21, 8192
  s_cselect_b32 s21, s22, s21
  v_add_u32 v5, s21, v2
  s_add_u32 s21, s20, 2
  s_sub_u32 s22, s21, 10
  s_cmp_ge_u32 s21, 10
  s_cselect_b32 s21, s22, s21
  s_lshl_b32 s21, s21, 10
  s_add_u32 s22, s21, 8192
  s_cmp_ge_u32 s21, 8192
  s_cselect_b32 s21, s22, s21
  v_add_u32 v6, s21, v2
  s_add_u32 s21, s20, 3
  s_sub_u32 s22, s21, 10
  s_cmp_ge_u32 s21, 10
  s_cselect_b32 s21, s22, s21
  s_lshl_b32 s21, s21, 10
  s_add_u32 s21, s21, 0
  v_add_u32 v8, s21, v2
  s_add_u32 s21, s20, 4
  s_sub_u32 s22, s21, 10
  s_cmp_ge_u32 s21, 10
  s_cselect_b32 s21, s22, s21
  s_lshl_b32 s21, s21, 10
  s_add_u32 s21, s21, 0
  v_add_u32 v9, s21, v2
  s_add_u32 s21, s20, 7
  s_sub_u32 s22, s21, 10
  s_cmp_ge_u32 s21, 10
  s_cselect_b32 s21, s22, s21
  s_lshl_b32 s21, s21, 10
  s_add_u32 s21, s21, 0
  v_add_u32 v10, s21, v2
  v_and_b32 v3, 1, v1
  v_cmp_eq_u32 vcc, 0, v3
  v_mov_b32 v3, 0xeeeeeeee
  v_mov_b32 v7, 0x44444444
  v_cndmask_b32 v3, v3, v7, vcc
  s_mul_i32 s20, s16, 24576
  s_add_u32 s20, s20, 65536
  v_add_u32 v15, s20, v2
  v_add_u32 v83, 0, v1
  s_mov_b32 s20, 174763
  v_mul_lo_u32 v84, v83, s20
  v_lshrrev_b32 v84, 20, v84
  v_mul_u32_u24 v80, 6, v84
  v_sub_u32 v80, v83, v80
  v_lshlrev_b32 v80, 4, v80
  s_mov_b32 s20, 12288
  v_mul_lo_u32 v84, v84, s20
  v_add_u32 v80, v80, v84
  v_add_u32 v83, 64, v1
  s_mov_b32 s20, 174763
  v_mul_lo_u32 v84, v83, s20
  v_lshrrev_b32 v84, 20, v84
  v_mul_u32_u24 v81, 6, v84
  v_sub_u32 v81, v83, v81
  v_lshlrev_b32 v81, 4, v81
  s_mov_b32 s20, 12288
  v_mul_lo_u32 v84, v84, s20
  v_add_u32 v81, v81, v84
  v_add_u32 v83, 128, v1
  s_mov_b32 s20, 174763
  v_mul_lo_u32 v84, v83, s20
  v_lshrrev_b32 v84, 20, v84
  v_mul_u32_u24 v82, 6, v84
  v_sub_u32 v82, v83, v82
  v_lshlrev_b32 v82, 4, v82
  s_mov_b32 s20, 12288
  v_mul_lo_u32 v84, v84, s20
  v_add_u32 v82, v82, v84
  v_lshrrev_b32 v83, 4, v1
  v_lshlrev_b32 v83, 3, v83
  v_bfe_u32 v84, v1, 2, 2
  v_add_u32 v83, v83, v84
  v_mul_u32_u24 v83, 96, v83
  v_and_b32 v84, 3, v1
  v_lshlrev_b32 v84, 3, v84
  v_add_u32 v85, v83, v84
  s_lshl_b32 s34, s16, 14
  v_add_u32 v85, s34, v85
  s_mul_i32 s35, s17, 384
  s_mul_i32 s20, s16, 96
  s_add_u32 s35, s35, s20
  s_mul_i32 s36, s16, 3
  s_add_u32 s20, s36, 0
  s_sub_u32 s22, s20, 10
  s_cmp_ge_u32 s20, 10
  s_cselect_b32 s20, s22, s20
  s_mul_i32 s20, s20, 786432
  s_add_u32 s20, s20, s35
  s_add_u32 s21, s34, 0
  s_mov_b32 m0, s21
  s_nop 0
  buffer_load_dwordx4 v80, s[8:11], s20 offen lds
  s_add_u32 s21, s34, 1024
  s_mov_b32 m0, s21
  s_nop 0
  buffer_load_dwordx4 v81, s[8:11], s20 offen lds
  s_add_u32 s21, s34, 2048
  s_mov_b32 m0, s21
  s_nop 0
  buffer_load_dwordx4 v82, s[8:11], s20 offen lds
  s_add_u32 s20, s36, 0
  s_sub_u32 s22, s20, 10
  s_cmp_ge_u32 s20, 10
  s_cselect_b32 s20, s22, s20
  s_mul_i32 s20, s20, 786432
  s_add_u32 s20, s20, s35
  s_add_u32 s21, s34, 3072
  s_mov_b32 m0, s21
  s_nop 0
  buffer_load_dwordx4 v80, s[12:15], s20 offen lds
  s_add_u32 s21, s34, 4096
  s_mov_b32 m0, s21
  s_nop 0
  buffer_load_dwordx4 v81, s[12:15], s20 offen lds
  s_add_u32 s21, s34, 5120
  s_mov_b32 m0, s21
  s_nop 0
  buffer_load_dwordx4 v82, s[12:15], s20 offen lds
  s_add_u32 s20, s36, 0
  s_sub_u32 s22, s20, 10
  s_cmp_ge_u32 s20, 10
  s_cselect_b32 s20, s22, s20
  s_mul_i32 s20, s20, 786432
  s_add_u32 s20, s20, s35
  s_add_u32 s20, s20, 393216
  s_add_u32 s21, s34, 6144
  s_mov_b32 m0, s21
  s_nop 0
  buffer_load_dwordx4 v80, s[8:11], s20 offen lds
  s_add_u32 s21, s34, 7168
  s_mov_b32 m0, s21
  s_nop 0
  buffer_load_dwordx4 v81, s[8:11], s20 offen lds
  s_add_u32 s21, s34, 8192
  s_mov_b32 m0, s21
  s_nop 0
  buffer_load_dwordx4 v82, s[8:11], s20 offen lds
  s_add_u32 s20, s36, 0
  s_sub_u32 s22, s20, 10
  s_cmp_ge_u32 s20, 10
  s_cselect_b32 s20, s22, s20
  s_mul_i32 s20, s20, 786432
  s_add_u32 s20, s20, s35
  s_add_u32 s20, s20, 393216
  s_add_u32 s21, s34, 9216
  s_mov_b32 m0, s21
  s_nop 0
  buffer_load_dwordx4 v80, s[12:15], s20 offen lds
  s_add_u32 s21, s34, 10240
  s_mov_b32 m0, s21
  s_nop 0
  buffer_load_dwordx4 v81, s[12:15], s20 offen lds
  s_add_u32 s21, s34, 11264
  s_mov_b32 m0, s21
  s_nop 0
  buffer_load_dwordx4 v82, s[12:15], s20 offen lds
  s_waitcnt vmcnt(9)
  ds_read_b64_tr_b16 a[0:1], v85 offset:0
  ds_read_b64_tr_b16 a[2:3], v85 offset:384
  ds_read_b64_tr_b16 a[8:9], v85 offset:32
  ds_read_b64_tr_b16 a[10:11], v85 offset:416
  ds_read_b64_tr_b16 a[16:17], v85 offset:64
  ds_read_b64_tr_b16 a[18:19], v85 offset:448
  s_waitcnt lgkmcnt(0)
  s_add_u32 s20, s36, 1
  s_sub_u32 s22, s20, 10
  s_cmp_ge_u32 s20, 10
  s_cselect_b32 s20, s22, s20
  s_mul_i32 s20, s20, 786432
  s_add_u32 s20, s20, s35
  s_add_u32 s21, s34, 12288
  s_mov_b32 m0, s21
  s_nop 0
  buffer_load_dwordx4 v80, s[8:11], s20 offen lds
  s_add_u32 s21, s34, 13312
  s_mov_b32 m0, s21
  s_nop 0
  buffer_load_dwordx4 v81, s[8:11], s20 offen lds
  s_add_u32 s21, s34, 14336
  s_mov_b32 m0, s21
  s_nop 0
  buffer_load_dwordx4 v82, s[8:11], s20 offen lds
  s_waitcnt vmcnt(9)
  ds_read_b64_tr_b16 a[24:25], v85 offset:3072
  ds_read_b64_tr_b16 a[26:27], v85 offset:3456
  ds_read_b64_tr_b16 v[88:89], v85 offset:3104
  ds_read_b64_tr_b16 v[90:91], v85 offset:3488
  ds_read_b64_tr_b16 a[32:33], v85 offset:3136
  ds_read_b64_tr_b16 a[34:35], v85 offset:3520
  s_waitcnt lgkmcnt(0)
  ds_write_b128 v15, v[88:91] offset:0
  s_add_u32 s20, s36, 1
  s_sub_u32 s22, s20, 10
  s_cmp_ge_u32 s20, 10
  s_cselect_b32 s20, s22, s20
  s_mul_i32 s20, s20, 786432
  s_add_u32 s20, s20, s35
  s_add_u32 s21, s34, 0
  s_mov_b32 m0, s21
  s_nop 0
  buffer_load_dwordx4 v80, s[12:15], s20 offen lds
  s_add_u32 s21, s34, 1024
  s_mov_b32 m0, s21
  s_nop 0
  buffer_load_dwordx4 v81, s[12:15], s20 offen lds
  s_add_u32 s21, s34, 2048
  s_mov_b32 m0, s21
  s_nop 0
  buffer_load_dwordx4 v82, s[12:15], s20 offen lds
  s_waitcnt vmcnt(9)
  ds_read_b64_tr_b16 a[4:5], v85 offset:6144
  ds_read_b64_tr_b16 a[6:7], v85 offset:6528
  ds_read_b64_tr_b16 a[12:13], v85 offset:6176
  ds_read_b64_tr_b16 a[14:15], v85 offset:6560
  ds_read_b64_tr_b16 a[20:21], v85 offset:6208
  ds_read_b64_tr_b16 a[22:23], v85 offset:6592
  s_waitcnt lgkmcnt(0)
  s_add_u32 s20, s36, 1
  s_sub_u32 s22, s20, 10
  s_cmp_ge_u32 s20, 10
  s_cselect_b32 s20, s22, s20
  s_mul_i32 s20, s20, 786432
  s_add_u32 s20, s20, s35
  s_add_u32 s20, s20, 393216
  s_add_u32 s21, s34, 3072
  s_mov_b32 m0, s21
  s_nop 0
  buffer_load_dwordx4 v80, s[8:11], s20 offen lds
  s_add_u32 s21, s34, 4096
  s_mov_b32 m0, s21
  s_nop 0
  buffer_load_dwordx4 v81, s[8:11], s20 offen lds
  s_add_u32 s21, s34, 5120
  s_mov_b32 m0, s21
  s_nop 0
  buffer_load_dwordx4 v82, s[8:11], s20 offen lds
  s_waitcnt vmcnt(9)
  ds_read_b64_tr_b16 a[28:29], v85 offset:9216
  ds_read_b64_tr_b16 a[30:31], v85 offset:9600
  ds_read_b64_tr_b16 v[88:89], v85 offset:9248
  ds_read_b64_tr_b16 v[90:91], v85 offset:9632
  ds_read_b64_tr_b16 a[36:37], v85 offset:9280
  ds_read_b64_tr_b16 a[38:39], v85 offset:9664
  s_waitcnt lgkmcnt(0)
  ds_write_b128 v15, v[88:91] offset:1024
  s_add_u32 s20, s36, 1
  s_sub_u32 s22, s20, 10
  s_cmp_ge_u32 s20, 10
  s_cselect_b32 s20, s22, s20
  s_mul_i32 s20, s20, 786432
  s_add_u32 s20, s20, s35
  s_add_u32 s20, s20, 393216
  s_add_u32 s21, s34, 6144
  s_mov_b32 m0, s21
  s_nop 0
  buffer_load_dwordx4 v80, s[12:15], s20 offen lds
  s_add_u32 s21, s34, 7168
  s_mov_b32 m0, s21
  s_nop 0
  buffer_load_dwordx4 v81, s[12:15], s20 offen lds
  s_add_u32 s21, s34, 8192
  s_mov_b32 m0, s21
  s_nop 0
  buffer_load_dwordx4 v82, s[12:15], s20 offen lds
  s_waitcnt vmcnt(9)
  ds_read_b64_tr_b16 a[40:41], v85 offset:12288
  ds_read_b64_tr_b16 a[42:43], v85 offset:12672
  ds_read_b64_tr_b16 a[48:49], v85 offset:12320
  ds_read_b64_tr_b16 a[50:51], v85 offset:12704
  ds_read_b64_tr_b16 a[56:57], v85 offset:12352
  ds_read_b64_tr_b16 a[58:59], v85 offset:12736
  s_waitcnt lgkmcnt(0)
  s_add_u32 s20, s36, 2
  s_sub_u32 s22, s20, 10
  s_cmp_ge_u32 s20, 10
  s_cselect_b32 s20, s22, s20
  s_mul_i32 s20, s20, 786432
  s_add_u32 s20, s20, s35
  s_add_u32 s21, s34, 9216
  s_mov_b32 m0, s21
  s_nop 0
  buffer_load_dwordx4 v80, s[8:11], s20 offen lds
  s_add_u32 s21, s34, 10240
  s_mov_b32 m0, s21
  s_nop 0
  buffer_load_dwordx4 v81, s[8:11], s20 offen lds
  s_add_u32 s21, s34, 11264
  s_mov_b32 m0, s21
  s_nop 0
  buffer_load_dwordx4 v82, s[8:11], s20 offen lds
  s_waitcnt vmcnt(9)
  ds_read_b64_tr_b16 v[88:89], v85 offset:0
  ds_read_b64_tr_b16 v[90:91], v85 offset:384
  ds_read_b64_tr_b16 a[64:65], v85 offset:32
  ds_read_b64_tr_b16 a[66:67], v85 offset:416
  ds_read_b64_tr_b16 a[72:73], v85 offset:64
  ds_read_b64_tr_b16 a[74:75], v85 offset:448
  s_waitcnt lgkmcnt(0)
  ds_write_b128 v15, v[88:91] offset:2048
  s_add_u32 s20, s36, 2
  s_sub_u32 s22, s20, 10
  s_cmp_ge_u32 s20, 10
  s_cselect_b32 s20, s22, s20
  s_mul_i32 s20, s20, 786432
  s_add_u32 s20, s20, s35
  s_add_u32 s21, s34, 12288
  s_mov_b32 m0, s21
  s_nop 0
  buffer_load_dwordx4 v80, s[12:15], s20 offen lds
  s_add_u32 s21, s34, 13312
  s_mov_b32 m0, s21
  s_nop 0
  buffer_load_dwordx4 v81, s[12:15], s20 offen lds
  s_add_u32 s21, s34, 14336
  s_mov_b32 m0, s21
  s_nop 0
  buffer_load_dwordx4 v82, s[12:15], s20 offen lds
  s_waitcnt vmcnt(9)
  ds_read_b64_tr_b16 a[44:45], v85 offset:3072
  ds_read_b64_tr_b16 a[46:47], v85 offset:3456
  ds_read_b64_tr_b16 a[52:53], v85 offset:3104
  ds_read_b64_tr_b16 a[54:55], v85 offset:3488
  ds_read_b64_tr_b16 a[60:61], v85 offset:3136
  ds_read_b64_tr_b16 a[62:63], v85 offset:3520
  s_waitcnt lgkmcnt(0)
  s_add_u32 s20, s36, 2
  s_sub_u32 s22, s20, 10
  s_cmp_ge_u32 s20, 10
  s_cselect_b32 s20, s22, s20
  s_mul_i32 s20, s20, 786432
  s_add_u32 s20, s20, s35
  s_add_u32 s20, s20, 393216
  s_add_u32 s21, s34, 0
  s_mov_b32 m0, s21
  s_nop 0
  buffer_load_dwordx4 v80, s[8:11], s20 offen lds
  s_add_u32 s21, s34, 1024
  s_mov_b32 m0, s21
  s_nop 0
  buffer_load_dwordx4 v81, s[8:11], s20 offen lds
  s_add_u32 s21, s34, 2048
  s_mov_b32 m0, s21
  s_nop 0
  buffer_load_dwordx4 v82, s[8:11], s20 offen lds
  s_waitcnt vmcnt(9)
  ds_read_b64_tr_b16 v[88:89], v85 offset:6144
  ds_read_b64_tr_b16 v[90:91], v85 offset:6528
  ds_read_b64_tr_b16 a[68:69], v85 offset:6176
  ds_read_b64_tr_b16 a[70:71], v85 offset:6560
  ds_read_b64_tr_b16 a[76:77], v85 offset:6208
  ds_read_b64_tr_b16 a[78:79], v85 offset:6592
  s_waitcnt lgkmcnt(0)
  ds_write_b128 v15, v[88:91] offset:3072
  s_add_u32 s20, s36, 2
  s_sub_u32 s22, s20, 10
  s_cmp_ge_u32 s20, 10
  s_cselect_b32 s20, s22, s20
  s_mul_i32 s20, s20, 786432
  s_add_u32 s20, s20, s35
  s_add_u32 s20, s20, 393216
  s_add_u32 s21, s34, 3072
  s_mov_b32 m0, s21
  s_nop 0
  buffer_load_dwordx4 v80, s[12:15], s20 offen lds
  s_add_u32 s21, s34, 4096
  s_mov_b32 m0, s21
  s_nop 0
  buffer_load_dwordx4 v81, s[12:15], s20 offen lds
  s_add_u32 s21, s34, 5120
  s_mov_b32 m0, s21
  s_nop 0
  buffer_load_dwordx4 v82, s[12:15], s20 offen lds
  s_waitcnt vmcnt(9)
  ds_read_b64_tr_b16 a[80:81], v85 offset:9216
  ds_read_b64_tr_b16 a[82:83], v85 offset:9600
  ds_read_b64_tr_b16 a[88:89], v85 offset:9248
  ds_read_b64_tr_b16 a[90:91], v85 offset:9632
  ds_read_b64_tr_b16 v[88:89], v85 offset:9280
  ds_read_b64_tr_b16 v[90:91], v85 offset:9664
  s_waitcnt lgkmcnt(0)
  ds_write_b128 v15, v[88:91] offset:4096
  s_add_u32 s20, s36, 3
  s_sub_u32 s22, s20, 10
  s_cmp_ge_u32 s20, 10
  s_cselect_b32 s20, s22, s20
  s_mul_i32 s20, s20, 786432
  s_add_u32 s20, s20, s35
  s_add_u32 s21, s34, 6144
  s_mov_b32 m0, s21
  s_nop 0
  buffer_load_dwordx4 v80, s[8:11], s20 offen lds
  s_add_u32 s21, s34, 7168
  s_mov_b32 m0, s21
  s_nop 0
  buffer_load_dwordx4 v81, s[8:11], s20 offen lds
  s_add_u32 s21, s34, 8192
  s_mov_b32 m0, s21
  s_nop 0
  buffer_load_dwordx4 v82, s[8:11], s20 offen lds
  s_waitcnt vmcnt(9)
  ds_read_b64_tr_b16 a[96:97], v85 offset:12288
  ds_read_b64_tr_b16 a[98:99], v85 offset:12672
  ds_read_b64_tr_b16 a[104:105], v85 offset:12320
  ds_read_b64_tr_b16 a[106:107], v85 offset:12704
  ds_read_b64_tr_b16 a[112:113], v85 offset:12352
  ds_read_b64_tr_b16 a[114:115], v85 offset:12736
  s_waitcnt lgkmcnt(0)
  s_add_u32 s20, s36, 3
  s_sub_u32 s22, s20, 10
  s_cmp_ge_u32 s20, 10
  s_cselect_b32 s20, s22, s20
  s_mul_i32 s20, s20, 786432
  s_add_u32 s20, s20, s35
  s_add_u32 s21, s34, 9216
  s_mov_b32 m0, s21
  s_nop 0
  buffer_load_dwordx4 v80, s[12:15], s20 offen lds
  s_add_u32 s21, s34, 10240
  s_mov_b32 m0, s21
  s_nop 0
  buffer_load_dwordx4 v81, s[12:15], s20 offen lds
  s_add_u32 s21, s34, 11264
  s_mov_b32 m0, s21
  s_nop 0
  buffer_load_dwordx4 v82, s[12:15], s20 offen lds
  s_waitcnt vmcnt(9)
  ds_read_b64_tr_b16 a[84:85], v85 offset:0
  ds_read_b64_tr_b16 a[86:87], v85 offset:384
  ds_read_b64_tr_b16 a[92:93], v85 offset:32
  ds_read_b64_tr_b16 a[94:95], v85 offset:416
  ds_read_b64_tr_b16 v[88:89], v85 offset:64
  ds_read_b64_tr_b16 v[90:91], v85 offset:448
  s_waitcnt lgkmcnt(0)
  ds_write_b128 v15, v[88:91] offset:5120
  s_add_u32 s20, s36, 3
  s_sub_u32 s22, s20, 10
  s_cmp_ge_u32 s20, 10
  s_cselect_b32 s20, s22, s20
  s_mul_i32 s20, s20, 786432
  s_add_u32 s20, s20, s35
  s_add_u32 s20, s20, 393216
  s_add_u32 s21, s34, 12288
  s_mov_b32 m0, s21
  s_nop 0
  buffer_load_dwordx4 v80, s[8:11], s20 offen lds
  s_add_u32 s21, s34, 13312
  s_mov_b32 m0, s21
  s_nop 0
  buffer_load_dwordx4 v81, s[8:11], s20 offen lds
  s_add_u32 s21, s34, 14336
  s_mov_b32 m0, s21
  s_nop 0
  buffer_load_dwordx4 v82, s[8:11], s20 offen lds
  s_waitcnt vmcnt(9)
  ds_read_b64_tr_b16 a[100:101], v85 offset:3072
  ds_read_b64_tr_b16 a[102:103], v85 offset:3456
  ds_read_b64_tr_b16 a[108:109], v85 offset:3104
  ds_read_b64_tr_b16 a[110:111], v85 offset:3488
  ds_read_b64_tr_b16 a[116:117], v85 offset:3136
  ds_read_b64_tr_b16 a[118:119], v85 offset:3520
  s_waitcnt lgkmcnt(0)
  s_add_u32 s20, s36, 3
  s_sub_u32 s22, s20, 10
  s_cmp_ge_u32 s20, 10
  s_cselect_b32 s20, s22, s20
  s_mul_i32 s20, s20, 786432
  s_add_u32 s20, s20, s35
  s_add_u32 s20, s20, 393216
  s_add_u32 s21, s34, 0
  s_mov_b32 m0, s21
  s_nop 0
  buffer_load_dwordx4 v80, s[12:15], s20 offen lds
  s_add_u32 s21, s34, 1024
  s_mov_b32 m0, s21
  s_nop 0
  buffer_load_dwordx4 v81, s[12:15], s20 offen lds
  s_add_u32 s21, s34, 2048
  s_mov_b32 m0, s21
  s_nop 0
  buffer_load_dwordx4 v82, s[12:15], s20 offen lds
  s_waitcnt vmcnt(9)
  ds_read_b64_tr_b16 a[120:121], v85 offset:6144
  ds_read_b64_tr_b16 a[122:123], v85 offset:6528
  ds_read_b64_tr_b16 v[88:89], v85 offset:6176
  ds_read_b64_tr_b16 v[90:91], v85 offset:6560
  ds_read_b64_tr_b16 a[128:129], v85 offset:6208
  ds_read_b64_tr_b16 a[130:131], v85 offset:6592
  s_waitcnt lgkmcnt(0)
  ds_write_b128 v15, v[88:91] offset:6144
  s_add_u32 s20, s36, 4
  s_sub_u32 s22, s20, 10
  s_cmp_ge_u32 s20, 10
  s_cselect_b32 s20, s22, s20
  s_mul_i32 s20, s20, 786432
  s_add_u32 s20, s20, s35
  s_add_u32 s21, s34, 3072
  s_mov_b32 m0, s21
  s_nop 0
  buffer_load_dwordx4 v80, s[8:11], s20 offen lds
  s_add_u32 s21, s34, 4096
  s_mov_b32 m0, s21
  s_nop 0
  buffer_load_dwordx4 v81, s[8:11], s20 offen lds
  s_add_u32 s21, s34, 5120
  s_mov_b32 m0, s21
  s_nop 0
  buffer_load_dwordx4 v82, s[8:11], s20 offen lds
  s_waitcnt vmcnt(9)
  ds_read_b64_tr_b16 a[136:137], v85 offset:9216
  ds_read_b64_tr_b16 a[138:139], v85 offset:9600
  ds_read_b64_tr_b16 a[144:145], v85 offset:9248
  ds_read_b64_tr_b16 a[146:147], v85 offset:9632
  ds_read_b64_tr_b16 a[152:153], v85 offset:9280
  ds_read_b64_tr_b16 a[154:155], v85 offset:9664
  s_waitcnt lgkmcnt(0)
  s_add_u32 s20, s36, 4
  s_sub_u32 s22, s20, 10
  s_cmp_ge_u32 s20, 10
  s_cselect_b32 s20, s22, s20
  s_mul_i32 s20, s20, 786432
  s_add_u32 s20, s20, s35
  s_add_u32 s21, s34, 6144
  s_mov_b32 m0, s21
  s_nop 0
  buffer_load_dwordx4 v80, s[12:15], s20 offen lds
  s_add_u32 s21, s34, 7168
  s_mov_b32 m0, s21
  s_nop 0
  buffer_load_dwordx4 v81, s[12:15], s20 offen lds
  s_add_u32 s21, s34, 8192
  s_mov_b32 m0, s21
  s_nop 0
  buffer_load_dwordx4 v82, s[12:15], s20 offen lds
  s_waitcnt vmcnt(9)
  ds_read_b64_tr_b16 a[124:125], v85 offset:12288
  ds_read_b64_tr_b16 a[126:127], v85 offset:12672
  ds_read_b64_tr_b16 v[88:89], v85 offset:12320
  ds_read_b64_tr_b16 v[90:91], v85 offset:12704
  ds_read_b64_tr_b16 a[132:133], v85 offset:12352
  ds_read_b64_tr_b16 a[134:135], v85 offset:12736
  s_waitcnt lgkmcnt(0)
  ds_write_b128 v15, v[88:91] offset:7168
  s_add_u32 s20, s36, 4
  s_sub_u32 s22, s20, 10
  s_cmp_ge_u32 s20, 10
  s_cselect_b32 s20, s22, s20
  s_mul_i32 s20, s20, 786432
  s_add_u32 s20, s20, s35
  s_add_u32 s20, s20, 393216
  s_add_u32 s21, s34, 9216
  s_mov_b32 m0, s21
  s_nop 0
  buffer_load_dwordx4 v80, s[8:11], s20 offen lds
  s_add_u32 s21, s34, 10240
  s_mov_b32 m0, s21
  s_nop 0
  buffer_load_dwordx4 v81, s[8:11], s20 offen lds
  s_add_u32 s21, s34, 11264
  s_mov_b32 m0, s21
  s_nop 0
  buffer_load_dwordx4 v82, s[8:11], s20 offen lds
  s_waitcnt vmcnt(9)
  ds_read_b64_tr_b16 a[140:141], v85 offset:0
  ds_read_b64_tr_b16 a[142:143], v85 offset:384
  ds_read_b64_tr_b16 a[148:149], v85 offset:32
  ds_read_b64_tr_b16 a[150:151], v85 offset:416
  ds_read_b64_tr_b16 a[156:157], v85 offset:64
  ds_read_b64_tr_b16 a[158:159], v85 offset:448
  s_waitcnt lgkmcnt(0)
  s_add_u32 s20, s36, 4
  s_sub_u32 s22, s20, 10
  s_cmp_ge_u32 s20, 10
  s_cselect_b32 s20, s22, s20
  s_mul_i32 s20, s20, 786432
  s_add_u32 s20, s20, s35
  s_add_u32 s20, s20, 393216
  s_add_u32 s21, s34, 12288
  s_mov_b32 m0, s21
  s_nop 0
  buffer_load_dwordx4 v80, s[12:15], s20 offen lds
  s_add_u32 s21, s34, 13312
  s_mov_b32 m0, s21
  s_nop 0
  buffer_load_dwordx4 v81, s[12:15], s20 offen lds
  s_add_u32 s21, s34, 14336
  s_mov_b32 m0, s21
  s_nop 0
  buffer_load_dwordx4 v82, s[12:15], s20 offen lds
  s_waitcnt vmcnt(9)
  ds_read_b64_tr_b16 v[88:89], v85 offset:3072
  ds_read_b64_tr_b16 v[90:91], v85 offset:3456
  ds_read_b64_tr_b16 a[160:161], v85 offset:3104
  ds_read_b64_tr_b16 a[162:163], v85 offset:3488
  ds_read_b64_tr_b16 a[168:169], v85 offset:3136
  ds_read_b64_tr_b16 a[170:171], v85 offset:3520
  s_waitcnt lgkmcnt(0)
  ds_write_b128 v15, v[88:91] offset:8192
  s_add_u32 s20, s36, 5
  s_sub_u32 s22, s20, 10
  s_cmp_ge_u32 s20, 10
  s_cselect_b32 s20, s22, s20
  s_mul_i32 s20, s20, 786432
  s_add_u32 s20, s20, s35
  s_add_u32 s21, s34, 0
  s_mov_b32 m0, s21
  s_nop 0
  buffer_load_dwordx4 v80, s[8:11], s20 offen lds
  s_add_u32 s21, s34, 1024
  s_mov_b32 m0, s21
  s_nop 0
  buffer_load_dwordx4 v81, s[8:11], s20 offen lds
  s_add_u32 s21, s34, 2048
  s_mov_b32 m0, s21
  s_nop 0
  buffer_load_dwordx4 v82, s[8:11], s20 offen lds
  s_waitcnt vmcnt(9)
  ds_read_b64_tr_b16 a[176:177], v85 offset:6144
  ds_read_b64_tr_b16 a[178:179], v85 offset:6528
  ds_read_b64_tr_b16 a[184:185], v85 offset:6176
  ds_read_b64_tr_b16 a[186:187], v85 offset:6560
  ds_read_b64_tr_b16 v[88:89], v85 offset:6208
  ds_read_b64_tr_b16 v[90:91], v85 offset:6592
  s_waitcnt lgkmcnt(0)
  ds_write_b128 v15, v[88:91] offset:10240
  s_add_u32 s20, s36, 5
  s_sub_u32 s22, s20, 10
  s_cmp_ge_u32 s20, 10
  s_cselect_b32 s20, s22, s20
  s_mul_i32 s20, s20, 786432
  s_add_u32 s20, s20, s35
  s_add_u32 s21, s34, 3072
  s_mov_b32 m0, s21
  s_nop 0
  buffer_load_dwordx4 v80, s[12:15], s20 offen lds
  s_add_u32 s21, s34, 4096
  s_mov_b32 m0, s21
  s_nop 0
  buffer_load_dwordx4 v81, s[12:15], s20 offen lds
  s_add_u32 s21, s34, 5120
  s_mov_b32 m0, s21
  s_nop 0
  buffer_load_dwordx4 v82, s[12:15], s20 offen lds
  s_waitcnt vmcnt(9)
  ds_read_b64_tr_b16 v[88:89], v85 offset:9216
  ds_read_b64_tr_b16 v[90:91], v85 offset:9600
  ds_read_b64_tr_b16 a[164:165], v85 offset:9248
  ds_read_b64_tr_b16 a[166:167], v85 offset:9632
  ds_read_b64_tr_b16 a[172:173], v85 offset:9280
  ds_read_b64_tr_b16 a[174:175], v85 offset:9664
  s_waitcnt lgkmcnt(0)
  ds_write_b128 v15, v[88:91] offset:9216
  s_add_u32 s20, s36, 5
  s_sub_u32 s22, s20, 10
  s_cmp_ge_u32 s20, 10
  s_cselect_b32 s20, s22, s20
  s_mul_i32 s20, s20, 786432
  s_add_u32 s20, s20, s35
  s_add_u32 s20, s20, 393216
  s_add_u32 s21, s34, 6144
  s_mov_b32 m0, s21
  s_nop 0
  buffer_load_dwordx4 v80, s[8:11], s20 offen lds
  s_add_u32 s21, s34, 7168
  s_mov_b32 m0, s21
  s_nop 0
  buffer_load_dwordx4 v81, s[8:11], s20 offen lds
  s_add_u32 s21, s34, 8192
  s_mov_b32 m0, s21
  s_nop 0
  buffer_load_dwordx4 v82, s[8:11], s20 offen lds
  s_waitcnt vmcnt(9)
  ds_read_b64_tr_b16 a[180:181], v85 offset:12288
  ds_read_b64_tr_b16 a[182:183], v85 offset:12672
  ds_read_b64_tr_b16 a[188:189], v85 offset:12320
  ds_read_b64_tr_b16 a[190:191], v85 offset:12704
  ds_read_b64_tr_b16 v[88:89], v85 offset:12352
  ds_read_b64_tr_b16 v[90:91], v85 offset:12736
  s_waitcnt lgkmcnt(0)
  ds_write_b128 v15, v[88:91] offset:11264
  s_add_u32 s20, s36, 5
  s_sub_u32 s22, s20, 10
  s_cmp_ge_u32 s20, 10
  s_cselect_b32 s20, s22, s20
  s_mul_i32 s20, s20, 786432
  s_add_u32 s20, s20, s35
  s_add_u32 s20, s20, 393216
  s_add_u32 s21, s34, 9216
  s_mov_b32 m0, s21
  s_nop 0
  buffer_load_dwordx4 v80, s[12:15], s20 offen lds
  s_add_u32 s21, s34, 10240
  s_mov_b32 m0, s21
  s_nop 0
  buffer_load_dwordx4 v81, s[12:15], s20 offen lds
  s_add_u32 s21, s34, 11264
  s_mov_b32 m0, s21
  s_nop 0
  buffer_load_dwordx4 v82, s[12:15], s20 offen lds
  s_waitcnt vmcnt(9)
  ds_read_b64_tr_b16 a[192:193], v85 offset:0
  ds_read_b64_tr_b16 a[194:195], v85 offset:384
  ds_read_b64_tr_b16 a[200:201], v85 offset:32
  ds_read_b64_tr_b16 a[202:203], v85 offset:416
  ds_read_b64_tr_b16 a[208:209], v85 offset:64
  ds_read_b64_tr_b16 a[210:211], v85 offset:448
  s_waitcnt lgkmcnt(0)
  s_add_u32 s20, s36, 6
  s_sub_u32 s22, s20, 10
  s_cmp_ge_u32 s20, 10
  s_cselect_b32 s20, s22, s20
  s_mul_i32 s20, s20, 786432
  s_add_u32 s20, s20, s35
  s_add_u32 s21, s34, 12288
  s_mov_b32 m0, s21
  s_nop 0
  buffer_load_dwordx4 v80, s[8:11], s20 offen lds
  s_add_u32 s21, s34, 13312
  s_mov_b32 m0, s21
  s_nop 0
  buffer_load_dwordx4 v81, s[8:11], s20 offen lds
  s_add_u32 s21, s34, 14336
  s_mov_b32 m0, s21
  s_nop 0
  buffer_load_dwordx4 v82, s[8:11], s20 offen lds
  s_waitcnt vmcnt(9)
  ds_read_b64_tr_b16 a[216:217], v85 offset:3072
  ds_read_b64_tr_b16 a[218:219], v85 offset:3456
  ds_read_b64_tr_b16 v[88:89], v85 offset:3104
  ds_read_b64_tr_b16 v[90:91], v85 offset:3488
  ds_read_b64_tr_b16 a[224:225], v85 offset:3136
  ds_read_b64_tr_b16 a[226:227], v85 offset:3520
  s_waitcnt lgkmcnt(0)
  ds_write_b128 v15, v[88:91] offset:12288
  s_add_u32 s20, s36, 6
  s_sub_u32 s22, s20, 10
  s_cmp_ge_u32 s20, 10
  s_cselect_b32 s20, s22, s20
  s_mul_i32 s20, s20, 786432
  s_add_u32 s20, s20, s35
  s_add_u32 s21, s34, 0
  s_mov_b32 m0, s21
  s_nop 0
  buffer_load_dwordx4 v80, s[12:15], s20 offen lds
  s_add_u32 s21, s34, 1024
  s_mov_b32 m0, s21
  s_nop 0
  buffer_load_dwordx4 v81, s[12:15], s20 offen lds
  s_add_u32 s21, s34, 2048
  s_mov_b32 m0, s21
  s_nop 0
  buffer_load_dwordx4 v82, s[12:15], s20 offen lds
  s_waitcnt vmcnt(9)
  ds_read_b64_tr_b16 a[196:197], v85 offset:6144
  ds_read_b64_tr_b16 a[198:199], v85 offset:6528
  ds_read_b64_tr_b16 a[204:205], v85 offset:6176
  ds_read_b64_tr_b16 a[206:207], v85 offset:6560
  ds_read_b64_tr_b16 a[212:213], v85 offset:6208
  ds_read_b64_tr_b16 a[214:215], v85 offset:6592
  s_waitcnt lgkmcnt(0)
  s_add_u32 s20, s36, 6
  s_sub_u32 s22, s20, 10
  s_cmp_ge_u32 s20, 10
  s_cselect_b32 s20, s22, s20
  s_mul_i32 s20, s20, 786432
  s_add_u32 s20, s20, s35
  s_add_u32 s20, s20, 393216
  s_add_u32 s21, s34, 3072
  s_mov_b32 m0, s21
  s_nop 0
  buffer_load_dwordx4 v80, s[8:11], s20 offen lds
  s_add_u32 s21, s34, 4096
  s_mov_b32 m0, s21
  s_nop 0
  buffer_load_dwordx4 v81, s[8:11], s20 offen lds
  s_add_u32 s21, s34, 5120
  s_mov_b32 m0, s21
  s_nop 0
  buffer_load_dwordx4 v82, s[8:11], s20 offen lds
  s_waitcnt vmcnt(9)
  ds_read_b64_tr_b16 a[220:221], v85 offset:9216
  ds_read_b64_tr_b16 a[222:223], v85 offset:9600
  ds_read_b64_tr_b16 v[88:89], v85 offset:9248
  ds_read_b64_tr_b16 v[90:91], v85 offset:9632
  ds_read_b64_tr_b16 a[228:229], v85 offset:9280
  ds_read_b64_tr_b16 a[230:231], v85 offset:9664
  s_waitcnt lgkmcnt(0)
  ds_write_b128 v15, v[88:91] offset:13312
  s_add_u32 s20, s36, 6
  s_sub_u32 s22, s20, 10
  s_cmp_ge_u32 s20, 10
  s_cselect_b32 s20, s22, s20
  s_mul_i32 s20, s20, 786432
  s_add_u32 s20, s20, s35
  s_add_u32 s20, s20, 393216
  s_add_u32 s21, s34, 6144
  s_mov_b32 m0, s21
  s_nop 0
  buffer_load_dwordx4 v80, s[12:15], s20 offen lds
  s_add_u32 s21, s34, 7168
  s_mov_b32 m0, s21
  s_nop 0
  buffer_load_dwordx4 v81, s[12:15], s20 offen lds
  s_add_u32 s21, s34, 8192
  s_mov_b32 m0, s21
  s_nop 0
  buffer_load_dwordx4 v82, s[12:15], s20 offen lds
  s_waitcnt vmcnt(9)
  ds_read_b64_tr_b16 a[232:233], v85 offset:12288
  ds_read_b64_tr_b16 a[234:235], v85 offset:12672
  ds_read_b64_tr_b16 a[240:241], v85 offset:12320
  ds_read_b64_tr_b16 a[242:243], v85 offset:12704
  ds_read_b64_tr_b16 a[248:249], v85 offset:12352
  ds_read_b64_tr_b16 a[250:251], v85 offset:12736
  s_waitcnt lgkmcnt(0)
  s_add_u32 s20, s36, 7
  s_sub_u32 s22, s20, 10
  s_cmp_ge_u32 s20, 10
  s_cselect_b32 s20, s22, s20
  s_mul_i32 s20, s20, 786432
  s_add_u32 s20, s20, s35
  s_add_u32 s21, s34, 9216
  s_mov_b32 m0, s21
  s_nop 0
  buffer_load_dwordx4 v80, s[8:11], s20 offen lds
  s_add_u32 s21, s34, 10240
  s_mov_b32 m0, s21
  s_nop 0
  buffer_load_dwordx4 v81, s[8:11], s20 offen lds
  s_add_u32 s21, s34, 11264
  s_mov_b32 m0, s21
  s_nop 0
  buffer_load_dwordx4 v82, s[8:11], s20 offen lds
  s_waitcnt vmcnt(9)
  ds_read_b64_tr_b16 v[88:89], v85 offset:0
  ds_read_b64_tr_b16 v[90:91], v85 offset:384
  ds_read_b64_tr_b16 v[128:129], v85 offset:32
  ds_read_b64_tr_b16 v[130:131], v85 offset:416
  ds_read_b64_tr_b16 v[136:137], v85 offset:64
  ds_read_b64_tr_b16 v[138:139], v85 offset:448
  s_waitcnt lgkmcnt(0)
  ds_write_b128 v15, v[88:91] offset:14336
  s_add_u32 s20, s36, 7
  s_sub_u32 s22, s20, 10
  s_cmp_ge_u32 s20, 10
  s_cselect_b32 s20, s22, s20
  s_mul_i32 s20, s20, 786432
  s_add_u32 s20, s20, s35
  s_add_u32 s21, s34, 12288
  s_mov_b32 m0, s21
  s_nop 0
  buffer_load_dwordx4 v80, s[12:15], s20 offen lds
  s_add_u32 s21, s34, 13312
  s_mov_b32 m0, s21
  s_nop 0
  buffer_load_dwordx4 v81, s[12:15], s20 offen lds
  s_add_u32 s21, s34, 14336
  s_mov_b32 m0, s21
  s_nop 0
  buffer_load_dwordx4 v82, s[12:15], s20 offen lds
  s_waitcnt vmcnt(9)
  ds_read_b64_tr_b16 a[236:237], v85 offset:3072
  ds_read_b64_tr_b16 a[238:239], v85 offset:3456
  ds_read_b64_tr_b16 a[244:245], v85 offset:3104
  ds_read_b64_tr_b16 a[246:247], v85 offset:3488
  ds_read_b64_tr_b16 a[252:253], v85 offset:3136
  ds_read_b64_tr_b16 a[254:255], v85 offset:3520
  s_waitcnt lgkmcnt(0)
  s_add_u32 s20, s36, 7
  s_sub_u32 s22, s20, 10
  s_cmp_ge_u32 s20, 10
  s_cselect_b32 s20, s22, s20
  s_mul_i32 s20, s20, 786432
  s_add_u32 s20, s20, s35
  s_add_u32 s20, s20, 393216
  s_add_u32 s21, s34, 0
  s_mov_b32 m0, s21
  s_nop 0
  buffer_load_dwordx4 v80, s[8:11], s20 offen lds
  s_add_u32 s21, s34, 1024
  s_mov_b32 m0, s21
  s_nop 0
  buffer_load_dwordx4 v81, s[8:11], s20 offen lds
  s_add_u32 s21, s34, 2048
  s_mov_b32 m0, s21
  s_nop 0
  buffer_load_dwordx4 v82, s[8:11], s20 offen lds
  s_waitcnt vmcnt(9)
  ds_read_b64_tr_b16 v[88:89], v85 offset:6144
  ds_read_b64_tr_b16 v[90:91], v85 offset:6528
  ds_read_b64_tr_b16 v[132:133], v85 offset:6176
  ds_read_b64_tr_b16 v[134:135], v85 offset:6560
  ds_read_b64_tr_b16 v[140:141], v85 offset:6208
  ds_read_b64_tr_b16 v[142:143], v85 offset:6592
  s_waitcnt lgkmcnt(0)
  ds_write_b128 v15, v[88:91] offset:15360
  s_add_u32 s20, s36, 7
  s_sub_u32 s22, s20, 10
  s_cmp_ge_u32 s20, 10
  s_cselect_b32 s20, s22, s20
  s_mul_i32 s20, s20, 786432
  s_add_u32 s20, s20, s35
  s_add_u32 s20, s20, 393216
  s_add_u32 s21, s34, 3072
  s_mov_b32 m0, s21
  s_nop 0
  buffer_load_dwordx4 v80, s[12:15], s20 offen lds
  s_add_u32 s21, s34, 4096
  s_mov_b32 m0, s21
  s_nop 0
  buffer_load_dwordx4 v81, s[12:15], s20 offen lds
  s_add_u32 s21, s34, 5120
  s_mov_b32 m0, s21
  s_nop 0
  buffer_load_dwordx4 v82, s[12:15], s20 offen lds
  s_waitcnt vmcnt(9)
  ds_read_b64_tr_b16 v[144:145], v85 offset:9216
  ds_read_b64_tr_b16 v[146:147], v85 offset:9600
  ds_read_b64_tr_b16 v[152:153], v85 offset:9248
  ds_read_b64_tr_b16 v[154:155], v85 offset:9632
  ds_read_b64_tr_b16 v[88:89], v85 offset:9280
  ds_read_b64_tr_b16 v[90:91], v85 offset:9664
  s_waitcnt lgkmcnt(0)
  ds_write_b128 v15, v[88:91] offset:16384
  s_add_u32 s20, s36, 8
  s_sub_u32 s22, s20, 10
  s_cmp_ge_u32 s20, 10
  s_cselect_b32 s20, s22, s20
  s_mul_i32 s20, s20, 786432
  s_add_u32 s20, s20, s35
  s_add_u32 s21, s34, 6144
  s_mov_b32 m0, s21
  s_nop 0
  buffer_load_dwordx4 v80, s[8:11], s20 offen lds
  s_add_u32 s21, s34, 7168
  s_mov_b32 m0, s21
  s_nop 0
  buffer_load_dwordx4 v81, s[8:11], s20 offen lds
  s_add_u32 s21, s34, 8192
  s_mov_b32 m0, s21
  s_nop 0
  buffer_load_dwordx4 v82, s[8:11], s20 offen lds
  s_waitcnt vmcnt(9)
  ds_read_b64_tr_b16 v[160:161], v85 offset:12288
  ds_read_b64_tr_b16 v[162:163], v85 offset:12672
  ds_read_b64_tr_b16 v[168:169], v85 offset:12320
  ds_read_b64_tr_b16 v[170:171], v85 offset:12704
  ds_read_b64_tr_b16 v[176:177], v85 offset:12352
  ds_read_b64_tr_b16 v[178:179], v85 offset:12736
  s_waitcnt lgkmcnt(0)
  s_add_u32 s20, s36, 8
  s_sub_u32 s22, s20, 10
  s_cmp_ge_u32 s20, 10
  s_cselect_b32 s20, s22, s20
  s_mul_i32 s20, s20, 786432
  s_add_u32 s20, s20, s35
  s_add_u32 s21, s34, 9216
  s_mov_b32 m0, s21
  s_nop 0
  buffer_load_dwordx4 v80, s[12:15], s20 offen lds
  s_add_u32 s21, s34, 10240
  s_mov_b32 m0, s21
  s_nop 0
  buffer_load_dwordx4 v81, s[12:15], s20 offen lds
  s_add_u32 s21, s34, 11264
  s_mov_b32 m0, s21
  s_nop 0
  buffer_load_dwordx4 v82, s[12:15], s20 offen lds
  s_waitcnt vmcnt(9)
  ds_read_b64_tr_b16 v[148:149], v85 offset:0
  ds_read_b64_tr_b16 v[150:151], v85 offset:384
  ds_read_b64_tr_b16 v[156:157], v85 offset:32
  ds_read_b64_tr_b16 v[158:159], v85 offset:416
  ds_read_b64_tr_b16 v[88:89], v85 offset:64
  ds_read_b64_tr_b16 v[90:91], v85 offset:448
  s_waitcnt lgkmcnt(0)
  ds_write_b128 v15, v[88:91] offset:17408
  s_add_u32 s20, s36, 8
  s_sub_u32 s22, s20, 10
  s_cmp_ge_u32 s20, 10
  s_cselect_b32 s20, s22, s20
  s_mul_i32 s20, s20, 786432
  s_add_u32 s20, s20, s35
  s_add_u32 s20, s20, 393216
  s_add_u32 s21, s34, 12288
  s_mov_b32 m0, s21
  s_nop 0
  buffer_load_dwordx4 v80, s[8:11], s20 offen lds
  s_add_u32 s21, s34, 13312
  s_mov_b32 m0, s21
  s_nop 0
  buffer_load_dwordx4 v81, s[8:11], s20 offen lds
  s_add_u32 s21, s34, 14336
  s_mov_b32 m0, s21
  s_nop 0
  buffer_load_dwordx4 v82, s[8:11], s20 offen lds
  s_waitcnt vmcnt(9)
  ds_read_b64_tr_b16 v[164:165], v85 offset:3072
  ds_read_b64_tr_b16 v[166:167], v85 offset:3456
  ds_read_b64_tr_b16 v[172:173], v85 offset:3104
  ds_read_b64_tr_b16 v[174:175], v85 offset:3488
  ds_read_b64_tr_b16 v[180:181], v85 offset:3136
  ds_read_b64_tr_b16 v[182:183], v85 offset:3520
  s_waitcnt lgkmcnt(0)
  s_add_u32 s20, s36, 8
  s_sub_u32 s22, s20, 10
  s_cmp_ge_u32 s20, 10
  s_cselect_b32 s20, s22, s20
  s_mul_i32 s20, s20, 786432
  s_add_u32 s20, s20, s35
  s_add_u32 s20, s20, 393216
  s_add_u32 s21, s34, 0
  s_mov_b32 m0, s21
  s_nop 0
  buffer_load_dwordx4 v80, s[12:15], s20 offen lds
  s_add_u32 s21, s34, 1024
  s_mov_b32 m0, s21
  s_nop 0
  buffer_load_dwordx4 v81, s[12:15], s20 offen lds
  s_add_u32 s21, s34, 2048
  s_mov_b32 m0, s21
  s_nop 0
  buffer_load_dwordx4 v82, s[12:15], s20 offen lds
  s_waitcnt vmcnt(9)
  ds_read_b64_tr_b16 v[184:185], v85 offset:6144
  ds_read_b64_tr_b16 v[186:187], v85 offset:6528
  ds_read_b64_tr_b16 v[88:89], v85 offset:6176
  ds_read_b64_tr_b16 v[90:91], v85 offset:6560
  ds_read_b64_tr_b16 v[192:193], v85 offset:6208
  ds_read_b64_tr_b16 v[194:195], v85 offset:6592
  s_waitcnt lgkmcnt(0)
  ds_write_b128 v15, v[88:91] offset:18432
  s_add_u32 s20, s36, 9
  s_sub_u32 s22, s20, 10
  s_cmp_ge_u32 s20, 10
  s_cselect_b32 s20, s22, s20
  s_mul_i32 s20, s20, 786432
  s_add_u32 s20, s20, s35
  s_add_u32 s21, s34, 3072
  s_mov_b32 m0, s21
  s_nop 0
  buffer_load_dwordx4 v80, s[8:11], s20 offen lds
  s_add_u32 s21, s34, 4096
  s_mov_b32 m0, s21
  s_nop 0
  buffer_load_dwordx4 v81, s[8:11], s20 offen lds
  s_add_u32 s21, s34, 5120
  s_mov_b32 m0, s21
  s_nop 0
  buffer_load_dwordx4 v82, s[8:11], s20 offen lds
  s_waitcnt vmcnt(9)
  ds_read_b64_tr_b16 v[200:201], v85 offset:9216
  ds_read_b64_tr_b16 v[202:203], v85 offset:9600
  ds_read_b64_tr_b16 v[208:209], v85 offset:9248
  ds_read_b64_tr_b16 v[210:211], v85 offset:9632
  ds_read_b64_tr_b16 v[216:217], v85 offset:9280
  ds_read_b64_tr_b16 v[218:219], v85 offset:9664
  s_waitcnt lgkmcnt(0)
  s_add_u32 s20, s36, 9
  s_sub_u32 s22, s20, 10
  s_cmp_ge_u32 s20, 10
  s_cselect_b32 s20, s22, s20
  s_mul_i32 s20, s20, 786432
  s_add_u32 s20, s20, s35
  s_add_u32 s21, s34, 6144
  s_mov_b32 m0, s21
  s_nop 0
  buffer_load_dwordx4 v80, s[12:15], s20 offen lds
  s_add_u32 s21, s34, 7168
  s_mov_b32 m0, s21
  s_nop 0
  buffer_load_dwordx4 v81, s[12:15], s20 offen lds
  s_add_u32 s21, s34, 8192
  s_mov_b32 m0, s21
  s_nop 0
  buffer_load_dwordx4 v82, s[12:15], s20 offen lds
  s_waitcnt vmcnt(9)
  ds_read_b64_tr_b16 v[188:189], v85 offset:12288
  ds_read_b64_tr_b16 v[190:191], v85 offset:12672
  ds_read_b64_tr_b16 v[88:89], v85 offset:12320
  ds_read_b64_tr_b16 v[90:91], v85 offset:12704
  ds_read_b64_tr_b16 v[196:197], v85 offset:12352
  ds_read_b64_tr_b16 v[198:199], v85 offset:12736
  s_waitcnt lgkmcnt(0)
  ds_write_b128 v15, v[88:91] offset:19456
  s_add_u32 s20, s36, 9
  s_sub_u32 s22, s20, 10
  s_cmp_ge_u32 s20, 10
  s_cselect_b32 s20, s22, s20
  s_mul_i32 s20, s20, 786432
  s_add_u32 s20, s20, s35
  s_add_u32 s20, s20, 393216
  s_add_u32 s21, s34, 9216
  s_mov_b32 m0, s21
  s_nop 0
  buffer_load_dwordx4 v80, s[8:11], s20 offen lds
  s_add_u32 s21, s34, 10240
  s_mov_b32 m0, s21
  s_nop 0
  buffer_load_dwordx4 v81, s[8:11], s20 offen lds
  s_add_u32 s21, s34, 11264
  s_mov_b32 m0, s21
  s_nop 0
  buffer_load_dwordx4 v82, s[8:11], s20 offen lds
  s_waitcnt vmcnt(9)
  ds_read_b64_tr_b16 v[204:205], v85 offset:0
  ds_read_b64_tr_b16 v[206:207], v85 offset:384
  ds_read_b64_tr_b16 v[212:213], v85 offset:32
  ds_read_b64_tr_b16 v[214:215], v85 offset:416
  ds_read_b64_tr_b16 v[220:221], v85 offset:64
  ds_read_b64_tr_b16 v[222:223], v85 offset:448
  s_waitcnt lgkmcnt(0)
  s_add_u32 s20, s36, 9
  s_sub_u32 s22, s20, 10
  s_cmp_ge_u32 s20, 10
  s_cselect_b32 s20, s22, s20
  s_mul_i32 s20, s20, 786432
  s_add_u32 s20, s20, s35
  s_add_u32 s20, s20, 393216
  s_add_u32 s21, s34, 12288
  s_mov_b32 m0, s21
  s_nop 0
  buffer_load_dwordx4 v80, s[12:15], s20 offen lds
  s_add_u32 s21, s34, 13312
  s_mov_b32 m0, s21
  s_nop 0
  buffer_load_dwordx4 v81, s[12:15], s20 offen lds
  s_add_u32 s21, s34, 14336
  s_mov_b32 m0, s21
  s_nop 0
  buffer_load_dwordx4 v82, s[12:15], s20 offen lds
  s_waitcnt vmcnt(9)
  ds_read_b64_tr_b16 v[88:89], v85 offset:3072
  ds_read_b64_tr_b16 v[90:91], v85 offset:3456
  ds_read_b64_tr_b16 v[224:225], v85 offset:3104
  ds_read_b64_tr_b16 v[226:227], v85 offset:3488
  ds_read_b64_tr_b16 v[232:233], v85 offset:3136
  ds_read_b64_tr_b16 v[234:235], v85 offset:3520
  s_waitcnt lgkmcnt(0)
  ds_write_b128 v15, v[88:91] offset:20480
  s_waitcnt vmcnt(6)
  ds_read_b64_tr_b16 v[240:241], v85 offset:6144
  ds_read_b64_tr_b16 v[242:243], v85 offset:6528
  ds_read_b64_tr_b16 v[248:249], v85 offset:6176
  ds_read_b64_tr_b16 v[250:251], v85 offset:6560
  ds_read_b64_tr_b16 v[88:89], v85 offset:6208
  ds_read_b64_tr_b16 v[90:91], v85 offset:6592
  s_waitcnt lgkmcnt(0)
  ds_write_b128 v15, v[88:91] offset:22528
  s_waitcnt vmcnt(3)
  ds_read_b64_tr_b16 v[88:89], v85 offset:9216
  ds_read_b64_tr_b16 v[90:91], v85 offset:9600
  ds_read_b64_tr_b16 v[228:229], v85 offset:9248
  ds_read_b64_tr_b16 v[230:231], v85 offset:9632
  ds_read_b64_tr_b16 v[236:237], v85 offset:9280
  ds_read_b64_tr_b16 v[238:239], v85 offset:9664
  s_waitcnt lgkmcnt(0)
  ds_write_b128 v15, v[88:91] offset:21504
  s_waitcnt vmcnt(0)
  ds_read_b64_tr_b16 v[244:245], v85 offset:12288
  ds_read_b64_tr_b16 v[246:247], v85 offset:12672
  ds_read_b64_tr_b16 v[252:253], v85 offset:12320
  ds_read_b64_tr_b16 v[254:255], v85 offset:12704
  ds_read_b64_tr_b16 v[88:89], v85 offset:12352
  ds_read_b64_tr_b16 v[90:91], v85 offset:12736
  s_waitcnt lgkmcnt(0)
  ds_write_b128 v15, v[88:91] offset:23552
  s_waitcnt lgkmcnt(0)
  s_barrier
  v_and_b32 v81, 3, v1
  v_lshlrev_b32 v80, 6, v81
  v_bfe_u32 v81, v1, 2, 2
  v_lshlrev_b32 v81, 4, v81
  v_add_u32 v80, v80, v81
  v_lshrrev_b32 v81, 4, v1
  v_lshlrev_b32 v81, 2, v81
  v_add_u32 v80, v80, v81
  s_mul_i32 s20, s16, 768
  s_add_u32 s20, s20, 10240
  v_add_u32 v11, s20, v80
  v_bfe_u32 v80, v1, 2, 2
  v_lshlrev_b32 v80, 6, v80
  v_lshrrev_b32 v81, 4, v1
  v_lshlrev_b32 v81, 4, v81
  v_add_u32 v80, v80, v81
  v_and_b32 v81, 1, v1
  v_lshlrev_b32 v81, 3, v81
  v_add_u32 v80, v80, v81
  v_add_u32 v12, 10240, v80
  v_lshrrev_b32 v80, 5, v1
  v_lshlrev_b32 v80, 8, v80
  v_bfe_u32 v81, v1, 4, 1
  v_lshlrev_b32 v81, 4, v81
  v_add_u32 v80, v80, v81
  v_and_b32 v81, 7, v1
  v_lshlrev_b32 v82, 5, v81
  v_add_u32 v80, v80, v82
  v_lshlrev_b32 v82, 4, v81
  v_bfe_u32 v83, v1, 3, 1
  v_mul_u32_u24 v83, 49152, v83
  v_add_u32 v80, v80, v83
  s_lshr_b32 s21, s17, 4
  s_lshl_b32 s21, s21, 14
  s_and_b32 s20, s17, 15
  s_lshl_b32 s20, s20, 9
  s_add_u32 s20, s20, s21
  v_add_u32 v13, s20, v80
  v_mov_b32 v82, 0x7ff00000
  v_and_b32 v83, 8, v1
  v_cmp_eq_u32 vcc, 0, v83
  s_nop 1
  v_cndmask_b32 v13, v82, v13, vcc
  v_and_b32 v81, 7, v1
  v_lshlrev_b32 v82, 4, v81
  v_bfe_u32 v83, v1, 3, 2
  v_mul_u32_u24 v83, 49152, v83
  v_add_u32 v80, v82, v83
  s_lshl_b32 s20, s17, 7
  s_add_u32 s20, s20, 32768
  v_add_u32 v14, s20, v80
  v_mov_b32 v82, 0x7ff00000
  v_cmp_gt_u32 vcc, 8, v1
  s_nop 1
  v_cndmask_b32 v14, v82, v14, vcc
  s_mov_b32 s24, 0
  s_mov_b32 s25, -1
  s_mov_b32 s74, 0xff00ff00
  s_mov_b32 s75, 0xff00ff00
  s_mov_b32 s38, 0x3dd53b95
  s_mov_b32 s18, 0
  s_mul_i32 s29, s17, 24576
  s_add_u32 s29, s29, 8912896
  s_mov_b32 s52, s32
  s_mov_b32 s53, s33
  s_mov_b32 s54, 256
  s_mov_b32 s55, 0x00020000
  s_cmp_lg_u32 s16, 0
  s_cbranch_scc1 Lwr_21
  v_lshrrev_b32 v16, 4, v2
  v_lshlrev_b32 v16, 7, v16
  v_mov_b32 v17, 196
  s_mov_b32 s51, 106496
  s_mov_b32 s50, 114688
Lwrt_22:
  buffer_load_dword v18, v16, s[4:7], s51 offen sc1
  buffer_load_dword v19, v16, s[4:7], s50 offen sc1
  buffer_load_dword v20, v17, s[52:55], 0 offen sc1
  s_waitcnt vmcnt(0)
  v_cmp_ne_u32 vcc, s70, v18
  s_cbranch_vccnz Lwra_24
  v_cmp_ne_u32 vcc, s70, v19
  s_cbranch_vccnz Lwra_24
  v_cmp_eq_u32 vcc, 0, v20
  s_cbranch_vccnz Lwra_24
  s_branch Lwrd_23
Lwra_24:
  s_sleep 2
  s_cmp_eq_u32 s19, 0
  s_cbranch_scc1 Lwrd_23
  s_sub_u32 s19, s19, 1
  s_branch Lwrt_22
Lwrd_23:
  v_mov_b32 v16, 0
  ds_write_b32 v16, v20 offset:10240
  s_waitcnt lgkmcnt(0)
Lwr_21:
  s_barrier
  v_mov_b32 v16, 0
  ds_read_b32 v17, v16 offset:10240
  s_waitcnt lgkmcnt(0)
  v_readfirstlane_b32 s50, v17
  s_barrier
  s_nop 2
  s_and_b32 s51, s50, 1
  s_lshl_b32 s51, s51, 13
  s_add_u32 s43, s43, s51
  s_and_b32 s51, s50, 2
  s_lshl_b32 s51, s51, 12
  s_add_u32 s39, s39, s51
  s_waitcnt vmcnt(0)
  s_lshl_b32 s20, s17, 7
  v_mov_b32 v0, s20
  s_cmp_lg_u32 s16, 3
  s_cbranch_scc1 La_25
  s_add_u32 s23, s18, 1
  s_mov_b32 s22, 0
Lwf_27:
  buffer_load_dword v7, v0, s[4:7], s22 offen sc1
  s_waitcnt vmcnt(0)
  v_cmp_gt_u32 vcc, s23, v7
  s_cbranch_vccz Lwfd_28
  s_sleep 2
  s_cmp_eq_u32 s19, 0
  s_cbranch_scc1 Lwfd_28
  s_sub_u32 s19, s19, 1
  s_branch Lwf_27
Lwfd_28:
LAok_26:
  s_mov_b32 s23, 16384
  s_mov_b32 s21, s29
  s_add_u32 s20, s23, 0
  s_mov_b32 m0, s20
  s_nop 0
  buffer_load_dwordx4 v2, s[4:7], s21 offen sc1 lds
  s_add_u32 s21, s21, 1024
  s_add_u32 s20, s23, 1024
  s_mov_b32 m0, s20
  s_nop 0
  buffer_load_dwordx4 v2, s[4:7], s21 offen sc1 lds
  s_add_u32 s21, s21, 1024
  s_add_u32 s20, s23, 2048
  s_mov_b32 m0, s20
  s_nop 0
  buffer_load_dwordx4 v2, s[4:7], s21 offen sc1 lds
  s_add_u32 s21, s21, 1024
  s_add_u32 s20, s23, 3072
  s_mov_b32 m0, s20
  s_nop 0
  buffer_load_dwordx4 v2, s[4:7], s21 offen sc1 lds
  s_add_u32 s21, s21, 1024
  s_add_u32 s20, s23, 4096
  s_mov_b32 m0, s20
  s_nop 0
  buffer_load_dwordx4 v2, s[4:7], s21 offen sc1 lds
  s_add_u32 s21, s21, 1024
  s_add_u32 s20, s23, 5120
  s_mov_b32 m0, s20
  s_nop 0
  buffer_load_dwordx4 v2, s[4:7], s21 offen sc1 lds
  s_add_u32 s21, s21, 1024
  s_add_u32 s20, s23, 6144
  s_mov_b32 m0, s20
  s_nop 0
  buffer_load_dwordx4 v2, s[4:7], s21 offen sc1 lds
  s_add_u32 s21, s21, 1024
  s_add_u32 s20, s23, 7168
  s_mov_b32 m0, s20
  s_nop 0
  buffer_load_dwordx4 v2, s[4:7], s21 offen sc1 lds
  s_add_u32 s21, s21, 1024
  s_add_u32 s20, s23, 8192
  s_mov_b32 m0, s20
  s_nop 0
  buffer_load_dwordx4 v2, s[4:7], s21 offen sc1 lds
  s_add_u32 s21, s21, 1024
  s_add_u32 s20, s23, 9216
  s_mov_b32 m0, s20
  s_nop 0
  buffer_load_dwordx4 v2, s[4:7], s21 offen sc1 lds
  s_add_u32 s21, s21, 1024
  s_add_u32 s20, s23, 10240
  s_mov_b32 m0, s20
  s_nop 0
  buffer_load_dwordx4 v2, s[4:7], s21 offen sc1 lds
  s_add_u32 s21, s21, 1024
  s_add_u32 s20, s23, 11264
  s_mov_b32 m0, s20
  s_nop 0
  buffer_load_dwordx4 v2, s[4:7], s21 offen sc1 lds
  s_add_u32 s21, s21, 1024
  s_add_u32 s20, s23, 12288
  s_mov_b32 m0, s20
  s_nop 0
  buffer_load_dwordx4 v2, s[4:7], s21 offen sc1 lds
  s_add_u32 s21, s21, 1024
  s_add_u32 s20, s23, 13312
  s_mov_b32 m0, s20
  s_nop 0
  buffer_load_dwordx4 v2, s[4:7], s21 offen sc1 lds
  s_add_u32 s21, s21, 1024
  s_add_u32 s20, s23, 14336
  s_mov_b32 m0, s20
  s_nop 0
  buffer_load_dwordx4 v2, s[4:7], s21 offen sc1 lds
  s_add_u32 s21, s21, 1024
  s_add_u32 s20, s23, 15360
  s_mov_b32 m0, s20
  s_nop 0
  buffer_load_dwordx4 v2, s[4:7], s21 offen sc1 lds
  s_add_u32 s21, s21, 1024
  s_add_u32 s20, s23, 16384
  s_mov_b32 m0, s20
  s_nop 0
  buffer_load_dwordx4 v2, s[4:7], s21 offen sc1 lds
  s_add_u32 s21, s21, 1024
  s_add_u32 s20, s23, 17408
  s_mov_b32 m0, s20
  s_nop 0
  buffer_load_dwordx4 v2, s[4:7], s21 offen sc1 lds
  s_add_u32 s21, s21, 1024
  s_add_u32 s20, s23, 18432
  s_mov_b32 m0, s20
  s_nop 0
  buffer_load_dwordx4 v2, s[4:7], s21 offen sc1 lds
  s_add_u32 s21, s21, 1024
  s_add_u32 s20, s23, 19456
  s_mov_b32 m0, s20
  s_nop 0
  buffer_load_dwordx4 v2, s[4:7], s21 offen sc1 lds
  s_add_u32 s21, s21, 1024
  s_add_u32 s20, s23, 20480
  s_mov_b32 m0, s20
  s_nop 0
  buffer_load_dwordx4 v2, s[4:7], s21 offen sc1 lds
  s_add_u32 s21, s21, 1024
  s_add_u32 s20, s23, 21504
  s_mov_b32 m0, s20
  s_nop 0
  buffer_load_dwordx4 v2, s[4:7], s21 offen sc1 lds
  s_add_u32 s21, s21, 1024
  s_add_u32 s20, s23, 22528
  s_mov_b32 m0, s20
  s_nop 0
  buffer_load_dwordx4 v2, s[4:7], s21 offen sc1 lds
  s_add_u32 s21, s21, 1024
  s_add_u32 s20, s23, 23552
  s_mov_b32 m0, s20
  s_nop 0
  buffer_load_dwordx4 v2, s[4:7], s21 offen sc1 lds
  s_waitcnt vmcnt(0)
La_25:
  s_mov_b32 s62, 0
  s_mov_b32 s60, 0
  s_mov_b32 s63, 1
  s_lshl_b32 s21, s16, 2
  s_add_u32 s21, s21, 10240
  v_mov_b32 v40, s21
  v_mov_b32 v41, s63
  ds_write_b32 v40, v41
LAloop_29:
  v_mov_b32 v16, 0
  v_mov_b32 v17, 0
  v_mov_b32 v18, 0
  v_mov_b32 v19, 0
  v_mov_b32 v20, 0
  v_mov_b32 v21, 0
  v_mov_b32 v22, 0
  v_mov_b32 v23, 0
  v_mov_b32 v24, 0
  v_mov_b32 v25, 0
  v_mov_b32 v26, 0
  v_mov_b32 v27, 0
  v_mov_b32 v28, 0
  v_mov_b32 v29, 0
  v_mov_b32 v30, 0
  v_mov_b32 v31, 0
  v_mov_b32 v32, 0
  v_mov_b32 v33, 0
  v_mov_b32 v34, 0
  v_mov_b32 v35, 0
  v_mov_b32 v36, 0
  v_mov_b32 v37, 0
  v_mov_b32 v38, 0
  v_mov_b32 v39, 0
  ds_read_b128 v[64:67], v15 offset:0
  ds_read_b128 v[68:71], v15 offset:1024
  ds_read_b128 v[72:75], v15 offset:2048
  ds_read_b128 v[76:79], v15 offset:3072
  s_add_u32 s20, s18, 0
  s_and_b32 s20, s20, 3
  s_mul_i32 s20, s20, 32768
  s_add_u32 s26, s20, s43
  s_and_b32 s20, s18, 3
  s_mul_i32 s20, s20, 49152
  s_add_u32 s27, s20, s43
  s_add_u32 s27, s27, 131072
  v_lshrrev_b32 v7, 1, v4
  v_and_b32 v7, 0x2000, v7
  v_and_b32 v52, 0x1fff, v4
  v_or_b32 v52, v7, v52
  v_lshrrev_b32 v7, 1, v5
  v_and_b32 v7, 0x2000, v7
  v_and_b32 v53, 0x1fff, v5
  v_or_b32 v53, v7, v53
  v_lshrrev_b32 v7, 1, v6
  v_and_b32 v7, 0x2000, v7
  v_and_b32 v54, 0x1fff, v6
  v_or_b32 v54, v7, v54
  s_mov_b32 s20, 0
  buffer_load_dword v1, v0, s[4:7], s20 offen sc1
  s_waitcnt lgkmcnt(0)
  s_barrier
  s_sleep 20
Lcl_30:
  buffer_load_dwordx4 v[40:43], v4, s[4:7], s26 offen sc1
  buffer_load_dwordx4 v[44:47], v5, s[4:7], s26 offen sc1
  buffer_load_dwordx4 v[48:51], v6, s[4:7], s26 offen sc1
  s_waitcnt vmcnt(0)
  v_max3_u32 v7, v43, v47, v51
  v_cmp_eq_u32 vcc, -1, v7
  s_cbranch_vccz Lclok_31
  s_cmp_eq_u32 s19, 0
  s_cbranch_scc1 Lclok_31
  s_sub_u32 s19, s19, 1
  s_branch Lcl_30
Lclok_31:
  s_mov_b32 s63, 1
  ds_write_b128 v52, v[40:43]
  ds_write_b128 v53, v[44:47]
  ds_write_b128 v54, v[48:51]
  v_smfmac_f32_16x16x64_bf16 v[16:19], v[40:43], a[0:7], v3
  v_smfmac_f32_16x16x64_bf16 v[20:23], v[40:43], a[8:15], v3
  v_smfmac_f32_16x16x64_bf16 v[24:27], v[40:43], a[16:23], v3
  v_smfmac_f32_16x16x64_bf16 v[28:31], v[40:43], a[24:31], v3
  v_smfmac_f32_16x16x64_bf16 v[32:35], v[40:43], v[64:71], v3
  ds_read_b128 v[64:67], v15 offset:4096
  ds_read_b128 v[68:71], v15 offset:5120
  v_smfmac_f32_16x16x64_bf16 v[36:39], v[40:43], a[32:39], v3
  s_waitcnt lgkmcnt(2)
  s_barrier
  ds_read_b128 v[52:55], v8 offset:0
  ds_read_b128 v[56:59], v9 offset:0
  ds_read_b128 v[60:63], v9 offset:1024
  v_smfmac_f32_16x16x64_bf16 v[16:19], v[44:47], a[40:47], v3
  v_smfmac_f32_16x16x64_bf16 v[20:23], v[44:47], a[48:55], v3
  v_smfmac_f32_16x16x64_bf16 v[24:27], v[44:47], a[56:63], v3
  v_smfmac_f32_16x16x64_bf16 v[28:31], v[44:47], v[72:79], v3
  ds_read_b128 v[72:75], v15 offset:6144
  ds_read_b128 v[76:79], v15 offset:7168
  v_smfmac_f32_16x16x64_bf16 v[32:35], v[44:47], a[64:71], v3
  v_smfmac_f32_16x16x64_bf16 v[36:39], v[44:47], a[72:79], v3
  v_smfmac_f32_16x16x64_bf16 v[16:19], v[48:51], a[80:87], v3
  v_smfmac_f32_16x16x64_bf16 v[20:23], v[48:51], a[88:95], v3
  s_waitcnt lgkmcnt(5)
  v_smfmac_f32_16x16x64_bf16 v[24:27], v[48:51], v[64:71], v3
  ds_read_b128 v[64:67], v15 offset:8192
  ds_read_b128 v[68:71], v15 offset:9216
  v_smfmac_f32_16x16x64_bf16 v[28:31], v[48:51], a[96:103], v3
  v_smfmac_f32_16x16x64_bf16 v[32:35], v[48:51], a[104:111], v3
  v_smfmac_f32_16x16x64_bf16 v[36:39], v[48:51], a[112:119], v3
  s_cmp_lg_u32 s16, 0
  s_cbranch_scc1 Lnw0_32
  s_waitcnt lgkmcnt(6)
  v_smfmac_f32_16x16x64_bf16 v[16:19], v[52:55], a[120:127], v3
  s_waitcnt lgkmcnt(2)
  v_smfmac_f32_16x16x64_bf16 v[20:23], v[52:55], v[72:79], v3
  ds_read_b128 v[72:75], v15 offset:10240
  ds_read_b128 v[76:79], v15 offset:11264
  v_smfmac_f32_16x16x64_bf16 v[24:27], v[52:55], a[128:135], v3
  v_smfmac_f32_16x16x64_bf16 v[28:31], v[52:55], a[136:143], v3
  v_smfmac_f32_16x16x64_bf16 v[32:35], v[52:55], a[144:151], v3
  v_smfmac_f32_16x16x64_bf16 v[36:39], v[52:55], a[152:159], v3
  ds_read_b128 v[52:55], v9 offset:2048
  s_and_b32 s20, s18, 1
  s_mul_i32 s20, s20, 24576
  s_add_u32 s20, s20, 28672
  v_add_u32 v7, s20, v2
  ds_read_b128 v[80:83], v7 offset:0
  ds_read_b128 v[104:107], v7 offset:6144
  s_waitcnt lgkmcnt(5)
  v_smfmac_f32_16x16x64_bf16 v[16:19], v[56:59], v[64:71], v3
  ds_read_b128 v[64:67], v15 offset:12288
  ds_read_b128 v[68:71], v15 offset:13312
  v_smfmac_f32_16x16x64_bf16 v[20:23], v[56:59], a[160:167], v3
  v_smfmac_f32_16x16x64_bf16 v[24:27], v[56:59], a[168:175], v3
  v_smfmac_f32_16x16x64_bf16 v[28:31], v[56:59], a[176:183], v3
  v_smfmac_f32_16x16x64_bf16 v[32:35], v[56:59], a[184:191], v3
  s_waitcnt lgkmcnt(5)
  v_smfmac_f32_16x16x64_bf16 v[36:39], v[56:59], v[72:79], v3
  ds_read_b128 v[72:75], v15 offset:14336
  ds_read_b128 v[76:79], v15 offset:15360
  ds_read_b128 v[56:59], v10 offset:0
  ds_read_b128 v[84:87], v7 offset:1024
  ds_read_b128 v[108:111], v7 offset:7168
  ds_read_b128 v[88:91], v7 offset:2048
  v_smfmac_f32_16x16x64_bf16 v[16:19], v[60:63], a[192:199], v3
  v_smfmac_f32_16x16x64_bf16 v[20:23], v[60:63], a[200:207], v3
  v_smfmac_f32_16x16x64_bf16 v[24:27], v[60:63], a[208:215], v3
  v_smfmac_f32_16x16x64_bf16 v[28:31], v[60:63], a[216:223], v3
  s_waitcnt lgkmcnt(6)
  v_smfmac_f32_16x16x64_bf16 v[32:35], v[60:63], v[64:71], v3
  ds_read_b128 v[64:67], v15 offset:16384
  ds_read_b128 v[68:71], v15 offset:17408
  v_smfmac_f32_16x16x64_bf16 v[36:39], v[60:63], a[224:231], v3
  ds_read_b128 v[60:63], v10 offset:1024
  ds_read_b128 v[112:115], v7 offset:8192
  ds_read_b128 v[92:95], v7 offset:3072
  v_smfmac_f32_16x16x64_bf16 v[16:19], v[52:55], a[232:239], v3
  v_smfmac_f32_16x16x64_bf16 v[20:23], v[52:55], a[240:247], v3
  v_smfmac_f32_16x16x64_bf16 v[24:27], v[52:55], a[248:255], v3
  s_waitcnt lgkmcnt(9)
  v_smfmac_f32_16x16x64_bf16 v[28:31], v[52:55], v[72:79], v3
  ds_read_b128 v[72:75], v15 offset:18432
  ds_read_b128 v[76:79], v15 offset:19456
  v_smfmac_f32_16x16x64_bf16 v[32:35], v[52:55], v[128:135], v3
  v_smfmac_f32_16x16x64_bf16 v[36:39], v[52:55], v[136:143], v3
  ds_read_b128 v[52:55], v10 offset:2048
  ds_read_b128 v[116:119], v7 offset:9216
  ds_read_b128 v[96:99], v7 offset:4096
  ds_read_b128 v[120:123], v7 offset:10240
  s_waitcnt lgkmcnt(14)
  v_smfmac_f32_16x16x64_bf16 v[16:19], v[56:59], v[144:151], v3
  v_smfmac_f32_16x16x64_bf16 v[20:23], v[56:59], v[152:159], v3
  s_waitcnt lgkmcnt(9)
  v_smfmac_f32_16x16x64_bf16 v[24:27], v[56:59], v[64:71], v3
  ds_read_b128 v[64:67], v15 offset:20480
  ds_read_b128 v[68:71], v15 offset:21504
  v_smfmac_f32_16x16x64_bf16 v[28:31], v[56:59], v[160:167], v3
  v_smfmac_f32_16x16x64_bf16 v[32:35], v[56:59], v[168:175], v3
  v_smfmac_f32_16x16x64_bf16 v[36:39], v[56:59], v[176:183], v3
  ds_read_b128 v[100:103], v7 offset:5120
  ds_read_b128 v[124:127], v7 offset:11264
  s_waitcnt lgkmcnt(12)
  v_smfmac_f32_16x16x64_bf16 v[16:19], v[60:63], v[184:191], v3
  v_smfmac_f32_16x16x64_bf16 v[28:31], v[60:63], v[200:207], v3
  s_waitcnt lgkmcnt(7)
  s_waitcnt lgkmcnt(2)
  v_smfmac_f32_16x16x64_bf16 v[16:19], v[52:55], v[64:71], v3
  v_smfmac_f32_16x16x64_bf16 v[28:31], v[52:55], v[240:247], v3
  v_smfmac_f32_16x16x64_bf16 v[20:23], v[60:63], v[72:79], v3
  ds_read_b128 v[72:75], v15 offset:22528
  ds_read_b128 v[76:79], v15 offset:23552
  v_smfmac_f32_16x16x64_bf16 v[32:35], v[60:63], v[208:215], v3
  v_add_f32 v16, v16, v17
  v_add_f32 v18, v18, v19
  v_cvt_pk_bf16_f32 v16, v16, v18
  v_smfmac_f32_16x16x64_bf16 v[20:23], v[52:55], v[224:231], v3
  ds_write_b32 v11, v16 offset:0
  v_add_f32 v28, v28, v29
  v_add_f32 v30, v30, v31
  v_smfmac_f32_16x16x64_bf16 v[32:35], v[52:55], v[248:255], v3
  v_cvt_pk_bf16_f32 v28, v28, v30
  ds_write_b32 v11, v28 offset:3072
  v_smfmac_f32_16x16x64_bf16 v[24:27], v[60:63], v[192:199], v3
  v_smfmac_f32_16x16x64_bf16 v[36:39], v[60:63], v[216:223], v3
  v_add_f32 v20, v20, v21
  v_add_f32 v22, v22, v23
  v_cvt_pk_bf16_f32 v20, v20, v22
  v_smfmac_f32_16x16x64_bf16 v[24:27], v[52:55], v[232:239], v3
  ds_write_b32 v11, v20 offset:256
  v_add_f32 v32, v32, v33
  v_add_f32 v34, v34, v35
  s_waitcnt lgkmcnt(3)
  v_smfmac_f32_16x16x64_bf16 v[36:39], v[52:55], v[72:79], v3
  v_cvt_pk_bf16_f32 v32, v32, v34
  ds_write_b32 v11, v32 offset:3328
  v_add_f32 v24, v24, v25
  v_add_f32 v26, v26, v27
  v_cvt_pk_bf16_f32 v24, v24, v26
  ds_write_b32 v11, v24 offset:512
  s_nop 1
  v_add_f32 v36, v36, v37
  v_add_f32 v38, v38, v39
  v_cvt_pk_bf16_f32 v36, v36, v38
  ds_write_b32 v11, v36 offset:3584
  s_branch Lnw0j_33
Lnw0_32:
  s_waitcnt lgkmcnt(6)
  v_smfmac_f32_16x16x64_bf16 v[16:19], v[52:55], a[120:127], v3
  s_waitcnt lgkmcnt(2)
  v_smfmac_f32_16x16x64_bf16 v[20:23], v[52:55], v[72:79], v3
  ds_read_b128 v[72:75], v15 offset:10240
  ds_read_b128 v[76:79], v15 offset:11264
  v_smfmac_f32_16x16x64_bf16 v[24:27], v[52:55], a[128:135], v3
  v_smfmac_f32_16x16x64_bf16 v[28:31], v[52:55], a[136:143], v3
  v_smfmac_f32_16x16x64_bf16 v[32:35], v[52:55], a[144:151], v3
  v_smfmac_f32_16x16x64_bf16 v[36:39], v[52:55], a[152:159], v3
  ds_read_b128 v[52:55], v9 offset:2048
  s_waitcnt lgkmcnt(3)
  v_smfmac_f32_16x16x64_bf16 v[16:19], v[56:59], v[64:71], v3
  ds_read_b128 v[64:67], v15 offset:12288
  ds_read_b128 v[68:71], v15 offset:13312
  v_smfmac_f32_16x16x64_bf16 v[20:23], v[56:59], a[160:167], v3
  v_smfmac_f32_16x16x64_bf16 v[24:27], v[56:59], a[168:175], v3
  v_smfmac_f32_16x16x64_bf16 v[28:31], v[56:59], a[176:183], v3
  v_smfmac_f32_16x16x64_bf16 v[32:35], v[56:59], a[184:191], v3
  s_waitcnt lgkmcnt(3)
  v_smfmac_f32_16x16x64_bf16 v[36:39], v[56:59], v[72:79], v3
  ds_read_b128 v[72:75], v15 offset:14336
  ds_read_b128 v[76:79], v15 offset:15360
  ds_read_b128 v[56:59], v10 offset:0
  v_smfmac_f32_16x16x64_bf16 v[16:19], v[60:63], a[192:199], v3
  v_smfmac_f32_16x16x64_bf16 v[20:23], v[60:63], a[200:207], v3
  v_smfmac_f32_16x16x64_bf16 v[24:27], v[60:63], a[208:215], v3
  v_smfmac_f32_16x16x64_bf16 v[28:31], v[60:63], a[216:223], v3
  s_waitcnt lgkmcnt(3)
  v_smfmac_f32_16x16x64_bf16 v[32:35], v[60:63], v[64:71], v3
  ds_read_b128 v[64:67], v15 offset:16384
  ds_read_b128 v[68:71], v15 offset:17408
  v_smfmac_f32_16x16x64_bf16 v[36:39], v[60:63], a[224:231], v3
  ds_read_b128 v[60:63], v10 offset:1024
  v_smfmac_f32_16x16x64_bf16 v[16:19], v[52:55], a[232:239], v3
  v_smfmac_f32_16x16x64_bf16 v[20:23], v[52:55], a[240:247], v3
  v_smfmac_f32_16x16x64_bf16 v[24:27], v[52:55], a[248:255], v3
  s_waitcnt lgkmcnt(4)
  v_smfmac_f32_16x16x64_bf16 v[28:31], v[52:55], v[72:79], v3
  ds_read_b128 v[72:75], v15 offset:18432
  ds_read_b128 v[76:79], v15 offset:19456
  v_smfmac_f32_16x16x64_bf16 v[32:35], v[52:55], v[128:135], v3
  v_smfmac_f32_16x16x64_bf16 v[36:39], v[52:55], v[136:143], v3
  ds_read_b128 v[52:55], v10 offset:2048
  s_waitcnt lgkmcnt(6)
  v_smfmac_f32_16x16x64_bf16 v[16:19], v[56:59], v[144:151], v3
  v_smfmac_f32_16x16x64_bf16 v[20:23], v[56:59], v[152:159], v3
  s_waitcnt lgkmcnt(4)
  v_smfmac_f32_16x16x64_bf16 v[24:27], v[56:59], v[64:71], v3
  ds_read_b128 v[64:67], v15 offset:20480
  ds_read_b128 v[68:71], v15 offset:21504
  v_smfmac_f32_16x16x64_bf16 v[28:31], v[56:59], v[160:167], v3
  v_smfmac_f32_16x16x64_bf16 v[32:35], v[56:59], v[168:175], v3
  v_smfmac_f32_16x16x64_bf16 v[36:39], v[56:59], v[176:183], v3
  s_waitcnt lgkmcnt(5)
  v_smfmac_f32_16x16x64_bf16 v[16:19], v[60:63], v[184:191], v3
  v_smfmac_f32_16x16x64_bf16 v[28:31], v[60:63], v[200:207], v3
  s_waitcnt lgkmcnt(2)
  s_waitcnt lgkmcnt(0)
  v_smfmac_f32_16x16x64_bf16 v[16:19], v[52:55], v[64:71], v3
  v_smfmac_f32_16x16x64_bf16 v[28:31], v[52:55], v[240:247], v3
  v_smfmac_f32_16x16x64_bf16 v[20:23], v[60:63], v[72:79], v3
  ds_read_b128 v[72:75], v15 offset:22528
  ds_read_b128 v[76:79], v15 offset:23552
  v_smfmac_f32_16x16x64_bf16 v[32:35], v[60:63], v[208:215], v3
  v_add_f32 v16, v16, v17
  v_add_f32 v18, v18, v19
  v_cvt_pk_bf16_f32 v16, v16, v18
  v_smfmac_f32_16x16x64_bf16 v[20:23], v[52:55], v[224:231], v3
  ds_write_b32 v11, v16 offset:0
  v_add_f32 v28, v28, v29
  v_add_f32 v30, v30, v31
  v_smfmac_f32_16x16x64_bf16 v[32:35], v[52:55], v[248:255], v3
  v_cvt_pk_bf16_f32 v28, v28, v30
  ds_write_b32 v11, v28 offset:3072
  v_smfmac_f32_16x16x64_bf16 v[24:27], v[60:63], v[192:199], v3
  v_smfmac_f32_16x16x64_bf16 v[36:39], v[60:63], v[216:223], v3
  v_add_f32 v20, v20, v21
  v_add_f32 v22, v22, v23
  v_cvt_pk_bf16_f32 v20, v20, v22
  v_smfmac_f32_16x16x64_bf16 v[24:27], v[52:55], v[232:239], v3
  ds_write_b32 v11, v20 offset:256
  v_add_f32 v32, v32, v33
  v_add_f32 v34, v34, v35
  s_waitcnt lgkmcnt(3)
  v_smfmac_f32_16x16x64_bf16 v[36:39], v[52:55], v[72:79], v3
  v_cvt_pk_bf16_f32 v32, v32, v34
  ds_write_b32 v11, v32 offset:3328
  v_add_f32 v24, v24, v25
  v_add_f32 v26, v26, v27
  v_cvt_pk_bf16_f32 v24, v24, v26
  ds_write_b32 v11, v24 offset:512
  s_nop 1
  v_add_f32 v36, v36, v37
  v_add_f32 v38, v38, v39
  v_cvt_pk_bf16_f32 v36, v36, v38
  ds_write_b32 v11, v36 offset:3584
Lnw0j_33:
  s_waitcnt lgkmcnt(0)
  s_barrier
  s_cmp_lg_u32 s16, 0
  s_cbranch_scc1 LAw_34
  ds_read_b64_tr_b16 v[16:17], v12 offset:0
  ds_read_b64_tr_b16 v[18:19], v12 offset:256
  ds_read_b64_tr_b16 v[40:41], v12 offset:3072
  ds_read_b64_tr_b16 v[42:43], v12 offset:3328
  ds_read_b64_tr_b16 v[20:21], v12 offset:512
  ds_read_b64_tr_b16 v[22:23], v12 offset:768
  ds_read_b64_tr_b16 v[44:45], v12 offset:3584
  ds_read_b64_tr_b16 v[46:47], v12 offset:3840
  ds_read_b64_tr_b16 v[24:25], v12 offset:1024
  ds_read_b64_tr_b16 v[26:27], v12 offset:1280
  ds_read_b64_tr_b16 v[48:49], v12 offset:4096
  ds_read_b64_tr_b16 v[50:51], v12 offset:4352
  s_waitcnt lgkmcnt(8)
  v_mfma_f32_16x16x32_bf16 v[64:67], v[80:83], v[16:19], 0
  v_mfma_f32_16x16x32_bf16 v[68:71], v[104:107], v[16:19], 0
  v_mfma_f32_16x16x32_bf16 v[72:75], v[40:43], v[16:19], 0
  ds_read_b64_tr_b16 v[28:29], v12 offset:1536
  ds_read_b64_tr_b16 v[30:31], v12 offset:1792
  ds_read_b64_tr_b16 v[52:53], v12 offset:4608
  ds_read_b64_tr_b16 v[54:55], v12 offset:4864
  s_waitcnt lgkmcnt(8)
  v_mfma_f32_16x16x32_bf16 v[64:67], v[84:87], v[20:23], v[64:67]
  v_mfma_f32_16x16x32_bf16 v[68:71], v[108:111], v[20:23], v[68:71]
  v_mfma_f32_16x16x32_bf16 v[72:75], v[44:47], v[20:23], v[72:75]
  ds_read_b64_tr_b16 v[32:33], v12 offset:2048
  ds_read_b64_tr_b16 v[34:35], v12 offset:2304
  ds_read_b64_tr_b16 v[56:57], v12 offset:5120
  ds_read_b64_tr_b16 v[58:59], v12 offset:5376
  s_waitcnt lgkmcnt(8)
  v_mfma_f32_16x16x32_bf16 v[64:67], v[88:91], v[24:27], v[64:67]
  v_mfma_f32_16x16x32_bf16 v[68:71], v[112:115], v[24:27], v[68:71]
  v_mfma_f32_16x16x32_bf16 v[72:75], v[48:51], v[24:27], v[72:75]
  ds_read_b64_tr_b16 v[36:37], v12 offset:2560
  ds_read_b64_tr_b16 v[38:39], v12 offset:2816
  ds_read_b64_tr_b16 v[60:61], v12 offset:5632
  ds_read_b64_tr_b16 v[62:63], v12 offset:5888
  s_waitcnt lgkmcnt(8)
  v_mfma_f32_16x16x32_bf16 v[64:67], v[92:95], v[28:31], v[64:67]
  v_mfma_f32_16x16x32_bf16 v[68:71], v[116:119], v[28:31], v[68:71]
  v_mfma_f32_16x16x32_bf16 v[72:75], v[52:55], v[28:31], v[72:75]
  s_waitcnt lgkmcnt(4)
  v_mfma_f32_16x16x32_bf16 v[64:67], v[96:99], v[32:35], v[64:67]
  v_mfma_f32_16x16x32_bf16 v[68:71], v[120:123], v[32:35], v[68:71]
  v_mfma_f32_16x16x32_bf16 v[72:75], v[56:59], v[32:35], v[72:75]
  s_waitcnt lgkmcnt(0)
  v_mfma_f32_16x16x32_bf16 v[64:67], v[100:103], v[36:39], v[64:67]
  v_mfma_f32_16x16x32_bf16 v[68:71], v[124:127], v[36:39], v[68:71]
  v_mfma_f32_16x16x32_bf16 v[72:75], v[60:63], v[36:39], v[72:75]
  v_mov_b32 v42, 0xff800000
  s_nop 3
  v_cndmask_b32 v76, v64, v68, s[74:75]
  v_cndmask_b32 v77, v65, v69, s[74:75]
  v_cndmask_b32 v78, v66, v70, s[74:75]
  v_cndmask_b32 v79, v67, v71, s[74:75]
  v_cndmask_b32 v40, v72, v74, s[74:75]
  v_cndmask_b32 v40, v40, v42, s[24:25]
  v_cndmask_b32 v41, v73, v75, s[74:75]
  v_cndmask_b32 v41, v41, v42, s[24:25]
  v_max3_f32 v17, v76, v77, v78
  v_max3_f32 v17, v17, v79, v40
  v_max_f32 v17, v17, v41
  s_nop 1
  v_max_f32_dpp v17, v17, v17 row_ror:8 row_mask:0xf bank_mask:0xf
  v_mov_b32 v18, v17
  s_nop 1
  v_permlane16_swap_b32 v17, v18
  v_max_f32 v17, v17, v18
  v_mov_b32 v18, v17
  s_nop 1
  v_permlane32_swap_b32 v17, v18
  v_max_f32 v17, v17, v18
  v_mul_f32 v17, s38, v17
  v_fma_f32 v76, v76, s38, -v17
  v_fma_f32 v77, v77, s38, -v17
  v_fma_f32 v78, v78, s38, -v17
  v_fma_f32 v79, v79, s38, -v17
  v_fma_f32 v40, v40, s38, -v17
  v_fma_f32 v41, v41, s38, -v17
  v_exp_f32 v76, v76
  v_exp_f32 v77, v77
  v_exp_f32 v78, v78
  v_exp_f32 v79, v79
  v_exp_f32 v40, v40
  v_exp_f32 v41, v41
  v_add_f32 v18, v76, v77
  v_add_f32 v19, v78, v79
  v_add_f32 v43, v40, v41
  v_add_f32 v18, v18, v19
  v_add_f32 v18, v18, v43
  s_nop 1
  v_add_f32_dpp v18, v18, v18 row_ror:8 row_mask:0xf bank_mask:0xf
  v_mov_b32 v19, v18
  s_nop 1
  v_permlane16_swap_b32 v18, v19
  v_add_f32 v18, v18, v19
  v_mov_b32 v19, v18
  s_nop 1
  v_permlane32_swap_b32 v18, v19
  v_add_f32 v18, v18, v19
  v_rcp_f32 v18, v18
  s_nop 0
  v_mul_f32 v76, v76, v18
  v_mul_f32 v77, v77, v18
  v_mul_f32 v78, v78, v18
  v_mul_f32 v79, v79, v18
  v_cvt_pk_bf16_f32 v20, v76, v77
  v_cvt_pk_bf16_f32 v22, v78, v79
  v_mul_f32 v40, v40, v18
  v_mul_f32 v41, v41, v18
  v_permlane16_swap_b32 v20, v22
  v_cvt_pk_bf16_f32 v24, v40, v41
  s_nop 0
  v_mov_b32_dpp v21, v20 row_ror:8 row_mask:0xf bank_mask:0xf
  v_mov_b32_dpp v23, v22 row_ror:8 row_mask:0xf bank_mask:0xf
  v_mov_b32 v25, v24
  buffer_store_dwordx4 v[20:23], v13, s[4:7], s27 offen sc1
  s_nop 0
  v_permlane16_swap_b32 v24, v25
  s_nop 1
  v_mov_b32_dpp v26, v24 row_ror:8 row_mask:0xf bank_mask:0xf
  v_mov_b32_dpp v27, v25 row_ror:8 row_mask:0xf bank_mask:0xf
  buffer_store_dwordx4 v[24:27], v14, s[4:7], s27 offen sc1
  s_barrier
  s_branch LAe_35
LAw_34:
  s_cmp_eq_u32 s16, 3
  s_cbranch_scc1 LAw3_36
  s_and_b32 s20, s18, 1
  s_mul_i32 s20, s20, 24576
  s_add_u32 s20, s20, 16384
  s_sub_u32 s21, s16, 1
  s_mul_i32 s21, s21, 6144
  v_add_u32 v7, s20, v2
  s_add_u32 s20, s20, s21
  v_add_u32 v76, s20, v2
  ds_read_b128 v[80:83], v7 offset:12288
  ds_read_b128 v[104:107], v7 offset:18432
  ds_read_b128 v[16:19], v76 offset:0
  ds_read_b64_tr_b16 v[40:41], v12 offset:3072
  ds_read_b64_tr_b16 v[42:43], v12 offset:3328
  ds_read_b128 v[84:87], v7 offset:13312
  ds_read_b128 v[108:111], v7 offset:19456
  ds_read_b128 v[20:23], v76 offset:1024
  ds_read_b64_tr_b16 v[44:45], v12 offset:3584
  ds_read_b64_tr_b16 v[46:47], v12 offset:3840
  ds_read_b128 v[88:91], v7 offset:14336
  ds_read_b128 v[112:115], v7 offset:20480
  ds_read_b128 v[24:27], v76 offset:2048
  ds_read_b64_tr_b16 v[48:49], v12 offset:4096
  ds_read_b64_tr_b16 v[50:51], v12 offset:4352
  s_waitcnt lgkmcnt(10)
  v_mfma_f32_16x16x32_bf16 v[64:67], v[80:83], v[16:19], 0
  v_mfma_f32_16x16x32_bf16 v[68:71], v[104:107], v[16:19], 0
  v_mfma_f32_16x16x32_bf16 v[72:75], v[40:43], v[16:19], 0
  ds_read_b128 v[92:95], v7 offset:15360
  ds_read_b128 v[116:119], v7 offset:21504
  ds_read_b128 v[28:31], v76 offset:3072
  ds_read_b64_tr_b16 v[52:53], v12 offset:4608
  ds_read_b64_tr_b16 v[54:55], v12 offset:4864
  s_waitcnt lgkmcnt(10)
  v_mfma_f32_16x16x32_bf16 v[64:67], v[84:87], v[20:23], v[64:67]
  v_mfma_f32_16x16x32_bf16 v[68:71], v[108:111], v[20:23], v[68:71]
  v_mfma_f32_16x16x32_bf16 v[72:75], v[44:47], v[20:23], v[72:75]
  ds_read_b128 v[96:99], v7 offset:16384
  ds_read_b128 v[120:123], v7 offset:22528
  ds_read_b128 v[32:35], v76 offset:4096
  ds_read_b64_tr_b16 v[56:57], v12 offset:5120
  ds_read_b64_tr_b16 v[58:59], v12 offset:5376
  s_waitcnt lgkmcnt(10)
  v_mfma_f32_16x16x32_bf16 v[64:67], v[88:91], v[24:27], v[64:67]
  v_mfma_f32_16x16x32_bf16 v[68:71], v[112:115], v[24:27], v[68:71]
  v_mfma_f32_16x16x32_bf16 v[72:75], v[48:51], v[24:27], v[72:75]
  ds_read_b128 v[100:103], v7 offset:17408
  ds_read_b128 v[124:127], v7 offset:23552
  ds_read_b128 v[36:39], v76 offset:5120
  ds_read_b64_tr_b16 v[60:61], v12 offset:5632
  ds_read_b64_tr_b16 v[62:63], v12 offset:5888
  s_waitcnt lgkmcnt(10)
  v_mfma_f32_16x16x32_bf16 v[64:67], v[92:95], v[28:31], v[64:67]
  v_mfma_f32_16x16x32_bf16 v[68:71], v[116:119], v[28:31], v[68:71]
  v_mfma_f32_16x16x32_bf16 v[72:75], v[52:55], v[28:31], v[72:75]
  s_waitcnt lgkmcnt(5)
  v_mfma_f32_16x16x32_bf16 v[64:67], v[96:99], v[32:35], v[64:67]
  v_mfma_f32_16x16x32_bf16 v[68:71], v[120:123], v[32:35], v[68:71]
  v_mfma_f32_16x16x32_bf16 v[72:75], v[56:59], v[32:35], v[72:75]
  s_waitcnt lgkmcnt(0)
  v_mfma_f32_16x16x32_bf16 v[64:67], v[100:103], v[36:39], v[64:67]
  v_mfma_f32_16x16x32_bf16 v[68:71], v[124:127], v[36:39], v[68:71]
  v_mfma_f32_16x16x32_bf16 v[72:75], v[60:63], v[36:39], v[72:75]
  v_mov_b32 v76, 0xff800000
  v_lshrrev_b32 v77, 4, v2
  v_and_b32 v78, 15, v77
  v_lshrrev_b32 v77, 4, v77
  v_lshlrev_b32 v77, 2, v77
  v_sub_u32 v77, v78, v77
  s_sub_u32 s21, s16, 1
  s_lshl_b32 s21, s21, 4
  v_add_u32 v77, s21, v77
  v_cmp_le_i32 vcc, 0, v77
  s_nop 1
  v_cndmask_b32 v64, v76, v64, vcc
  v_cmp_le_i32 vcc, 1, v77
  s_nop 1
  v_cndmask_b32 v65, v76, v65, vcc
  v_cmp_le_i32 vcc, 2, v77
  s_nop 1
  v_cndmask_b32 v66, v76, v66, vcc
  v_cmp_le_i32 vcc, 3, v77
  s_nop 1
  v_cndmask_b32 v67, v76, v67, vcc
  v_cmp_le_i32 vcc, 16, v77
  s_nop 1
  v_cndmask_b32 v68, v76, v68, vcc
  v_cmp_le_i32 vcc, 17, v77
  s_nop 1
  v_cndmask_b32 v69, v76, v69, vcc
  v_cmp_le_i32 vcc, 18, v77
  s_nop 1
  v_cndmask_b32 v70, v76, v70, vcc
  v_cmp_le_i32 vcc, 19, v77
  s_nop 1
  v_cndmask_b32 v71, v76, v71, vcc
  v_max3_f32 v17, v64, v65, v66
  v_max3_f32 v17, v17, v67, v68
  v_max3_f32 v17, v17, v69, v70
  v_cndmask_b32 v72, v72, v76, s[24:25]
  v_cndmask_b32 v73, v73, v76, s[24:25]
  v_cndmask_b32 v74, v74, v76, s[24:25]
  v_cndmask_b32 v75, v75, v76, s[24:25]
  v_max3_f32 v17, v17, v71, v72
  v_max3_f32 v17, v17, v73, v74
  v_max_f32 v17, v17, v75
  v_mov_b32 v18, v17
  s_nop 1
  v_permlane16_swap_b32 v17, v18
  v_max_f32 v17, v17, v18
  v_mov_b32 v18, v17
  s_nop 1
  v_permlane32_swap_b32 v17, v18
  v_max_f32 v17, v17, v18
  v_mul_f32 v17, s38, v17
  v_fma_f32 v64, v64, s38, -v17
  v_fma_f32 v65, v65, s38, -v17
  v_fma_f32 v66, v66, s38, -v17
  v_fma_f32 v67, v67, s38, -v17
  v_fma_f32 v68, v68, s38, -v17
  v_fma_f32 v69, v69, s38, -v17
  v_fma_f32 v70, v70, s38, -v17
  v_fma_f32 v71, v71, s38, -v17
  v_fma_f32 v72, v72, s38, -v17
  v_fma_f32 v73, v73, s38, -v17
  v_fma_f32 v74, v74, s38, -v17
  v_fma_f32 v75, v75, s38, -v17
  v_exp_f32 v64, v64
  v_exp_f32 v65, v65
  v_exp_f32 v66, v66
  v_exp_f32 v67, v67
  v_exp_f32 v68, v68
  v_exp_f32 v69, v69
  v_exp_f32 v70, v70
  v_exp_f32 v71, v71
  v_exp_f32 v72, v72
  v_exp_f32 v73, v73
  v_exp_f32 v74, v74
  v_exp_f32 v75, v75
  v_add_f32 v18, v64, v65
  v_add_f32 v19, v66, v67
  v_add_f32 v18, v18, v68
  v_add_f32 v19, v19, v69
  v_add_f32 v18, v18, v70
  v_add_f32 v19, v19, v71
  v_add_f32 v18, v18, v72
  v_add_f32 v19, v19, v73
  v_add_f32 v18, v18, v74
  v_add_f32 v19, v19, v75
  v_add_f32 v18, v18, v19
  v_mov_b32 v19, v18
  s_nop 1
  v_permlane16_swap_b32 v18, v19
  v_add_f32 v18, v18, v19
  v_mov_b32 v19, v18
  s_nop 1
  v_permlane32_swap_b32 v18, v19
  v_add_f32 v18, v18, v19
  v_rcp_f32 v18, v18
  s_nop 0
  v_mul_f32 v64, v64, v18
  v_mul_f32 v65, v65, v18
  v_mul_f32 v66, v66, v18
  v_mul_f32 v67, v67, v18
  v_mul_f32 v68, v68, v18
  v_mul_f32 v69, v69, v18
  v_mul_f32 v70, v70, v18
  v_mul_f32 v71, v71, v18
  v_mul_f32 v72, v72, v18
  v_mul_f32 v73, v73, v18
  v_mul_f32 v74, v74, v18
  v_mul_f32 v75, v75, v18
  v_cvt_pk_bf16_f32 v20, v64, v65
  v_cvt_pk_bf16_f32 v21, v66, v67
  v_cvt_pk_bf16_f32 v22, v68, v69
  v_cvt_pk_bf16_f32 v23, v70, v71
  v_cvt_pk_bf16_f32 v24, v72, v73
  v_cvt_pk_bf16_f32 v25, v74, v75
  s_and_b32 s20, s18, 3
  s_mul_i32 s20, s20, 163840
  s_add_u32 s20, s20, s43
  s_add_u32 s20, s20, 376832
  s_sub_u32 s21, s16, 1
  s_lshl_b32 s22, s21, 2
  s_lshr_b32 s23, s17, 3
  s_add_u32 s22, s22, s23
  s_lshl_b32 s22, s22, 14
  s_and_b32 s23, s17, 7
  s_lshl_b32 s23, s23, 10
  s_add_u32 s22, s22, s23
  s_add_u32 s22, s22, s20
  buffer_store_dwordx4 v[20:23], v2, s[4:7], s22 offen sc1
  v_mov_b32 v26, v24
  v_mov_b32 v27, v25
  s_nop 0
  v_permlane16_swap_b32 v24, v26
  v_permlane16_swap_b32 v25, v27
  s_add_u32 s21, s21, 8
  s_lshl_b32 s21, s21, 14
  s_add_u32 s20, s20, s21
  s_lshl_b32 s23, s17, 8
  s_add_u32 s20, s20, s23
  v_mov_b32 v42, 0x7ff00000
  v_cmp_gt_u32 vcc, 256, v2
  s_nop 1
  v_cndmask_b32 v42, v42, v2, vcc
  buffer_store_dwordx4 v[24:27], v42, s[4:7], s20 offen sc1
  s_barrier
  s_waitcnt vmcnt(0)
  v_mov_b32 v20, 0x7ff00000
  v_mov_b32 v22, 0
  v_cmp_eq_u32 vcc, 0, v2
  s_nop 1
  v_cndmask_b32 v20, v20, v22, vcc
  s_add_u32 s20, s18, 1
  v_mov_b32 v21, s20
  s_lshl_b32 s21, s17, 1
  s_add_u32 s21, s21, s16
  s_sub_u32 s21, s21, 1
  s_lshl_b32 s21, s21, 7
  s_add_u32 s21, s21, 327680
  s_add_u32 s21, s21, s43
  buffer_store_dword v21, v20, s[4:7], s21 offen sc1
  s_branch LAe_35
LAw3_36:
  s_add_u32 s20, s18, 3
  s_and_b32 s20, s20, 3
  s_mul_i32 s20, s20, 49152
  s_add_u32 s20, s20, s43
  s_add_u32 s20, s20, 131072
  s_add_u32 s21, s20, 98304
  v_mov_b32 v16, -1
  v_mov_b32 v17, -1
  v_mov_b32 v18, -1
  v_mov_b32 v19, -1
  s_barrier
  buffer_store_dwordx4 v[16:19], v13, s[4:7], s20 offen sc1
  buffer_store_dwordx4 v[16:19], v14, s[4:7], s20 offen sc1
  s_cmp_ge_u32 s18, 63
  s_cbranch_scc1 LAe_35
  s_add_u32 s29, s29, 786432
  s_add_u32 s23, s18, 2
  v_cmp_gt_u32 vcc, s23, v1
  s_cbranch_vccz LAok_37
  s_mov_b32 s22, 0
Lwf_38:
  buffer_load_dword v7, v0, s[4:7], s22 offen sc1
  s_waitcnt vmcnt(0)
  v_cmp_gt_u32 vcc, s23, v7
  s_cbranch_vccz Lwfd_39
  s_sleep 2
  s_cmp_eq_u32 s19, 0
  s_cbranch_scc1 Lwfd_39
  s_sub_u32 s19, s19, 1
  s_branch Lwf_38
Lwfd_39:
LAok_37:
  s_add_u32 s23, s18, 1
  s_and_b32 s23, s23, 1
  s_mul_i32 s23, s23, 24576
  s_add_u32 s23, s23, 16384
  s_mov_b32 s21, s29
  s_add_u32 s20, s23, 0
  s_mov_b32 m0, s20
  s_nop 0
  buffer_load_dwordx4 v2, s[4:7], s21 offen sc1 lds
  s_add_u32 s21, s21, 1024
  s_add_u32 s20, s23, 1024
  s_mov_b32 m0, s20
  s_nop 0
  buffer_load_dwordx4 v2, s[4:7], s21 offen sc1 lds
  s_add_u32 s21, s21, 1024
  s_add_u32 s20, s23, 2048
  s_mov_b32 m0, s20
  s_nop 0
  buffer_load_dwordx4 v2, s[4:7], s21 offen sc1 lds
  s_add_u32 s21, s21, 1024
  s_add_u32 s20, s23, 3072
  s_mov_b32 m0, s20
  s_nop 0
  buffer_load_dwordx4 v2, s[4:7], s21 offen sc1 lds
  s_add_u32 s21, s21, 1024
  s_add_u32 s20, s23, 4096
  s_mov_b32 m0, s20
  s_nop 0
  buffer_load_dwordx4 v2, s[4:7], s21 offen sc1 lds
  s_add_u32 s21, s21, 1024
  s_add_u32 s20, s23, 5120
  s_mov_b32 m0, s20
  s_nop 0
  buffer_load_dwordx4 v2, s[4:7], s21 offen sc1 lds
  s_add_u32 s21, s21, 1024
  s_add_u32 s20, s23, 6144
  s_mov_b32 m0, s20
  s_nop 0
  buffer_load_dwordx4 v2, s[4:7], s21 offen sc1 lds
  s_add_u32 s21, s21, 1024
  s_add_u32 s20, s23, 7168
  s_mov_b32 m0, s20
  s_nop 0
  buffer_load_dwordx4 v2, s[4:7], s21 offen sc1 lds
  s_add_u32 s21, s21, 1024
  s_add_u32 s20, s23, 8192
  s_mov_b32 m0, s20
  s_nop 0
  buffer_load_dwordx4 v2, s[4:7], s21 offen sc1 lds
  s_add_u32 s21, s21, 1024
  s_add_u32 s20, s23, 9216
  s_mov_b32 m0, s20
  s_nop 0
  buffer_load_dwordx4 v2, s[4:7], s21 offen sc1 lds
  s_add_u32 s21, s21, 1024
  s_add_u32 s20, s23, 10240
  s_mov_b32 m0, s20
  s_nop 0
  buffer_load_dwordx4 v2, s[4:7], s21 offen sc1 lds
  s_add_u32 s21, s21, 1024
  s_add_u32 s20, s23, 11264
  s_mov_b32 m0, s20
  s_nop 0
  buffer_load_dwordx4 v2, s[4:7], s21 offen sc1 lds
  s_add_u32 s21, s21, 1024
  s_add_u32 s20, s23, 12288
  s_mov_b32 m0, s20
  s_nop 0
  buffer_load_dwordx4 v2, s[4:7], s21 offen sc1 lds
  s_add_u32 s21, s21, 1024
  s_add_u32 s20, s23, 13312
  s_mov_b32 m0, s20
  s_nop 0
  buffer_load_dwordx4 v2, s[4:7], s21 offen sc1 lds
  s_add_u32 s21, s21, 1024
  s_add_u32 s20, s23, 14336
  s_mov_b32 m0, s20
  s_nop 0
  buffer_load_dwordx4 v2, s[4:7], s21 offen sc1 lds
  s_add_u32 s21, s21, 1024
  s_add_u32 s20, s23, 15360
  s_mov_b32 m0, s20
  s_nop 0
  buffer_load_dwordx4 v2, s[4:7], s21 offen sc1 lds
  s_add_u32 s21, s21, 1024
  s_add_u32 s20, s23, 16384
  s_mov_b32 m0, s20
  s_nop 0
  buffer_load_dwordx4 v2, s[4:7], s21 offen sc1 lds
  s_add_u32 s21, s21, 1024
  s_add_u32 s20, s23, 17408
  s_mov_b32 m0, s20
  s_nop 0
  buffer_load_dwordx4 v2, s[4:7], s21 offen sc1 lds
  s_add_u32 s21, s21, 1024
  s_add_u32 s20, s23, 18432
  s_mov_b32 m0, s20
  s_nop 0
  buffer_load_dwordx4 v2, s[4:7], s21 offen sc1 lds
  s_add_u32 s21, s21, 1024
  s_add_u32 s20, s23, 19456
  s_mov_b32 m0, s20
  s_nop 0
  buffer_load_dwordx4 v2, s[4:7], s21 offen sc1 lds
  s_add_u32 s21, s21, 1024
  s_add_u32 s20, s23, 20480
  s_mov_b32 m0, s20
  s_nop 0
  buffer_load_dwordx4 v2, s[4:7], s21 offen sc1 lds
  s_add_u32 s21, s21, 1024
  s_add_u32 s20, s23, 21504
  s_mov_b32 m0, s20
  s_nop 0
  buffer_load_dwordx4 v2, s[4:7], s21 offen sc1 lds
  s_add_u32 s21, s21, 1024
  s_add_u32 s20, s23, 22528
  s_mov_b32 m0, s20
  s_nop 0
  buffer_load_dwordx4 v2, s[4:7], s21 offen sc1 lds
  s_add_u32 s21, s21, 1024
  s_add_u32 s20, s23, 23552
  s_mov_b32 m0, s20
  s_nop 0
  buffer_load_dwordx4 v2, s[4:7], s21 offen sc1 lds
LAe_35:
  s_lshl_b32 s21, s16, 2
  s_add_u32 s21, s21, 10240
  v_mov_b32 v40, s21
  v_mov_b32 v41, s63
  ds_write_b32 v40, v41
  s_add_u32 s18, s18, 1
  s_cmp_lt_u32 s18, s31
  s_cbranch_scc1 LAloop_29
  s_branch L_end
L_goB:
  s_load_dwordx2 s[8:9], s[0:1], 32
  s_mov_b32 s10, 0x780000
  s_mov_b32 s11, 0x00020000
  s_load_dwordx2 s[12:13], s[0:1], 40
  s_mov_b32 s14, 0x780000
  s_mov_b32 s15, 0x00020000
  v_lshrrev_b32 v3, 6, v0
  v_and_b32 v1, 63, v0
  v_readfirstlane_b32 s16, v3
  v_lshlrev_b32 v2, 4, v1
  s_mov_b32 s19, 400000
  s_waitcnt lgkmcnt(0)
  s_nop 0
  s_mul_i32 s20, s16, 3
  s_add_u32 s21, s20, 0
  s_sub_u32 s22, s21, 10
  s_cmp_ge_u32 s21, 10
  s_cselect_b32 s21, s22, s21
  s_lshl_b32 s21, s21, 10
  s_add_u32 s22, s21, 8192
  s_cmp_ge_u32 s21, 8192
  s_cselect_b32 s21, s22, s21
  v_add_u32 v4, s21, v2
  s_add_u32 s21, s20, 1
  s_sub_u32 s22, s21, 10
  s_cmp_ge_u32 s21, 10
  s_cselect_b32 s21, s22, s21
  s_lshl_b32 s21, s21, 10
  s_add_u32 s22, s21, 8192
  s_cmp_ge_u32 s21, 8192
  s_cselect_b32 s21, s22, s21
  v_add_u32 v5, s21, v2
  s_add_u32 s21, s20, 2
  s_sub_u32 s22, s21, 10
  s_cmp_ge_u32 s21, 10
  s_cselect_b32 s21, s22, s21
  s_lshl_b32 s21, s21, 10
  s_add_u32 s22, s21, 8192
  s_cmp_ge_u32 s21, 8192
  s_cselect_b32 s21, s22, s21
  v_add_u32 v6, s21, v2
  s_add_u32 s21, s20, 3
  s_sub_u32 s22, s21, 10
  s_cmp_ge_u32 s21, 10
  s_cselect_b32 s21, s22, s21
  s_lshl_b32 s21, s21, 10
  s_add_u32 s21, s21, 0
  v_add_u32 v8, s21, v2
  s_add_u32 s21, s20, 4
  s_sub_u32 s22, s21, 10
  s_cmp_ge_u32 s21, 10
  s_cselect_b32 s21, s22, s21
  s_lshl_b32 s21, s21, 10
  s_add_u32 s21, s21, 0
  v_add_u32 v9, s21, v2
  s_add_u32 s21, s20, 7
  s_sub_u32 s22, s21, 10
  s_cmp_ge_u32 s21, 10
  s_cselect_b32 s21, s22, s21
  s_lshl_b32 s21, s21, 10
  s_add_u32 s21, s21, 0
  v_add_u32 v10, s21, v2
  v_and_b32 v3, 1, v1
  v_cmp_eq_u32 vcc, 0, v3
  v_mov_b32 v3, 0xeeeeeeee
  v_mov_b32 v7, 0x44444444
  v_cndmask_b32 v3, v3, v7, vcc
  s_mul_i32 s20, s16, 24576
  s_add_u32 s20, s20, 65536
  v_add_u32 v15, s20, v2
  s_lshl_b32 s34, s16, 14
  v_add_u32 v83, 0, v1
  s_mov_b32 s20, 174763
  v_mul_lo_u32 v84, v83, s20
  v_lshrrev_b32 v84, 20, v84
  v_mul_u32_u24 v80, 6, v84
  v_sub_u32 v80, v83, v80
  v_lshlrev_b32 v80, 4, v80
  s_mov_b32 s20, 12288
  v_mul_lo_u32 v84, v84, s20
  v_add_u32 v80, v80, v84
  v_add_u32 v83, 64, v1
  s_mov_b32 s20, 174763
  v_mul_lo_u32 v84, v83, s20
  v_lshrrev_b32 v84, 20, v84
  v_mul_u32_u24 v81, 6, v84
  v_sub_u32 v81, v83, v81
  v_lshlrev_b32 v81, 4, v81
  s_mov_b32 s20, 12288
  v_mul_lo_u32 v84, v84, s20
  v_add_u32 v81, v81, v84
  v_add_u32 v83, 128, v1
  s_mov_b32 s20, 174763
  v_mul_lo_u32 v84, v83, s20
  v_lshrrev_b32 v84, 20, v84
  v_mul_u32_u24 v82, 6, v84
  v_sub_u32 v82, v83, v82
  v_lshlrev_b32 v82, 4, v82
  s_mov_b32 s20, 12288
  v_mul_lo_u32 v84, v84, s20
  v_add_u32 v82, v82, v84
  v_lshrrev_b32 v83, 4, v1
  v_lshlrev_b32 v83, 3, v83
  v_bfe_u32 v84, v1, 2, 2
  v_add_u32 v83, v83, v84
  v_and_b32 v84, 3, v1
  v_lshlrev_b32 v84, 3, v84
  v_mul_u32_u24 v85, 96, v83
  v_add_u32 v85, v85, v84
  v_add_u32 v85, s34, v85
  v_mul_u32_u24 v86, 160, v83
  v_add_u32 v86, v86, v84
  v_add_u32 v86, s34, v86
  s_mul_i32 s35, s17, 384
  s_mul_i32 s20, s16, 96
  s_add_u32 s35, s35, s20
  s_mul_i32 s36, s16, 3
  s_sleep 100
  s_add_u32 s20, s36, 0
  s_sub_u32 s22, s20, 10
  s_cmp_ge_u32 s20, 10
  s_cselect_b32 s20, s22, s20
  s_mul_i32 s20, s20, 786432
  s_add_u32 s20, s20, s35
  s_add_u32 s21, s34, 0
  s_mov_b32 m0, s21
  s_nop 0
  buffer_load_dwordx4 v80, s[8:11], s20 offen lds
  s_add_u32 s21, s34, 1024
  s_mov_b32 m0, s21
  s_nop 0
  buffer_load_dwordx4 v81, s[8:11], s20 offen lds
  s_add_u32 s21, s34, 2048
  s_mov_b32 m0, s21
  s_nop 0
  buffer_load_dwordx4 v82, s[8:11], s20 offen lds
  s_add_u32 s20, s36, 0
  s_sub_u32 s22, s20, 10
  s_cmp_ge_u32 s20, 10
  s_cselect_b32 s20, s22, s20
  s_mul_i32 s20, s20, 786432
  s_add_u32 s20, s20, s35
  s_add_u32 s20, s20, 393216
  s_add_u32 s21, s34, 3072
  s_mov_b32 m0, s21
  s_nop 0
  buffer_load_dwordx4 v80, s[8:11], s20 offen lds
  s_add_u32 s21, s34, 4096
  s_mov_b32 m0, s21
  s_nop 0
  buffer_load_dwordx4 v81, s[8:11], s20 offen lds
  s_add_u32 s21, s34, 5120
  s_mov_b32 m0, s21
  s_nop 0
  buffer_load_dwordx4 v82, s[8:11], s20 offen lds
  s_add_u32 s20, s36, 1
  s_sub_u32 s22, s20, 10
  s_cmp_ge_u32 s20, 10
  s_cselect_b32 s20, s22, s20
  s_mul_i32 s20, s20, 786432
  s_add_u32 s20, s20, s35
  s_add_u32 s21, s34, 6144
  s_mov_b32 m0, s21
  s_nop 0
  buffer_load_dwordx4 v80, s[8:11], s20 offen lds
  s_add_u32 s21, s34, 7168
  s_mov_b32 m0, s21
  s_nop 0
  buffer_load_dwordx4 v81, s[8:11], s20 offen lds
  s_add_u32 s21, s34, 8192
  s_mov_b32 m0, s21
  s_nop 0
  buffer_load_dwordx4 v82, s[8:11], s20 offen lds
  s_add_u32 s20, s36, 1
  s_sub_u32 s22, s20, 10
  s_cmp_ge_u32 s20, 10
  s_cselect_b32 s20, s22, s20
  s_mul_i32 s20, s20, 786432
  s_add_u32 s20, s20, s35
  s_add_u32 s20, s20, 393216
  s_add_u32 s21, s34, 9216
  s_mov_b32 m0, s21
  s_nop 0
  buffer_load_dwordx4 v80, s[8:11], s20 offen lds
  s_add_u32 s21, s34, 10240
  s_mov_b32 m0, s21
  s_nop 0
  buffer_load_dwordx4 v81, s[8:11], s20 offen lds
  s_add_u32 s21, s34, 11264
  s_mov_b32 m0, s21
  s_nop 0
  buffer_load_dwordx4 v82, s[8:11], s20 offen lds
  s_waitcnt vmcnt(9)
  ds_read_b64_tr_b16 a[0:1], v85 offset:0
  ds_read_b64_tr_b16 a[2:3], v85 offset:384
  ds_read_b64_tr_b16 a[8:9], v85 offset:32
  ds_read_b64_tr_b16 a[10:11], v85 offset:416
  ds_read_b64_tr_b16 a[16:17], v85 offset:64
  ds_read_b64_tr_b16 a[18:19], v85 offset:448
  s_waitcnt lgkmcnt(0)
  s_add_u32 s20, s36, 2
  s_sub_u32 s22, s20, 10
  s_cmp_ge_u32 s20, 10
  s_cselect_b32 s20, s22, s20
  s_mul_i32 s20, s20, 786432
  s_add_u32 s20, s20, s35
  s_add_u32 s21, s34, 12288
  s_mov_b32 m0, s21
  s_nop 0
  buffer_load_dwordx4 v80, s[8:11], s20 offen lds
  s_add_u32 s21, s34, 13312
  s_mov_b32 m0, s21
  s_nop 0
  buffer_load_dwordx4 v81, s[8:11], s20 offen lds
  s_add_u32 s21, s34, 14336
  s_mov_b32 m0, s21
  s_nop 0
  buffer_load_dwordx4 v82, s[8:11], s20 offen lds
  s_waitcnt vmcnt(9)
  ds_read_b64_tr_b16 a[4:5], v85 offset:3072
  ds_read_b64_tr_b16 a[6:7], v85 offset:3456
  ds_read_b64_tr_b16 a[12:13], v85 offset:3104
  ds_read_b64_tr_b16 a[14:15], v85 offset:3488
  ds_read_b64_tr_b16 a[20:21], v85 offset:3136
  ds_read_b64_tr_b16 a[22:23], v85 offset:3520
  s_waitcnt lgkmcnt(0)
  s_add_u32 s20, s36, 2
  s_sub_u32 s22, s20, 10
  s_cmp_ge_u32 s20, 10
  s_cselect_b32 s20, s22, s20
  s_mul_i32 s20, s20, 786432
  s_add_u32 s20, s20, s35
  s_add_u32 s20, s20, 393216
  s_add_u32 s21, s34, 0
  s_mov_b32 m0, s21
  s_nop 0
  buffer_load_dwordx4 v80, s[8:11], s20 offen lds
  s_add_u32 s21, s34, 1024
  s_mov_b32 m0, s21
  s_nop 0
  buffer_load_dwordx4 v81, s[8:11], s20 offen lds
  s_add_u32 s21, s34, 2048
  s_mov_b32 m0, s21
  s_nop 0
  buffer_load_dwordx4 v82, s[8:11], s20 offen lds
  s_waitcnt vmcnt(9)
  ds_read_b64_tr_b16 a[24:25], v85 offset:6144
  ds_read_b64_tr_b16 a[26:27], v85 offset:6528
  ds_read_b64_tr_b16 v[88:89], v85 offset:6176
  ds_read_b64_tr_b16 v[90:91], v85 offset:6560
  ds_read_b64_tr_b16 a[32:33], v85 offset:6208
  ds_read_b64_tr_b16 a[34:35], v85 offset:6592
  s_waitcnt lgkmcnt(0)
  ds_write_b128 v15, v[88:91] offset:0
  s_add_u32 s20, s36, 3
  s_sub_u32 s22, s20, 10
  s_cmp_ge_u32 s20, 10
  s_cselect_b32 s20, s22, s20
  s_mul_i32 s20, s20, 786432
  s_add_u32 s20, s20, s35
  s_add_u32 s21, s34, 3072
  s_mov_b32 m0, s21
  s_nop 0
  buffer_load_dwordx4 v80, s[8:11], s20 offen lds
  s_add_u32 s21, s34, 4096
  s_mov_b32 m0, s21
  s_nop 0
  buffer_load_dwordx4 v81, s[8:11], s20 offen lds
  s_add_u32 s21, s34, 5120
  s_mov_b32 m0, s21
  s_nop 0
  buffer_load_dwordx4 v82, s[8:11], s20 offen lds
  s_waitcnt vmcnt(9)
  ds_read_b64_tr_b16 a[28:29], v85 offset:9216
  ds_read_b64_tr_b16 a[30:31], v85 offset:9600
  ds_read_b64_tr_b16 v[88:89], v85 offset:9248
  ds_read_b64_tr_b16 v[90:91], v85 offset:9632
  ds_read_b64_tr_b16 a[36:37], v85 offset:9280
  ds_read_b64_tr_b16 a[38:39], v85 offset:9664
  s_waitcnt lgkmcnt(0)
  ds_write_b128 v15, v[88:91] offset:1024
  s_add_u32 s20, s36, 3
  s_sub_u32 s22, s20, 10
  s_cmp_ge_u32 s20, 10
  s_cselect_b32 s20, s22, s20
  s_mul_i32 s20, s20, 786432
  s_add_u32 s20, s20, s35
  s_add_u32 s20, s20, 393216
  s_add_u32 s21, s34, 6144
  s_mov_b32 m0, s21
  s_nop 0
  buffer_load_dwordx4 v80, s[8:11], s20 offen lds
  s_add_u32 s21, s34, 7168
  s_mov_b32 m0, s21
  s_nop 0
  buffer_load_dwordx4 v81, s[8:11], s20 offen lds
  s_add_u32 s21, s34, 8192
  s_mov_b32 m0, s21
  s_nop 0
  buffer_load_dwordx4 v82, s[8:11], s20 offen lds
  s_waitcnt vmcnt(9)
  ds_read_b64_tr_b16 a[40:41], v85 offset:12288
  ds_read_b64_tr_b16 a[42:43], v85 offset:12672
  ds_read_b64_tr_b16 a[48:49], v85 offset:12320
  ds_read_b64_tr_b16 a[50:51], v85 offset:12704
  ds_read_b64_tr_b16 a[56:57], v85 offset:12352
  ds_read_b64_tr_b16 a[58:59], v85 offset:12736
  s_waitcnt lgkmcnt(0)
  s_add_u32 s20, s36, 4
  s_sub_u32 s22, s20, 10
  s_cmp_ge_u32 s20, 10
  s_cselect_b32 s20, s22, s20
  s_mul_i32 s20, s20, 786432
  s_add_u32 s20, s20, s35
  s_add_u32 s21, s34, 9216
  s_mov_b32 m0, s21
  s_nop 0
  buffer_load_dwordx4 v80, s[8:11], s20 offen lds
  s_add_u32 s21, s34, 10240
  s_mov_b32 m0, s21
  s_nop 0
  buffer_load_dwordx4 v81, s[8:11], s20 offen lds
  s_add_u32 s21, s34, 11264
  s_mov_b32 m0, s21
  s_nop 0
  buffer_load_dwordx4 v82, s[8:11], s20 offen lds
  s_waitcnt vmcnt(9)
  ds_read_b64_tr_b16 a[44:45], v85 offset:0
  ds_read_b64_tr_b16 a[46:47], v85 offset:384
  ds_read_b64_tr_b16 a[52:53], v85 offset:32
  ds_read_b64_tr_b16 a[54:55], v85 offset:416
  ds_read_b64_tr_b16 a[60:61], v85 offset:64
  ds_read_b64_tr_b16 a[62:63], v85 offset:448
  s_waitcnt lgkmcnt(0)
  s_add_u32 s20, s36, 4
  s_sub_u32 s22, s20, 10
  s_cmp_ge_u32 s20, 10
  s_cselect_b32 s20, s22, s20
  s_mul_i32 s20, s20, 786432
  s_add_u32 s20, s20, s35
  s_add_u32 s20, s20, 393216
  s_add_u32 s21, s34, 12288
  s_mov_b32 m0, s21
  s_nop 0
  buffer_load_dwordx4 v80, s[8:11], s20 offen lds
  s_add_u32 s21, s34, 13312
  s_mov_b32 m0, s21
  s_nop 0
  buffer_load_dwordx4 v81, s[8:11], s20 offen lds
  s_add_u32 s21, s34, 14336
  s_mov_b32 m0, s21
  s_nop 0
  buffer_load_dwordx4 v82, s[8:11], s20 offen lds
  s_waitcnt vmcnt(9)
  ds_read_b64_tr_b16 v[88:89], v85 offset:3072
  ds_read_b64_tr_b16 v[90:91], v85 offset:3456
  ds_read_b64_tr_b16 a[64:65], v85 offset:3104
  ds_read_b64_tr_b16 a[66:67], v85 offset:3488
  ds_read_b64_tr_b16 a[72:73], v85 offset:3136
  ds_read_b64_tr_b16 a[74:75], v85 offset:3520
  s_waitcnt lgkmcnt(0)
  ds_write_b128 v15, v[88:91] offset:2048
  s_add_u32 s20, s36, 5
  s_sub_u32 s22, s20, 10
  s_cmp_ge_u32 s20, 10
  s_cselect_b32 s20, s22, s20
  s_mul_i32 s20, s20, 786432
  s_add_u32 s20, s20, s35
  s_add_u32 s21, s34, 0
  s_mov_b32 m0, s21
  s_nop 0
  buffer_load_dwordx4 v80, s[8:11], s20 offen lds
  s_add_u32 s21, s34, 1024
  s_mov_b32 m0, s21
  s_nop 0
  buffer_load_dwordx4 v81, s[8:11], s20 offen lds
  s_add_u32 s21, s34, 2048
  s_mov_b32 m0, s21
  s_nop 0
  buffer_load_dwordx4 v82, s[8:11], s20 offen lds
  s_waitcnt vmcnt(9)
  ds_read_b64_tr_b16 v[88:89], v85 offset:6144
  ds_read_b64_tr_b16 v[90:91], v85 offset:6528
  ds_read_b64_tr_b16 a[68:69], v85 offset:6176
  ds_read_b64_tr_b16 a[70:71], v85 offset:6560
  ds_read_b64_tr_b16 a[76:77], v85 offset:6208
  ds_read_b64_tr_b16 a[78:79], v85 offset:6592
  s_waitcnt lgkmcnt(0)
  ds_write_b128 v15, v[88:91] offset:3072
  s_add_u32 s20, s36, 5
  s_sub_u32 s22, s20, 10
  s_cmp_ge_u32 s20, 10
  s_cselect_b32 s20, s22, s20
  s_mul_i32 s20, s20, 786432
  s_add_u32 s20, s20, s35
  s_add_u32 s20, s20, 393216
  s_add_u32 s21, s34, 3072
  s_mov_b32 m0, s21
  s_nop 0
  buffer_load_dwordx4 v80, s[8:11], s20 offen lds
  s_add_u32 s21, s34, 4096
  s_mov_b32 m0, s21
  s_nop 0
  buffer_load_dwordx4 v81, s[8:11], s20 offen lds
  s_add_u32 s21, s34, 5120
  s_mov_b32 m0, s21
  s_nop 0
  buffer_load_dwordx4 v82, s[8:11], s20 offen lds
  s_waitcnt vmcnt(9)
  ds_read_b64_tr_b16 a[80:81], v85 offset:9216
  ds_read_b64_tr_b16 a[82:83], v85 offset:9600
  ds_read_b64_tr_b16 a[88:89], v85 offset:9248
  ds_read_b64_tr_b16 a[90:91], v85 offset:9632
  ds_read_b64_tr_b16 v[88:89], v85 offset:9280
  ds_read_b64_tr_b16 v[90:91], v85 offset:9664
  s_waitcnt lgkmcnt(0)
  ds_write_b128 v15, v[88:91] offset:4096
  s_add_u32 s20, s36, 6
  s_sub_u32 s22, s20, 10
  s_cmp_ge_u32 s20, 10
  s_cselect_b32 s20, s22, s20
  s_mul_i32 s20, s20, 786432
  s_add_u32 s20, s20, s35
  s_add_u32 s21, s34, 6144
  s_mov_b32 m0, s21
  s_nop 0
  buffer_load_dwordx4 v80, s[8:11], s20 offen lds
  s_add_u32 s21, s34, 7168
  s_mov_b32 m0, s21
  s_nop 0
  buffer_load_dwordx4 v81, s[8:11], s20 offen lds
  s_add_u32 s21, s34, 8192
  s_mov_b32 m0, s21
  s_nop 0
  buffer_load_dwordx4 v82, s[8:11], s20 offen lds
  s_waitcnt vmcnt(9)
  ds_read_b64_tr_b16 a[84:85], v85 offset:12288
  ds_read_b64_tr_b16 a[86:87], v85 offset:12672
  ds_read_b64_tr_b16 a[92:93], v85 offset:12320
  ds_read_b64_tr_b16 a[94:95], v85 offset:12704
  ds_read_b64_tr_b16 v[88:89], v85 offset:12352
  ds_read_b64_tr_b16 v[90:91], v85 offset:12736
  s_waitcnt lgkmcnt(0)
  ds_write_b128 v15, v[88:91] offset:5120
  s_add_u32 s20, s36, 6
  s_sub_u32 s22, s20, 10
  s_cmp_ge_u32 s20, 10
  s_cselect_b32 s20, s22, s20
  s_mul_i32 s20, s20, 786432
  s_add_u32 s20, s20, s35
  s_add_u32 s20, s20, 393216
  s_add_u32 s21, s34, 9216
  s_mov_b32 m0, s21
  s_nop 0
  buffer_load_dwordx4 v80, s[8:11], s20 offen lds
  s_add_u32 s21, s34, 10240
  s_mov_b32 m0, s21
  s_nop 0
  buffer_load_dwordx4 v81, s[8:11], s20 offen lds
  s_add_u32 s21, s34, 11264
  s_mov_b32 m0, s21
  s_nop 0
  buffer_load_dwordx4 v82, s[8:11], s20 offen lds
  s_waitcnt vmcnt(9)
  ds_read_b64_tr_b16 a[96:97], v85 offset:0
  ds_read_b64_tr_b16 a[98:99], v85 offset:384
  ds_read_b64_tr_b16 a[104:105], v85 offset:32
  ds_read_b64_tr_b16 a[106:107], v85 offset:416
  ds_read_b64_tr_b16 a[112:113], v85 offset:64
  ds_read_b64_tr_b16 a[114:115], v85 offset:448
  s_waitcnt lgkmcnt(0)
  s_add_u32 s20, s36, 7
  s_sub_u32 s22, s20, 10
  s_cmp_ge_u32 s20, 10
  s_cselect_b32 s20, s22, s20
  s_mul_i32 s20, s20, 786432
  s_add_u32 s20, s20, s35
  s_add_u32 s21, s34, 12288
  s_mov_b32 m0, s21
  s_nop 0
  buffer_load_dwordx4 v80, s[8:11], s20 offen lds
  s_add_u32 s21, s34, 13312
  s_mov_b32 m0, s21
  s_nop 0
  buffer_load_dwordx4 v81, s[8:11], s20 offen lds
  s_add_u32 s21, s34, 14336
  s_mov_b32 m0, s21
  s_nop 0
  buffer_load_dwordx4 v82, s[8:11], s20 offen lds
  s_waitcnt vmcnt(9)
  ds_read_b64_tr_b16 a[100:101], v85 offset:3072
  ds_read_b64_tr_b16 a[102:103], v85 offset:3456
  ds_read_b64_tr_b16 a[108:109], v85 offset:3104
  ds_read_b64_tr_b16 a[110:111], v85 offset:3488
  ds_read_b64_tr_b16 a[116:117], v85 offset:3136
  ds_read_b64_tr_b16 a[118:119], v85 offset:3520
  s_waitcnt lgkmcnt(0)
  s_add_u32 s20, s36, 7
  s_sub_u32 s22, s20, 10
  s_cmp_ge_u32 s20, 10
  s_cselect_b32 s20, s22, s20
  s_mul_i32 s20, s20, 786432
  s_add_u32 s20, s20, s35
  s_add_u32 s20, s20, 393216
  s_add_u32 s21, s34, 0
  s_mov_b32 m0, s21
  s_nop 0
  buffer_load_dwordx4 v80, s[8:11], s20 offen lds
  s_add_u32 s21, s34, 1024
  s_mov_b32 m0, s21
  s_nop 0
  buffer_load_dwordx4 v81, s[8:11], s20 offen lds
  s_add_u32 s21, s34, 2048
  s_mov_b32 m0, s21
  s_nop 0
  buffer_load_dwordx4 v82, s[8:11], s20 offen lds
  s_waitcnt vmcnt(9)
  ds_read_b64_tr_b16 a[120:121], v85 offset:6144
  ds_read_b64_tr_b16 a[122:123], v85 offset:6528
  ds_read_b64_tr_b16 v[88:89], v85 offset:6176
  ds_read_b64_tr_b16 v[90:91], v85 offset:6560
  ds_read_b64_tr_b16 a[128:129], v85 offset:6208
  ds_read_b64_tr_b16 a[130:131], v85 offset:6592
  s_waitcnt lgkmcnt(0)
  ds_write_b128 v15, v[88:91] offset:6144
  s_add_u32 s20, s36, 8
  s_sub_u32 s22, s20, 10
  s_cmp_ge_u32 s20, 10
  s_cselect_b32 s20, s22, s20
  s_mul_i32 s20, s20, 786432
  s_add_u32 s20, s20, s35
  s_add_u32 s21, s34, 3072
  s_mov_b32 m0, s21
  s_nop 0
  buffer_load_dwordx4 v80, s[8:11], s20 offen lds
  s_add_u32 s21, s34, 4096
  s_mov_b32 m0, s21
  s_nop 0
  buffer_load_dwordx4 v81, s[8:11], s20 offen lds
  s_add_u32 s21, s34, 5120
  s_mov_b32 m0, s21
  s_nop 0
  buffer_load_dwordx4 v82, s[8:11], s20 offen lds
  s_waitcnt vmcnt(9)
  ds_read_b64_tr_b16 a[124:125], v85 offset:9216
  ds_read_b64_tr_b16 a[126:127], v85 offset:9600
  ds_read_b64_tr_b16 v[88:89], v85 offset:9248
  ds_read_b64_tr_b16 v[90:91], v85 offset:9632
  ds_read_b64_tr_b16 a[132:133], v85 offset:9280
  ds_read_b64_tr_b16 a[134:135], v85 offset:9664
  s_waitcnt lgkmcnt(0)
  ds_write_b128 v15, v[88:91] offset:7168
  s_add_u32 s20, s36, 8
  s_sub_u32 s22, s20, 10
  s_cmp_ge_u32 s20, 10
  s_cselect_b32 s20, s22, s20
  s_mul_i32 s20, s20, 786432
  s_add_u32 s20, s20, s35
  s_add_u32 s20, s20, 393216
  s_add_u32 s21, s34, 6144
  s_mov_b32 m0, s21
  s_nop 0
  buffer_load_dwordx4 v80, s[8:11], s20 offen lds
  s_add_u32 s21, s34, 7168
  s_mov_b32 m0, s21
  s_nop 0
  buffer_load_dwordx4 v81, s[8:11], s20 offen lds
  s_add_u32 s21, s34, 8192
  s_mov_b32 m0, s21
  s_nop 0
  buffer_load_dwordx4 v82, s[8:11], s20 offen lds
  s_waitcnt vmcnt(9)
  ds_read_b64_tr_b16 a[136:137], v85 offset:12288
  ds_read_b64_tr_b16 a[138:139], v85 offset:12672
  ds_read_b64_tr_b16 a[144:145], v85 offset:12320
  ds_read_b64_tr_b16 a[146:147], v85 offset:12704
  ds_read_b64_tr_b16 a[152:153], v85 offset:12352
  ds_read_b64_tr_b16 a[154:155], v85 offset:12736
  s_waitcnt lgkmcnt(0)
  s_add_u32 s20, s36, 9
  s_sub_u32 s22, s20, 10
  s_cmp_ge_u32 s20, 10
  s_cselect_b32 s20, s22, s20
  s_mul_i32 s20, s20, 786432
  s_add_u32 s20, s20, s35
  s_add_u32 s21, s34, 9216
  s_mov_b32 m0, s21
  s_nop 0
  buffer_load_dwordx4 v80, s[8:11], s20 offen lds
  s_add_u32 s21, s34, 10240
  s_mov_b32 m0, s21
  s_nop 0
  buffer_load_dwordx4 v81, s[8:11], s20 offen lds
  s_add_u32 s21, s34, 11264
  s_mov_b32 m0, s21
  s_nop 0
  buffer_load_dwordx4 v82, s[8:11], s20 offen lds
  s_waitcnt vmcnt(9)
  ds_read_b64_tr_b16 a[140:141], v85 offset:0
  ds_read_b64_tr_b16 a[142:143], v85 offset:384
  ds_read_b64_tr_b16 a[148:149], v85 offset:32
  ds_read_b64_tr_b16 a[150:151], v85 offset:416
  ds_read_b64_tr_b16 a[156:157], v85 offset:64
  ds_read_b64_tr_b16 a[158:159], v85 offset:448
  s_waitcnt lgkmcnt(0)
  s_add_u32 s20, s36, 9
  s_sub_u32 s22, s20, 10
  s_cmp_ge_u32 s20, 10
  s_cselect_b32 s20, s22, s20
  s_mul_i32 s20, s20, 786432
  s_add_u32 s20, s20, s35
  s_add_u32 s20, s20, 393216
  s_add_u32 s21, s34, 12288
  s_mov_b32 m0, s21
  s_nop 0
  buffer_load_dwordx4 v80, s[8:11], s20 offen lds
  s_add_u32 s21, s34, 13312
  s_mov_b32 m0, s21
  s_nop 0
  buffer_load_dwordx4 v81, s[8:11], s20 offen lds
  s_add_u32 s21, s34, 14336
  s_mov_b32 m0, s21
  s_nop 0
  buffer_load_dwordx4 v82, s[8:11], s20 offen lds
  s_waitcnt vmcnt(9)
  ds_read_b64_tr_b16 v[88:89], v85 offset:3072
  ds_read_b64_tr_b16 v[90:91], v85 offset:3456
  ds_read_b64_tr_b16 a[160:161], v85 offset:3104
  ds_read_b64_tr_b16 a[162:163], v85 offset:3488
  ds_read_b64_tr_b16 a[168:169], v85 offset:3136
  ds_read_b64_tr_b16 a[170:171], v85 offset:3520
  s_waitcnt lgkmcnt(0)
  ds_write_b128 v15, v[88:91] offset:8192
  s_waitcnt vmcnt(6)
  ds_read_b64_tr_b16 v[88:89], v85 offset:6144
  ds_read_b64_tr_b16 v[90:91], v85 offset:6528
  ds_read_b64_tr_b16 a[164:165], v85 offset:6176
  ds_read_b64_tr_b16 a[166:167], v85 offset:6560
  ds_read_b64_tr_b16 a[172:173], v85 offset:6208
  ds_read_b64_tr_b16 a[174:175], v85 offset:6592
  s_waitcnt lgkmcnt(0)
  ds_write_b128 v15, v[88:91] offset:9216
  s_waitcnt vmcnt(3)
  ds_read_b64_tr_b16 a[176:177], v85 offset:9216
  ds_read_b64_tr_b16 a[178:179], v85 offset:9600
  ds_read_b64_tr_b16 a[184:185], v85 offset:9248
  ds_read_b64_tr_b16 a[186:187], v85 offset:9632
  ds_read_b64_tr_b16 v[88:89], v85 offset:9280
  ds_read_b64_tr_b16 v[90:91], v85 offset:9664
  s_waitcnt lgkmcnt(0)
  ds_write_b128 v15, v[88:91] offset:10240
  s_waitcnt vmcnt(0)
  ds_read_b64_tr_b16 a[180:181], v85 offset:12288
  ds_read_b64_tr_b16 a[182:183], v85 offset:12672
  ds_read_b64_tr_b16 a[188:189], v85 offset:12320
  ds_read_b64_tr_b16 a[190:191], v85 offset:12704
  ds_read_b64_tr_b16 v[88:89], v85 offset:12352
  ds_read_b64_tr_b16 v[90:91], v85 offset:12736
  s_waitcnt lgkmcnt(0)
  ds_write_b128 v15, v[88:91] offset:11264
  s_waitcnt lgkmcnt(0)
  v_add_u32 v83, 0, v1
  s_mov_b32 s20, 104858
  v_mul_lo_u32 v84, v83, s20
  v_lshrrev_b32 v84, 20, v84
  v_mul_u32_u24 v100, 10, v84
  v_sub_u32 v100, v83, v100
  v_lshlrev_b32 v100, 4, v100
  s_mov_b32 s20, 1280
  v_mul_lo_u32 v84, v84, s20
  v_add_u32 v100, v100, v84
  v_add_u32 v83, 64, v1
  s_mov_b32 s20, 104858
  v_mul_lo_u32 v84, v83, s20
  v_lshrrev_b32 v84, 20, v84
  v_mul_u32_u24 v101, 10, v84
  v_sub_u32 v101, v83, v101
  v_lshlrev_b32 v101, 4, v101
  s_mov_b32 s20, 1280
  v_mul_lo_u32 v84, v84, s20
  v_add_u32 v101, v101, v84
  v_add_u32 v83, 128, v1
  s_mov_b32 s20, 104858
  v_mul_lo_u32 v84, v83, s20
  v_lshrrev_b32 v84, 20, v84
  v_mul_u32_u24 v102, 10, v84
  v_sub_u32 v102, v83, v102
  v_lshlrev_b32 v102, 4, v102
  s_mov_b32 s20, 1280
  v_mul_lo_u32 v84, v84, s20
  v_add_u32 v102, v102, v84
  v_add_u32 v83, 192, v1
  s_mov_b32 s20, 104858
  v_mul_lo_u32 v84, v83, s20
  v_lshrrev_b32 v84, 20, v84
  v_mul_u32_u24 v103, 10, v84
  v_sub_u32 v103, v83, v103
  v_lshlrev_b32 v103, 4, v103
  s_mov_b32 s20, 1280
  v_mul_lo_u32 v84, v84, s20
  v_add_u32 v103, v103, v84
  v_add_u32 v83, 256, v1
  s_mov_b32 s20, 104858
  v_mul_lo_u32 v84, v83, s20
  v_lshrrev_b32 v84, 20, v84
  v_mul_u32_u24 v104, 10, v84
  v_sub_u32 v104, v83, v104
  v_lshlrev_b32 v104, 4, v104
  s_mov_b32 s20, 1280
  v_mul_lo_u32 v84, v84, s20
  v_add_u32 v104, v104, v84
  s_mul_i32 s35, s17, 245760
  s_mul_i32 s20, s16, 320
  s_add_u32 s35, s35, s20
  s_add_u32 s20, s35, 0
  s_add_u32 s21, s34, 0
  s_mov_b32 m0, s21
  s_nop 0
  buffer_load_dwordx4 v100, s[12:15], s20 offen lds
  s_add_u32 s21, s34, 1024
  s_mov_b32 m0, s21
  s_nop 0
  buffer_load_dwordx4 v101, s[12:15], s20 offen lds
  s_add_u32 s21, s34, 2048
  s_mov_b32 m0, s21
  s_nop 0
  buffer_load_dwordx4 v102, s[12:15], s20 offen lds
  s_add_u32 s21, s34, 3072
  s_mov_b32 m0, s21
  s_nop 0
  buffer_load_dwordx4 v103, s[12:15], s20 offen lds
  s_add_u32 s21, s34, 4096
  s_mov_b32 m0, s21
  s_nop 0
  buffer_load_dwordx4 v104, s[12:15], s20 offen lds
  s_add_u32 s20, s35, 160
  s_add_u32 s21, s34, 5120
  s_mov_b32 m0, s21
  s_nop 0
  buffer_load_dwordx4 v100, s[12:15], s20 offen lds
  s_add_u32 s21, s34, 6144
  s_mov_b32 m0, s21
  s_nop 0
  buffer_load_dwordx4 v101, s[12:15], s20 offen lds
  s_add_u32 s21, s34, 7168
  s_mov_b32 m0, s21
  s_nop 0
  buffer_load_dwordx4 v102, s[12:15], s20 offen lds
  s_add_u32 s21, s34, 8192
  s_mov_b32 m0, s21
  s_nop 0
  buffer_load_dwordx4 v103, s[12:15], s20 offen lds
  s_add_u32 s21, s34, 9216
  s_mov_b32 m0, s21
  s_nop 0
  buffer_load_dwordx4 v104, s[12:15], s20 offen lds
  s_waitcnt vmcnt(5)
  ds_read_b64_tr_b16 a[192:193], v86 offset:0
  ds_read_b64_tr_b16 a[194:195], v86 offset:640
  ds_read_b64_tr_b16 a[216:217], v86 offset:32
  ds_read_b64_tr_b16 a[218:219], v86 offset:672
  ds_read_b64_tr_b16 a[232:233], v86 offset:64
  ds_read_b64_tr_b16 a[234:235], v86 offset:704
  ds_read_b64_tr_b16 v[88:89], v86 offset:96
  ds_read_b64_tr_b16 v[90:91], v86 offset:736
  ds_read_b64_tr_b16 v[144:145], v86 offset:128
  ds_read_b64_tr_b16 v[146:147], v86 offset:768
  s_waitcnt lgkmcnt(0)
  ds_write_b128 v15, v[88:91] offset:14336
  s_add_u32 s20, s35, 40960
  s_add_u32 s21, s34, 10240
  s_mov_b32 m0, s21
  s_nop 0
  buffer_load_dwordx4 v100, s[12:15], s20 offen lds
  s_add_u32 s21, s34, 11264
  s_mov_b32 m0, s21
  s_nop 0
  buffer_load_dwordx4 v101, s[12:15], s20 offen lds
  s_add_u32 s21, s34, 12288
  s_mov_b32 m0, s21
  s_nop 0
  buffer_load_dwordx4 v102, s[12:15], s20 offen lds
  s_add_u32 s21, s34, 13312
  s_mov_b32 m0, s21
  s_nop 0
  buffer_load_dwordx4 v103, s[12:15], s20 offen lds
  s_add_u32 s21, s34, 14336
  s_mov_b32 m0, s21
  s_nop 0
  buffer_load_dwordx4 v104, s[12:15], s20 offen lds
  s_waitcnt vmcnt(5)
  ds_read_b64_tr_b16 v[160:161], v86 offset:5120
  ds_read_b64_tr_b16 v[162:163], v86 offset:5760
  ds_read_b64_tr_b16 v[184:185], v86 offset:5152
  ds_read_b64_tr_b16 v[186:187], v86 offset:5792
  ds_read_b64_tr_b16 v[200:201], v86 offset:5184
  ds_read_b64_tr_b16 v[202:203], v86 offset:5824
  ds_read_b64_tr_b16 v[88:89], v86 offset:5216
  ds_read_b64_tr_b16 v[90:91], v86 offset:5856
  ds_read_b64_tr_b16 v[240:241], v86 offset:5248
  ds_read_b64_tr_b16 v[242:243], v86 offset:5888
  s_waitcnt lgkmcnt(0)
  ds_write_b128 v15, v[88:91] offset:20480
  s_add_u32 s20, s35, 41120
  s_add_u32 s21, s34, 0
  s_mov_b32 m0, s21
  s_nop 0
  buffer_load_dwordx4 v100, s[12:15], s20 offen lds
  s_add_u32 s21, s34, 1024
  s_mov_b32 m0, s21
  s_nop 0
  buffer_load_dwordx4 v101, s[12:15], s20 offen lds
  s_add_u32 s21, s34, 2048
  s_mov_b32 m0, s21
  s_nop 0
  buffer_load_dwordx4 v102, s[12:15], s20 offen lds
  s_add_u32 s21, s34, 3072
  s_mov_b32 m0, s21
  s_nop 0
  buffer_load_dwordx4 v103, s[12:15], s20 offen lds
  s_add_u32 s21, s34, 4096
  s_mov_b32 m0, s21
  s_nop 0
  buffer_load_dwordx4 v104, s[12:15], s20 offen lds
  s_waitcnt vmcnt(5)
  ds_read_b64_tr_b16 a[196:197], v86 offset:10240
  ds_read_b64_tr_b16 a[198:199], v86 offset:10880
  ds_read_b64_tr_b16 a[220:221], v86 offset:10272
  ds_read_b64_tr_b16 a[222:223], v86 offset:10912
  ds_read_b64_tr_b16 a[236:237], v86 offset:10304
  ds_read_b64_tr_b16 a[238:239], v86 offset:10944
  ds_read_b64_tr_b16 v[88:89], v86 offset:10336
  ds_read_b64_tr_b16 v[90:91], v86 offset:10976
  ds_read_b64_tr_b16 v[148:149], v86 offset:10368
  ds_read_b64_tr_b16 v[150:151], v86 offset:11008
  s_waitcnt lgkmcnt(0)
  ds_write_b128 v15, v[88:91] offset:15360
  s_add_u32 s20, s35, 81920
  s_add_u32 s21, s34, 5120
  s_mov_b32 m0, s21
  s_nop 0
  buffer_load_dwordx4 v100, s[12:15], s20 offen lds
  s_add_u32 s21, s34, 6144
  s_mov_b32 m0, s21
  s_nop 0
  buffer_load_dwordx4 v101, s[12:15], s20 offen lds
  s_add_u32 s21, s34, 7168
  s_mov_b32 m0, s21
  s_nop 0
  buffer_load_dwordx4 v102, s[12:15], s20 offen lds
  s_add_u32 s21, s34, 8192
  s_mov_b32 m0, s21
  s_nop 0
  buffer_load_dwordx4 v103, s[12:15], s20 offen lds
  s_add_u32 s21, s34, 9216
  s_mov_b32 m0, s21
  s_nop 0
  buffer_load_dwordx4 v104, s[12:15], s20 offen lds
  s_waitcnt vmcnt(5)
  ds_read_b64_tr_b16 v[164:165], v86 offset:0
  ds_read_b64_tr_b16 v[166:167], v86 offset:640
  ds_read_b64_tr_b16 v[188:189], v86 offset:32
  ds_read_b64_tr_b16 v[190:191], v86 offset:672
  ds_read_b64_tr_b16 v[204:205], v86 offset:64
  ds_read_b64_tr_b16 v[206:207], v86 offset:704
  ds_read_b64_tr_b16 v[88:89], v86 offset:96
  ds_read_b64_tr_b16 v[90:91], v86 offset:736
  ds_read_b64_tr_b16 v[244:245], v86 offset:128
  ds_read_b64_tr_b16 v[246:247], v86 offset:768
  s_waitcnt lgkmcnt(0)
  ds_write_b128 v15, v[88:91] offset:21504
  s_add_u32 s20, s35, 82080
  s_add_u32 s21, s34, 10240
  s_mov_b32 m0, s21
  s_nop 0
  buffer_load_dwordx4 v100, s[12:15], s20 offen lds
  s_add_u32 s21, s34, 11264
  s_mov_b32 m0, s21
  s_nop 0
  buffer_load_dwordx4 v101, s[12:15], s20 offen lds
  s_add_u32 s21, s34, 12288
  s_mov_b32 m0, s21
  s_nop 0
  buffer_load_dwordx4 v102, s[12:15], s20 offen lds
  s_add_u32 s21, s34, 13312
  s_mov_b32 m0, s21
  s_nop 0
  buffer_load_dwordx4 v103, s[12:15], s20 offen lds
  s_add_u32 s21, s34, 14336
  s_mov_b32 m0, s21
  s_nop 0
  buffer_load_dwordx4 v104, s[12:15], s20 offen lds
  s_waitcnt vmcnt(5)
  ds_read_b64_tr_b16 a[200:201], v86 offset:5120
  ds_read_b64_tr_b16 a[202:203], v86 offset:5760
  ds_read_b64_tr_b16 v[88:89], v86 offset:5152
  ds_read_b64_tr_b16 v[90:91], v86 offset:5792
  ds_read_b64_tr_b16 a[240:241], v86 offset:5184
  ds_read_b64_tr_b16 a[242:243], v86 offset:5824
  ds_read_b64_tr_b16 v[128:129], v86 offset:5216
  ds_read_b64_tr_b16 v[130:131], v86 offset:5856
  ds_read_b64_tr_b16 v[152:153], v86 offset:5248
  ds_read_b64_tr_b16 v[154:155], v86 offset:5888
  s_waitcnt lgkmcnt(0)
  ds_write_b128 v15, v[88:91] offset:12288
  s_add_u32 s20, s35, 122880
  s_add_u32 s21, s34, 0
  s_mov_b32 m0, s21
  s_nop 0
  buffer_load_dwordx4 v100, s[12:15], s20 offen lds
  s_add_u32 s21, s34, 1024
  s_mov_b32 m0, s21
  s_nop 0
  buffer_load_dwordx4 v101, s[12:15], s20 offen lds
  s_add_u32 s21, s34, 2048
  s_mov_b32 m0, s21
  s_nop 0
  buffer_load_dwordx4 v102, s[12:15], s20 offen lds
  s_add_u32 s21, s34, 3072
  s_mov_b32 m0, s21
  s_nop 0
  buffer_load_dwordx4 v103, s[12:15], s20 offen lds
  s_add_u32 s21, s34, 4096
  s_mov_b32 m0, s21
  s_nop 0
  buffer_load_dwordx4 v104, s[12:15], s20 offen lds
  s_waitcnt vmcnt(5)
  ds_read_b64_tr_b16 v[168:169], v86 offset:10240
  ds_read_b64_tr_b16 v[170:171], v86 offset:10880
  ds_read_b64_tr_b16 v[88:89], v86 offset:10272
  ds_read_b64_tr_b16 v[90:91], v86 offset:10912
  ds_read_b64_tr_b16 v[208:209], v86 offset:10304
  ds_read_b64_tr_b16 v[210:211], v86 offset:10944
  ds_read_b64_tr_b16 v[224:225], v86 offset:10336
  ds_read_b64_tr_b16 v[226:227], v86 offset:10976
  ds_read_b64_tr_b16 v[248:249], v86 offset:10368
  ds_read_b64_tr_b16 v[250:251], v86 offset:11008
  s_waitcnt lgkmcnt(0)
  ds_write_b128 v15, v[88:91] offset:18432
  s_add_u32 s20, s35, 123040
  s_add_u32 s21, s34, 5120
  s_mov_b32 m0, s21
  s_nop 0
  buffer_load_dwordx4 v100, s[12:15], s20 offen lds
  s_add_u32 s21, s34, 6144
  s_mov_b32 m0, s21
  s_nop 0
  buffer_load_dwordx4 v101, s[12:15], s20 offen lds
  s_add_u32 s21, s34, 7168
  s_mov_b32 m0, s21
  s_nop 0
  buffer_load_dwordx4 v102, s[12:15], s20 offen lds
  s_add_u32 s21, s34, 8192
  s_mov_b32 m0, s21
  s_nop 0
  buffer_load_dwordx4 v103, s[12:15], s20 offen lds
  s_add_u32 s21, s34, 9216
  s_mov_b32 m0, s21
  s_nop 0
  buffer_load_dwordx4 v104, s[12:15], s20 offen lds
  s_waitcnt vmcnt(5)
  ds_read_b64_tr_b16 a[204:205], v86 offset:0
  ds_read_b64_tr_b16 a[206:207], v86 offset:640
  ds_read_b64_tr_b16 v[88:89], v86 offset:32
  ds_read_b64_tr_b16 v[90:91], v86 offset:672
  ds_read_b64_tr_b16 a[244:245], v86 offset:64
  ds_read_b64_tr_b16 a[246:247], v86 offset:704
  ds_read_b64_tr_b16 v[132:133], v86 offset:96
  ds_read_b64_tr_b16 v[134:135], v86 offset:736
  ds_read_b64_tr_b16 v[156:157], v86 offset:128
  ds_read_b64_tr_b16 v[158:159], v86 offset:768
  s_waitcnt lgkmcnt(0)
  ds_write_b128 v15, v[88:91] offset:13312
  s_add_u32 s20, s35, 163840
  s_add_u32 s21, s34, 10240
  s_mov_b32 m0, s21
  s_nop 0
  buffer_load_dwordx4 v100, s[12:15], s20 offen lds
  s_add_u32 s21, s34, 11264
  s_mov_b32 m0, s21
  s_nop 0
  buffer_load_dwordx4 v101, s[12:15], s20 offen lds
  s_add_u32 s21, s34, 12288
  s_mov_b32 m0, s21
  s_nop 0
  buffer_load_dwordx4 v102, s[12:15], s20 offen lds
  s_add_u32 s21, s34, 13312
  s_mov_b32 m0, s21
  s_nop 0
  buffer_load_dwordx4 v103, s[12:15], s20 offen lds
  s_add_u32 s21, s34, 14336
  s_mov_b32 m0, s21
  s_nop 0
  buffer_load_dwordx4 v104, s[12:15], s20 offen lds
  s_waitcnt vmcnt(5)
  ds_read_b64_tr_b16 v[172:173], v86 offset:5120
  ds_read_b64_tr_b16 v[174:175], v86 offset:5760
  ds_read_b64_tr_b16 v[88:89], v86 offset:5152
  ds_read_b64_tr_b16 v[90:91], v86 offset:5792
  ds_read_b64_tr_b16 v[212:213], v86 offset:5184
  ds_read_b64_tr_b16 v[214:215], v86 offset:5824
  ds_read_b64_tr_b16 v[228:229], v86 offset:5216
  ds_read_b64_tr_b16 v[230:231], v86 offset:5856
  ds_read_b64_tr_b16 v[252:253], v86 offset:5248
  ds_read_b64_tr_b16 v[254:255], v86 offset:5888
  s_waitcnt lgkmcnt(0)
  ds_write_b128 v15, v[88:91] offset:19456
  s_add_u32 s20, s35, 164000
  s_add_u32 s21, s34, 0
  s_mov_b32 m0, s21
  s_nop 0
  buffer_load_dwordx4 v100, s[12:15], s20 offen lds
  s_add_u32 s21, s34, 1024
  s_mov_b32 m0, s21
  s_nop 0
  buffer_load_dwordx4 v101, s[12:15], s20 offen lds
  s_add_u32 s21, s34, 2048
  s_mov_b32 m0, s21
  s_nop 0
  buffer_load_dwordx4 v102, s[12:15], s20 offen lds
  s_add_u32 s21, s34, 3072
  s_mov_b32 m0, s21
  s_nop 0
  buffer_load_dwordx4 v103, s[12:15], s20 offen lds
  s_add_u32 s21, s34, 4096
  s_mov_b32 m0, s21
  s_nop 0
  buffer_load_dwordx4 v104, s[12:15], s20 offen lds
  s_waitcnt vmcnt(5)
  ds_read_b64_tr_b16 a[208:209], v86 offset:10240
  ds_read_b64_tr_b16 a[210:211], v86 offset:10880
  ds_read_b64_tr_b16 a[224:225], v86 offset:10272
  ds_read_b64_tr_b16 a[226:227], v86 offset:10912
  ds_read_b64_tr_b16 a[248:249], v86 offset:10304
  ds_read_b64_tr_b16 a[250:251], v86 offset:10944
  ds_read_b64_tr_b16 v[136:137], v86 offset:10336
  ds_read_b64_tr_b16 v[138:139], v86 offset:10976
  ds_read_b64_tr_b16 v[88:89], v86 offset:10368
  ds_read_b64_tr_b16 v[90:91], v86 offset:11008
  s_waitcnt lgkmcnt(0)
  ds_write_b128 v15, v[88:91] offset:16384
  s_add_u32 s20, s35, 204800
  s_add_u32 s21, s34, 5120
  s_mov_b32 m0, s21
  s_nop 0
  buffer_load_dwordx4 v100, s[12:15], s20 offen lds
  s_add_u32 s21, s34, 6144
  s_mov_b32 m0, s21
  s_nop 0
  buffer_load_dwordx4 v101, s[12:15], s20 offen lds
  s_add_u32 s21, s34, 7168
  s_mov_b32 m0, s21
  s_nop 0
  buffer_load_dwordx4 v102, s[12:15], s20 offen lds
  s_add_u32 s21, s34, 8192
  s_mov_b32 m0, s21
  s_nop 0
  buffer_load_dwordx4 v103, s[12:15], s20 offen lds
  s_add_u32 s21, s34, 9216
  s_mov_b32 m0, s21
  s_nop 0
  buffer_load_dwordx4 v104, s[12:15], s20 offen lds
  s_waitcnt vmcnt(5)
  ds_read_b64_tr_b16 v[176:177], v86 offset:0
  ds_read_b64_tr_b16 v[178:179], v86 offset:640
  ds_read_b64_tr_b16 v[192:193], v86 offset:32
  ds_read_b64_tr_b16 v[194:195], v86 offset:672
  ds_read_b64_tr_b16 v[216:217], v86 offset:64
  ds_read_b64_tr_b16 v[218:219], v86 offset:704
  ds_read_b64_tr_b16 v[232:233], v86 offset:96
  ds_read_b64_tr_b16 v[234:235], v86 offset:736
  ds_read_b64_tr_b16 v[88:89], v86 offset:128
  ds_read_b64_tr_b16 v[90:91], v86 offset:768
  s_waitcnt lgkmcnt(0)
  ds_write_b128 v15, v[88:91] offset:22528
  s_add_u32 s20, s35, 204960
  s_add_u32 s21, s34, 10240
  s_mov_b32 m0, s21
  s_nop 0
  buffer_load_dwordx4 v100, s[12:15], s20 offen lds
  s_add_u32 s21, s34, 11264
  s_mov_b32 m0, s21
  s_nop 0
  buffer_load_dwordx4 v101, s[12:15], s20 offen lds
  s_add_u32 s21, s34, 12288
  s_mov_b32 m0, s21
  s_nop 0
  buffer_load_dwordx4 v102, s[12:15], s20 offen lds
  s_add_u32 s21, s34, 13312
  s_mov_b32 m0, s21
  s_nop 0
  buffer_load_dwordx4 v103, s[12:15], s20 offen lds
  s_add_u32 s21, s34, 14336
  s_mov_b32 m0, s21
  s_nop 0
  buffer_load_dwordx4 v104, s[12:15], s20 offen lds
  s_waitcnt vmcnt(5)
  ds_read_b64_tr_b16 a[212:213], v86 offset:5120
  ds_read_b64_tr_b16 a[214:215], v86 offset:5760
  ds_read_b64_tr_b16 a[228:229], v86 offset:5152
  ds_read_b64_tr_b16 a[230:231], v86 offset:5792
  ds_read_b64_tr_b16 a[252:253], v86 offset:5184
  ds_read_b64_tr_b16 a[254:255], v86 offset:5824
  ds_read_b64_tr_b16 v[140:141], v86 offset:5216
  ds_read_b64_tr_b16 v[142:143], v86 offset:5856
  ds_read_b64_tr_b16 v[88:89], v86 offset:5248
  ds_read_b64_tr_b16 v[90:91], v86 offset:5888
  s_waitcnt lgkmcnt(0)
  ds_write_b128 v15, v[88:91] offset:17408
  s_waitcnt vmcnt(0)
  ds_read_b64_tr_b16 v[180:181], v86 offset:10240
  ds_read_b64_tr_b16 v[182:183], v86 offset:10880
  ds_read_b64_tr_b16 v[196:197], v86 offset:10272
  ds_read_b64_tr_b16 v[198:199], v86 offset:10912
  ds_read_b64_tr_b16 v[220:221], v86 offset:10304
  ds_read_b64_tr_b16 v[222:223], v86 offset:10944
  ds_read_b64_tr_b16 v[236:237], v86 offset:10336
  ds_read_b64_tr_b16 v[238:239], v86 offset:10976
  ds_read_b64_tr_b16 v[88:89], v86 offset:10368
  ds_read_b64_tr_b16 v[90:91], v86 offset:11008
  s_waitcnt lgkmcnt(0)
  ds_write_b128 v15, v[88:91] offset:23552
  s_waitcnt lgkmcnt(0)
  s_barrier
  v_bfe_u32 v80, v1, 3, 1
  v_lshlrev_b32 v80, 9, v80
  v_bfe_u32 v81, v1, 2, 1
  v_lshlrev_b32 v81, 6, v81
  v_add_u32 v80, v80, v81
  v_and_b32 v81, 1, v1
  v_lshlrev_b32 v81, 5, v81
  v_add_u32 v80, v80, v81
  v_bfe_u32 v81, v1, 1, 1
  v_lshlrev_b32 v81, 2, v81
  v_add_u32 v80, v80, v81
  v_lshrrev_b32 v81, 4, v1
  v_lshlrev_b32 v81, 3, v81
  v_add_u32 v80, v80, v81
  s_mul_i32 s20, s16, 3
  s_add_u32 s20, s20, 0
  s_lshr_b32 s21, s20, 2
  s_lshl_b32 s21, s21, 10
  s_and_b32 s20, s20, 3
  s_lshl_b32 s20, s20, 7
  s_add_u32 s20, s20, s21
  s_add_u32 s20, s20, 10240
  v_add_u32 v11, s20, v80
  s_mul_i32 s20, s16, 3
  s_add_u32 s20, s20, 1
  s_lshr_b32 s21, s20, 2
  s_lshl_b32 s21, s21, 10
  s_and_b32 s20, s20, 3
  s_lshl_b32 s20, s20, 7
  s_add_u32 s20, s20, s21
  s_add_u32 s20, s20, 10240
  v_add_u32 v12, s20, v80
  s_mul_i32 s20, s16, 3
  s_add_u32 s20, s20, 2
  s_lshr_b32 s21, s20, 2
  s_lshl_b32 s21, s21, 10
  s_and_b32 s20, s20, 3
  s_lshl_b32 s20, s20, 7
  s_add_u32 s20, s20, s21
  s_add_u32 s20, s20, 10240
  v_add_u32 v29, s20, v80
  v_mov_b32 v28, 0x05040100
  v_mov_b32 v82, 0x03020706
  v_and_b32 v83, 2, v1
  v_cmp_eq_u32 vcc, 0, v83
  s_nop 1
  v_cndmask_b32 v28, v82, v28, vcc
  v_lshrrev_b32 v80, 4, v1
  v_lshlrev_b32 v80, 7, v80
  v_bfe_u32 v81, v1, 2, 2
  v_lshlrev_b32 v81, 5, v81
  v_add_u32 v80, v80, v81
  v_and_b32 v81, 3, v1
  v_lshlrev_b32 v81, 3, v81
  v_add_u32 v80, v80, v81
  v_add_u32 v13, 10240, v80
  v_lshrrev_b32 v80, 4, v1
  s_mul_i32 s20, s16, 10
  v_add_u32 v80, s20, v80
  v_lshlrev_b32 v80, 14, v80
  v_and_b32 v81, 15, v1
  v_lshlrev_b32 v81, 4, v81
  v_add_u32 v80, v80, v81
  s_lshl_b32 s20, s17, 8
  v_add_u32 v14, s20, v80
  v_add_u32 v0, 131072, v14
  v_mov_b32 v82, 0x7ff00000
  v_cmp_gt_u32 vcc, 32, v1
  s_nop 1
  v_cndmask_b32 v0, v82, v0, vcc
  s_mov_b32 s18, 0
  s_mov_b32 s52, s32
  s_mov_b32 s53, s33
  s_mov_b32 s54, 256
  s_mov_b32 s55, 0x00020000
  s_cmp_lg_u32 s16, 0
  s_cbranch_scc1 Lwr_40
  v_lshrrev_b32 v16, 4, v2
  v_lshlrev_b32 v16, 7, v16
  v_mov_b32 v17, 196
  s_mov_b32 s51, 106496
  s_mov_b32 s50, 114688
Lwrt_41:
  buffer_load_dword v18, v16, s[4:7], s51 offen sc1
  buffer_load_dword v19, v16, s[4:7], s50 offen sc1
  buffer_load_dword v20, v17, s[52:55], 0 offen sc1
  s_waitcnt vmcnt(0)
  v_cmp_ne_u32 vcc, s70, v18
  s_cbranch_vccnz Lwra_43
  v_cmp_ne_u32 vcc, s70, v19
  s_cbranch_vccnz Lwra_43
  v_cmp_eq_u32 vcc, 0, v20
  s_cbranch_vccnz Lwra_43
  s_branch Lwrd_42
Lwra_43:
  s_sleep 2
  s_cmp_eq_u32 s19, 0
  s_cbranch_scc1 Lwrd_42
  s_sub_u32 s19, s19, 1
  s_branch Lwrt_41
Lwrd_42:
  v_mov_b32 v16, 0
  ds_write_b32 v16, v20 offset:10240
  s_waitcnt lgkmcnt(0)
Lwr_40:
  s_barrier
  v_mov_b32 v16, 0
  ds_read_b32 v17, v16 offset:10240
  s_waitcnt lgkmcnt(0)
  v_readfirstlane_b32 s50, v17
  s_barrier
  s_nop 2
  s_and_b32 s51, s50, 1
  s_lshl_b32 s51, s51, 13
  s_add_u32 s43, s43, s51
  s_and_b32 s51, s50, 2
  s_lshl_b32 s51, s51, 12
  s_add_u32 s39, s39, s51
  s_mov_b32 s62, 0
  s_mov_b32 s60, 0
  s_mov_b32 s63, 1
  s_lshl_b32 s21, s16, 2
  s_add_u32 s21, s21, 16384
  v_mov_b32 v40, s21
  v_mov_b32 v41, s63
  ds_write_b32 v40, v41
LBloop_44:
  v_mov_b32 v16, 0
  v_mov_b32 v17, 0
  v_mov_b32 v18, 0
  v_mov_b32 v19, 0
  v_mov_b32 v20, 0
  v_mov_b32 v21, 0
  v_mov_b32 v22, 0
  v_mov_b32 v23, 0
  v_mov_b32 v24, 0
  v_mov_b32 v25, 0
  v_mov_b32 v26, 0
  v_mov_b32 v27, 0
  ds_read_b128 v[64:67], v15 offset:0
  ds_read_b128 v[68:71], v15 offset:1024
  ds_read_b128 v[72:75], v15 offset:2048
  ds_read_b128 v[76:79], v15 offset:3072
  s_add_u32 s20, s18, 0
  s_and_b32 s20, s20, 3
  s_mul_i32 s20, s20, 32768
  s_add_u32 s26, s20, s43
  s_and_b32 s20, s18, 1
  s_mul_i32 s20, s20, 655360
  s_add_u32 s28, s20, s39
  v_lshrrev_b32 v7, 1, v4
  v_and_b32 v7, 0x2000, v7
  v_and_b32 v52, 0x1fff, v4
  v_or_b32 v52, v7, v52
  v_lshrrev_b32 v7, 1, v5
  v_and_b32 v7, 0x2000, v7
  v_and_b32 v53, 0x1fff, v5
  v_or_b32 v53, v7, v53
  v_lshrrev_b32 v7, 1, v6
  v_and_b32 v7, 0x2000, v7
  v_and_b32 v54, 0x1fff, v6
  v_or_b32 v54, v7, v54
  s_waitcnt lgkmcnt(0)
  s_barrier
  v_mov_b32 v80, 0
  v_mov_b32 v81, 0
  v_mov_b32 v82, 0
  v_mov_b32 v83, 0
  v_mov_b32 v84, 0
  v_mov_b32 v85, 0
  v_mov_b32 v86, 0
  v_mov_b32 v87, 0
  v_mov_b32 v88, 0
  v_mov_b32 v89, 0
  v_mov_b32 v90, 0
  v_mov_b32 v91, 0
  v_mov_b32 v92, 0
  v_mov_b32 v93, 0
  v_mov_b32 v94, 0
  v_mov_b32 v95, 0
  v_mov_b32 v96, 0
  v_mov_b32 v97, 0
  v_mov_b32 v98, 0
  v_mov_b32 v99, 0
  v_mov_b32 v100, 0
  v_mov_b32 v101, 0
  v_mov_b32 v102, 0
  v_mov_b32 v103, 0
  v_mov_b32 v104, 0
  v_mov_b32 v105, 0
  v_mov_b32 v106, 0
  v_mov_b32 v107, 0
  v_mov_b32 v108, 0
  v_mov_b32 v109, 0
  v_mov_b32 v110, 0
  v_mov_b32 v111, 0
  v_mov_b32 v112, 0
  v_mov_b32 v113, 0
  v_mov_b32 v114, 0
  v_mov_b32 v115, 0
  v_mov_b32 v116, 0
  v_mov_b32 v117, 0
  v_mov_b32 v118, 0
  v_mov_b32 v119, 0
  s_sleep 35
Lcl_45:
  buffer_load_dwordx4 v[40:43], v4, s[4:7], s26 offen sc1
  buffer_load_dwordx4 v[44:47], v5, s[4:7], s26 offen sc1
  buffer_load_dwordx4 v[48:51], v6, s[4:7], s26 offen sc1
  s_waitcnt vmcnt(0)
  v_max3_u32 v7, v43, v47, v51
  v_cmp_eq_u32 vcc, -1, v7
  s_cbranch_vccz Lclok_46
  s_cmp_eq_u32 s19, 0
  s_cbranch_scc1 Lclok_46
  s_sub_u32 s19, s19, 1
  s_branch Lcl_45
Lclok_46:
  s_mov_b32 s63, 1
  ds_write_b128 v52, v[40:43]
  ds_write_b128 v53, v[44:47]
  ds_write_b128 v54, v[48:51]
  v_smfmac_f32_16x16x64_bf16 v[16:19], v[40:43], a[0:7], v3
  v_smfmac_f32_16x16x64_bf16 v[20:23], v[40:43], a[8:15], v3
  v_smfmac_f32_16x16x64_bf16 v[24:27], v[40:43], a[16:23], v3
  s_waitcnt lgkmcnt(0)
  s_barrier
  ds_read_b128 v[52:55], v8 offset:0
  ds_read_b128 v[56:59], v9 offset:0
  ds_read_b128 v[60:63], v9 offset:1024
  v_smfmac_f32_16x16x64_bf16 v[16:19], v[44:47], a[24:31], v3
  v_smfmac_f32_16x16x64_bf16 v[20:23], v[44:47], v[64:71], v3
  ds_read_b128 v[64:67], v15 offset:4096
  ds_read_b128 v[68:71], v15 offset:5120
  v_smfmac_f32_16x16x64_bf16 v[24:27], v[44:47], a[32:39], v3
  v_smfmac_f32_16x16x64_bf16 v[16:19], v[48:51], a[40:47], v3
  v_smfmac_f32_16x16x64_bf16 v[20:23], v[48:51], a[48:55], v3
  v_smfmac_f32_16x16x64_bf16 v[24:27], v[48:51], a[56:63], v3
  s_waitcnt lgkmcnt(4)
  v_smfmac_f32_16x16x64_bf16 v[16:19], v[52:55], v[72:79], v3
  ds_read_b128 v[72:75], v15 offset:6144
  ds_read_b128 v[76:79], v15 offset:7168
  v_smfmac_f32_16x16x64_bf16 v[20:23], v[52:55], a[64:71], v3
  v_smfmac_f32_16x16x64_bf16 v[24:27], v[52:55], a[72:79], v3
  ds_read_b128 v[52:55], v9 offset:2048
  s_waitcnt lgkmcnt(6)
  v_smfmac_f32_16x16x64_bf16 v[16:19], v[56:59], a[80:87], v3
  v_smfmac_f32_16x16x64_bf16 v[20:23], v[56:59], a[88:95], v3
  s_waitcnt lgkmcnt(3)
  v_smfmac_f32_16x16x64_bf16 v[24:27], v[56:59], v[64:71], v3
  ds_read_b128 v[64:67], v15 offset:8192
  ds_read_b128 v[68:71], v15 offset:9216
  ds_read_b128 v[56:59], v10 offset:0
  v_smfmac_f32_16x16x64_bf16 v[16:19], v[60:63], a[96:103], v3
  v_smfmac_f32_16x16x64_bf16 v[20:23], v[60:63], a[104:111], v3
  v_smfmac_f32_16x16x64_bf16 v[24:27], v[60:63], a[112:119], v3
  ds_read_b128 v[60:63], v10 offset:1024
  s_waitcnt lgkmcnt(4)
  v_smfmac_f32_16x16x64_bf16 v[16:19], v[52:55], a[120:127], v3
  v_smfmac_f32_16x16x64_bf16 v[20:23], v[52:55], v[72:79], v3
  ds_read_b128 v[72:75], v15 offset:10240
  ds_read_b128 v[76:79], v15 offset:11264
  v_smfmac_f32_16x16x64_bf16 v[24:27], v[52:55], a[128:135], v3
  ds_read_b128 v[52:55], v10 offset:2048
  s_waitcnt lgkmcnt(4)
  v_smfmac_f32_16x16x64_bf16 v[16:19], v[56:59], a[136:143], v3
  v_smfmac_f32_16x16x64_bf16 v[20:23], v[56:59], a[144:151], v3
  v_smfmac_f32_16x16x64_bf16 v[24:27], v[56:59], a[152:159], v3
  s_waitcnt lgkmcnt(3)
  v_smfmac_f32_16x16x64_bf16 v[16:19], v[60:63], v[64:71], v3
  ds_read_b128 v[64:67], v15 offset:12288
  ds_read_b128 v[68:71], v15 offset:13312
  v_smfmac_f32_16x16x64_bf16 v[20:23], v[60:63], a[160:167], v3
  s_waitcnt lgkmcnt(2)
  v_smfmac_f32_16x16x64_bf16 v[16:19], v[52:55], a[176:183], v3
  v_smfmac_f32_16x16x64_bf16 v[20:23], v[52:55], a[184:191], v3
  v_smfmac_f32_16x16x64_bf16 v[24:27], v[60:63], a[168:175], v3
  v_smfmac_f32_16x16x64_bf16 v[24:27], v[52:55], v[72:79], v3
  ds_read_b128 v[72:75], v15 offset:14336
  ds_read_b128 v[76:79], v15 offset:15360
  v_add_f32 v16, v16, v17
  v_add_f32 v18, v18, v19
  v_cvt_pk_bf16_f32 v16, v16, v18
  s_nop 1
  v_mov_b32_dpp v17, v16 quad_perm:[2,3,0,1] row_mask:0xf bank_mask:0xf
  v_perm_b32 v16, v17, v16, v28
  ds_write_b32 v11, v16
  v_add_f32 v20, v20, v21
  v_add_f32 v22, v22, v23
  v_cvt_pk_bf16_f32 v20, v20, v22
  s_nop 1
  v_mov_b32_dpp v21, v20 quad_perm:[2,3,0,1] row_mask:0xf bank_mask:0xf
  v_perm_b32 v20, v21, v20, v28
  ds_write_b32 v12, v20
  v_add_f32 v24, v24, v25
  v_add_f32 v26, v26, v27
  v_cvt_pk_bf16_f32 v24, v24, v26
  s_nop 1
  v_mov_b32_dpp v25, v24 quad_perm:[2,3,0,1] row_mask:0xf bank_mask:0xf
  v_perm_b32 v24, v25, v24, v28
  ds_write_b32 v29, v24
  s_waitcnt lgkmcnt(0)
  s_barrier
  ds_read_b64_tr_b16 v[40:41], v13 offset:0
  ds_read_b64_tr_b16 v[42:43], v13 offset:512
  ds_read_b64_tr_b16 v[44:45], v13 offset:1024
  ds_read_b64_tr_b16 v[46:47], v13 offset:1536
  ds_read_b64_tr_b16 v[48:49], v13 offset:2048
  ds_read_b64_tr_b16 v[50:51], v13 offset:2560
  s_waitcnt lgkmcnt(4)
  v_smfmac_f32_16x16x64_bf16 v[80:83], v[40:43], a[192:199], v3
  v_smfmac_f32_16x16x64_bf16 v[84:87], v[40:43], a[216:223], v3
  s_waitcnt lgkmcnt(2)
  v_smfmac_f32_16x16x64_bf16 v[80:83], v[44:47], a[200:207], v3
  v_smfmac_f32_16x16x64_bf16 v[84:87], v[44:47], v[64:71], v3
  ds_read_b128 v[64:67], v15 offset:16384
  ds_read_b128 v[68:71], v15 offset:17408
  s_waitcnt lgkmcnt(2)
  v_smfmac_f32_16x16x64_bf16 v[80:83], v[48:51], a[208:215], v3
  v_smfmac_f32_16x16x64_bf16 v[84:87], v[48:51], a[224:231], v3
  v_smfmac_f32_16x16x64_bf16 v[88:91], v[40:43], a[232:239], v3
  v_smfmac_f32_16x16x64_bf16 v[92:95], v[40:43], v[72:79], v3
  ds_read_b128 v[72:75], v15 offset:18432
  ds_read_b128 v[76:79], v15 offset:19456
  v_smfmac_f32_16x16x64_bf16 v[88:91], v[44:47], a[240:247], v3
  v_add_f32 v80, v80, v81
  v_add_f32 v82, v82, v83
  v_smfmac_f32_16x16x64_bf16 v[92:95], v[44:47], v[128:135], v3
  v_cvt_pk_bf16_f32 v16, v80, v82
  v_add_f32 v84, v84, v85
  v_smfmac_f32_16x16x64_bf16 v[88:91], v[48:51], a[248:255], v3
  v_add_f32 v86, v86, v87
  v_cvt_pk_bf16_f32 v17, v84, v86
  v_smfmac_f32_16x16x64_bf16 v[92:95], v[48:51], v[136:143], v3
  v_smfmac_f32_16x16x64_bf16 v[96:99], v[40:43], v[144:151], v3
  v_smfmac_f32_16x16x64_bf16 v[100:103], v[40:43], v[160:167], v3
  v_smfmac_f32_16x16x64_bf16 v[96:99], v[44:47], v[152:159], v3
  v_add_f32 v88, v88, v89
  v_add_f32 v90, v90, v91
  v_smfmac_f32_16x16x64_bf16 v[100:103], v[44:47], v[168:175], v3
  v_cvt_pk_bf16_f32 v18, v88, v90
  v_add_f32 v92, v92, v93
  s_waitcnt lgkmcnt(2)
  v_smfmac_f32_16x16x64_bf16 v[96:99], v[48:51], v[64:71], v3
  ds_read_b128 v[64:67], v15 offset:20480
  ds_read_b128 v[68:71], v15 offset:21504
  v_add_f32 v94, v94, v95
  v_cvt_pk_bf16_f32 v19, v92, v94
  v_smfmac_f32_16x16x64_bf16 v[100:103], v[48:51], v[176:183], v3
  v_permlane32_swap_b32 v16, v18
  v_permlane32_swap_b32 v17, v19
  v_smfmac_f32_16x16x64_bf16 v[104:107], v[40:43], v[184:191], v3
  s_nop 0
  v_permlane16_swap_b32 v16, v17
  v_permlane16_swap_b32 v18, v19
  v_smfmac_f32_16x16x64_bf16 v[108:111], v[40:43], v[200:207], v3
  buffer_store_dwordx4 v[16:19], v14, s[4:7], s28 offen sc1
  s_waitcnt lgkmcnt(2)
  v_smfmac_f32_16x16x64_bf16 v[104:107], v[44:47], v[72:79], v3
  ds_read_b128 v[72:75], v15 offset:22528
  ds_read_b128 v[76:79], v15 offset:23552
  v_add_f32 v96, v96, v97
  v_add_f32 v98, v98, v99
  v_smfmac_f32_16x16x64_bf16 v[108:111], v[44:47], v[208:215], v3
  v_cvt_pk_bf16_f32 v20, v96, v98
  v_add_f32 v100, v100, v101
  v_smfmac_f32_16x16x64_bf16 v[104:107], v[48:51], v[192:199], v3
  v_add_f32 v102, v102, v103
  v_cvt_pk_bf16_f32 v21, v100, v102
  v_smfmac_f32_16x16x64_bf16 v[108:111], v[48:51], v[216:223], v3
  s_waitcnt lgkmcnt(2)
  v_smfmac_f32_16x16x64_bf16 v[112:115], v[40:43], v[64:71], v3
  v_smfmac_f32_16x16x64_bf16 v[116:119], v[40:43], v[240:247], v3
  v_smfmac_f32_16x16x64_bf16 v[112:115], v[44:47], v[224:231], v3
  v_add_f32 v104, v104, v105
  v_add_f32 v106, v106, v107
  v_smfmac_f32_16x16x64_bf16 v[116:119], v[44:47], v[248:255], v3
  v_cvt_pk_bf16_f32 v22, v104, v106
  v_add_f32 v108, v108, v109
  v_smfmac_f32_16x16x64_bf16 v[112:115], v[48:51], v[232:239], v3
  v_add_f32 v110, v110, v111
  v_cvt_pk_bf16_f32 v23, v108, v110
  s_waitcnt lgkmcnt(0)
  v_smfmac_f32_16x16x64_bf16 v[116:119], v[48:51], v[72:79], v3
  v_permlane32_swap_b32 v20, v22
  v_permlane32_swap_b32 v21, v23
  s_add_u32 s20, s28, 65536
  s_nop 0
  v_permlane16_swap_b32 v20, v21
  v_permlane16_swap_b32 v22, v23
  buffer_store_dwordx4 v[20:23], v14, s[4:7], s20 offen sc1
  v_add_f32 v112, v112, v113
  v_add_f32 v114, v114, v115
  v_cvt_pk_bf16_f32 v24, v112, v114
  v_add_f32 v116, v116, v117
  v_add_f32 v118, v118, v119
  v_cvt_pk_bf16_f32 v25, v116, v118
  v_mov_b32 v26, v24
  v_mov_b32 v27, v25
  s_nop 0
  v_permlane32_swap_b32 v24, v26
  v_permlane32_swap_b32 v25, v27
  s_nop 1
  v_permlane16_swap_b32 v24, v25
  v_permlane16_swap_b32 v26, v27
  buffer_store_dwordx4 v[24:27], v0, s[4:7], s28 offen sc1
  s_lshl_b32 s21, s16, 2
  s_add_u32 s21, s21, 16384
  v_mov_b32 v40, s21
  v_mov_b32 v41, s63
  ds_write_b32 v40, v41
  s_add_u32 s18, s18, 1
  s_cmp_lt_u32 s18, s31
  s_cbranch_scc1 LBloop_44
  s_branch L_end
L_goR:
  s_load_dwordx2 s[8:9], s[0:1], 0
  s_mov_b32 s10, 0x280000
  s_mov_b32 s11, 0x00020000
  v_lshrrev_b32 v3, 6, v0
  v_and_b32 v1, 63, v0
  v_readfirstlane_b32 s16, v3
  v_lshlrev_b32 v2, 4, v1
  s_mov_b32 s19, 400000
  s_waitcnt lgkmcnt(0)
  v_and_b32 v3, 1, v1
  v_cmp_eq_u32 vcc, 0, v3
  v_mov_b32 v3, 0xeeeeeeee
  v_mov_b32 v7, 0x44444444
  v_cndmask_b32 v3, v3, v7, vcc
  s_lshr_b32 s21, s16, 1
  s_lshl_b32 s21, s21, 14
  s_and_b32 s20, s16, 1
  s_lshl_b32 s20, s20, 12
  s_add_u32 s20, s20, s21
  v_add_u32 v4, s20, v2
  v_lshrrev_b32 v8, 4, v1
  v_lshlrev_b32 v8, 8, v8
  v_and_b32 v9, 15, v1
  v_lshlrev_b32 v9, 3, v9
  v_add_u32 v8, v8, v9
  s_lshl_b32 s20, s16, 10
  s_add_u32 s20, s20, 32768
  v_add_u32 v5, s20, v8
  s_lshl_b32 s20, s17, 14
  s_lshl_b32 s21, s16, 11
  s_add_u32 s20, s20, s21
  v_add_u32 v6, s20, v2
  s_lshl_b32 s20, s17, 15
  s_lshl_b32 s21, s16, 13
  s_add_u32 s20, s20, s21
  v_add_u32 v10, s20, v2
  v_lshrrev_b32 v8, 4, v1
  v_lshlrev_b32 v8, 7, v8
  v_bfe_u32 v9, v1, 1, 1
  v_lshlrev_b32 v9, 5, v9
  v_add_u32 v8, v8, v9
  v_bfe_u32 v9, v1, 2, 2
  v_lshlrev_b32 v9, 3, v9
  v_add_u32 v8, v8, v9
  v_and_b32 v9, 1, v1
  v_lshlrev_b32 v9, 2, v9
  v_add_u32 v8, v8, v9
  s_lshl_b32 s20, s16, 9
  v_add_u32 v11, s20, v8
  v_lshlrev_b32 v12, 3, v1
  v_lshrrev_b32 v13, 2, v1
  v_lshlrev_b32 v13, 4, v13
  s_lshl_b32 s20, s17, 8
  s_add_u32 s21, s20, 8192
  s_cmp_ge_u32 s17, 32
  s_cselect_b32 s20, s21, s20
  v_add_u32 v13, s20, v13
  v_and_b32 v9, 3, v1
  v_cmp_eq_u32 vcc, 0, v9
  v_mul_u32_u24 v9, 32768, v9
  v_add_u32 v13, v13, v9
  v_mov_b32 v8, 0x7ff00000
  v_cndmask_b32 v13, v8, v13, vcc
  v_lshlrev_b32 v14, 2, v1
  s_lshl_b32 s20, s17, 8
  v_add_u32 v14, s20, v14
  s_lshl_b32 s20, s16, 11
  s_add_u32 s20, s20, 4096
  v_add_u32 v15, s20, v2
  v_and_b32 v8, 15, v1
  s_and_b32 s20, s16, 1
  s_lshl_b32 s20, s20, 4
  v_add_u32 v8, s20, v8
  v_mul_u32_u24 v8, 1280, v8
  v_lshrrev_b32 v9, 4, v1
  v_lshlrev_b32 v9, 3, v9
  s_lshl_b32 s20, s17, 5
  v_add_u32 v9, s20, v9
  v_add_u32 v28, v8, v9
  s_and_b32 s20, s16, 1
  s_lshl_b32 s20, s20, 10
  s_add_u32 s20, s20, 4096
  v_add_u32 v29, s20, v2
  v_mov_b32 v33, v9
  s_lshl_b32 s20, s17, 7
  v_mov_b32 v30, s20
  v_mov_b32 v8, 0x7ff00000
  v_cmp_eq_u32 vcc, 0, v1
  s_nop 1
  v_cndmask_b32 v30, v8, v30, vcc
  v_and_b32 v0, 31, v1
  v_lshlrev_b32 v0, 7, v0
  v_lshlrev_b32 v31, 7, v1
  s_mov_b32 s24, 0
  s_mov_b32 s25, -1
  s_mov_b32 s18, 0
  s_mov_b32 s30, 59244544
  s_mov_b32 s52, s32
  s_mov_b32 s53, s33
  s_mov_b32 s54, 256
  s_mov_b32 s55, 0x00020000
  s_cmp_lg_u32 s16, 0
  s_cbranch_scc1 Lwr_47
  v_lshrrev_b32 v16, 4, v2
  v_lshlrev_b32 v16, 7, v16
  v_mov_b32 v17, 196
  s_mov_b32 s51, 106496
  s_mov_b32 s50, 114688
Lwrt_48:
  buffer_load_dword v18, v16, s[4:7], s51 offen sc1
  buffer_load_dword v19, v16, s[4:7], s50 offen sc1
  buffer_load_dword v20, v17, s[52:55], 0 offen sc1
  s_waitcnt vmcnt(0)
  v_cmp_ne_u32 vcc, s70, v18
  s_cbranch_vccnz Lwra_50
  v_cmp_ne_u32 vcc, s70, v19
  s_cbranch_vccnz Lwra_50
  v_cmp_eq_u32 vcc, 0, v20
  s_cbranch_vccnz Lwra_50
  s_branch Lwrd_49
Lwra_50:
  s_sleep 2
  s_cmp_eq_u32 s19, 0
  s_cbranch_scc1 Lwrd_49
  s_sub_u32 s19, s19, 1
  s_branch Lwrt_48
Lwrd_49:
  v_mov_b32 v16, 0
  ds_write_b32 v16, v20 offset:10240
  s_waitcnt lgkmcnt(0)
Lwr_47:
  s_barrier
  v_mov_b32 v16, 0
  ds_read_b32 v17, v16 offset:10240
  s_waitcnt lgkmcnt(0)
  v_readfirstlane_b32 s50, v17
  s_barrier
  s_nop 2
  s_and_b32 s51, s50, 1
  s_lshl_b32 s51, s51, 13
  s_add_u32 s43, s43, s51
  s_and_b32 s51, s50, 2
  s_lshl_b32 s51, s51, 12
  s_add_u32 s39, s39, s51
  s_mov_b32 s20, 68096
  buffer_load_dwordx2 v[34:35], v33, s[4:7], s20 offen sc1
  s_waitcnt vmcnt(0)
  v_lshlrev_b32 v24, 16, v34
  v_and_b32 v25, 0xffff0000, v34
  v_lshlrev_b32 v26, 16, v35
  v_and_b32 v27, 0xffff0000, v35
  s_mov_b32 s23, 1
  s_add_u32 s22, s43, 360448
Lwf_51:
  buffer_load_dword v7, v0, s[4:7], s22 offen sc1
  s_waitcnt vmcnt(0)
  v_cmp_gt_u32 vcc, s23, v7
  s_cbranch_vccz Lwfd_52
  s_sleep 2
  s_cmp_eq_u32 s19, 0
  s_cbranch_scc1 Lwfd_52
  s_sub_u32 s19, s19, 1
  s_branch Lwf_51
Lwfd_52:
  buffer_load_dwordx4 a[0:3], v10, s[4:7], s30 offen offset:0 sc1
  buffer_load_dwordx4 a[4:7], v10, s[4:7], s30 offen offset:1024 sc1
  buffer_load_dwordx4 a[8:11], v10, s[4:7], s30 offen offset:2048 sc1
  buffer_load_dwordx4 a[12:15], v10, s[4:7], s30 offen offset:3072 sc1
  s_add_u32 s20, s30, 4096
  buffer_load_dwordx4 a[16:19], v10, s[4:7], s20 offen offset:0 sc1
  buffer_load_dwordx4 a[20:23], v10, s[4:7], s20 offen offset:1024 sc1
  buffer_load_dwordx4 a[24:27], v10, s[4:7], s20 offen offset:2048 sc1
  buffer_load_dwordx4 a[28:31], v10, s[4:7], s20 offen offset:3072 sc1
  s_mov_b32 s62, 0
  s_mov_b32 s60, 0
  s_mov_b32 s63, 1
  s_lshl_b32 s21, s16, 2
  s_add_u32 s21, s21, 16384
  v_mov_b32 v40, s21
  v_mov_b32 v41, s63
  ds_write_b32 v40, v41
  v_mov_b32 v92, -1
  v_mov_b32 v93, -1
  v_mov_b32 v94, -1
  v_mov_b32 v95, -1
  v_mov_b32 v99, 0
  v_mov_b32 v103, 0
LRloop_53:
  v_mov_b32 v16, 0
  v_mov_b32 v17, 0
  v_mov_b32 v18, 0
  v_mov_b32 v19, 0
  s_add_u32 s20, s18, 1
  s_and_b32 s20, s20, 3
  s_mul_i32 s20, s20, 32768
  s_add_u32 s26, s20, s43
  s_and_b32 s20, s18, 3
  s_mul_i32 s20, s20, 49152
  s_add_u32 s27, s20, s43
  s_add_u32 s27, s27, 131072
  s_and_b32 s20, s18, 1
  s_mul_i32 s20, s20, 655360
  s_add_u32 s28, s20, s39
  s_cmp_lt_u32 s18, 1
  s_cbranch_scc1 LRn0_54
  s_sub_u32 s36, s18, 1
  s_waitcnt vmcnt(9)
  v_cmp_gt_u32 vcc, s18, v99
  s_cbranch_vccz LRfp_55
  s_mov_b32 s23, s18
  s_add_u32 s22, s43, 327680
Lwf_56:
  buffer_load_dword v7, v31, s[4:7], s22 offen sc1
  s_waitcnt vmcnt(0)
  v_cmp_gt_u32 vcc, s23, v7
  s_cbranch_vccz Lwfd_57
  s_sleep 1
  s_cmp_eq_u32 s19, 0
  s_cbranch_scc1 Lwfd_57
  s_sub_u32 s19, s19, 1
  s_branch Lwf_56
Lwfd_57:
LRfp_55:
  s_and_b32 s34, s36, 3
  s_mul_i32 s34, s34, 163840
  s_add_u32 s34, s34, s43
  s_add_u32 s34, s34, 376832
  s_lshl_b32 s20, s16, 14
  s_add_u32 s20, s20, s34
  buffer_load_dwordx4 a[160:163], v2, s[4:7], s20 offen offset:0 sc1
  buffer_load_dwordx4 a[164:167], v2, s[4:7], s20 offen offset:1024 sc1
  buffer_load_dwordx4 a[168:171], v2, s[4:7], s20 offen offset:2048 sc1
  buffer_load_dwordx4 a[172:175], v2, s[4:7], s20 offen offset:3072 sc1
  s_add_u32 s20, s20, 4096
  buffer_load_dwordx4 a[176:179], v2, s[4:7], s20 offen offset:0 sc1
  buffer_load_dwordx4 a[180:183], v2, s[4:7], s20 offen offset:1024 sc1
  buffer_load_dwordx4 a[184:187], v2, s[4:7], s20 offen offset:2048 sc1
  buffer_load_dwordx4 a[188:191], v2, s[4:7], s20 offen offset:3072 sc1
  s_lshl_b32 s20, s16, 11
  s_add_u32 s20, s20, s34
  s_add_u32 s20, s20, 131072
  buffer_load_dwordx4 a[192:195], v2, s[4:7], s20 offen offset:0 sc1
  buffer_load_dwordx4 a[196:199], v2, s[4:7], s20 offen offset:1024 sc1
  s_lshl_b32 s20, s16, 14
  s_add_u32 s20, s20, s34
  s_add_u32 s20, s20, 65536
  buffer_load_dwordx4 a[200:203], v2, s[4:7], s20 offen offset:0 sc1
  buffer_load_dwordx4 a[204:207], v2, s[4:7], s20 offen offset:1024 sc1
  buffer_load_dwordx4 a[208:211], v2, s[4:7], s20 offen offset:2048 sc1
  buffer_load_dwordx4 a[212:215], v2, s[4:7], s20 offen offset:3072 sc1
  s_add_u32 s20, s20, 4096
  buffer_load_dwordx4 a[216:219], v2, s[4:7], s20 offen offset:0 sc1
  buffer_load_dwordx4 a[220:223], v2, s[4:7], s20 offen offset:1024 sc1
  buffer_load_dwordx4 a[224:227], v2, s[4:7], s20 offen offset:2048 sc1
  buffer_load_dwordx4 a[228:231], v2, s[4:7], s20 offen offset:3072 sc1
  s_lshl_b32 s20, s16, 11
  s_add_u32 s20, s20, s34
  s_add_u32 s20, s20, 147456
  buffer_load_dwordx4 a[232:235], v2, s[4:7], s20 offen offset:0 sc1
  buffer_load_dwordx4 a[236:239], v2, s[4:7], s20 offen offset:1024 sc1
LRn0_54:
  s_sleep 1
  buffer_load_dwordx4 v[64:67], v6, s[4:7], s28 offen sc1
  buffer_load_dwordx4 v[68:71], v6, s[4:7], s28 offen offset:1024 sc1
  s_waitcnt vmcnt(0)
  v_max3_u32 v7, v67, v71, v67
  v_cmp_eq_u32 vcc, -1, v7
  s_cbranch_vccz Lzok_60
  buffer_load_dwordx4 v[64:67], v6, s[4:7], s28 offen sc1
  buffer_load_dwordx4 v[68:71], v6, s[4:7], s28 offen offset:1024 sc1
Lzt_61:
  buffer_load_dwordx4 v[64:67], v6, s[4:7], s28 offen sc1
  buffer_load_dwordx4 v[68:71], v6, s[4:7], s28 offen offset:1024 sc1
  s_waitcnt vmcnt(2)
  v_max3_u32 v7, v64, v65, v66
  v_max3_u32 v7, v7, v67, v68
  v_max3_u32 v7, v7, v69, v70
  v_max_u32 v7, v7, v71
  v_cmp_eq_u32 vcc, -1, v7
  s_cbranch_vccz Lzok_60
  s_cmp_eq_u32 s19, 0
  s_cbranch_scc1 Lzok_60
  s_sub_u32 s19, s19, 1
  s_branch Lzt_61
Lzok_60:
Lcl_58:
  buffer_load_dwordx4 v[128:131], v4, s[4:7], s27 offen offset:0 sc1
  buffer_load_dwordx4 v[132:135], v4, s[4:7], s27 offen offset:1024 sc1
  buffer_load_dwordx4 v[136:139], v4, s[4:7], s27 offen offset:2048 sc1
  buffer_load_dwordx4 v[140:143], v4, s[4:7], s27 offen offset:3072 sc1
  buffer_load_dwordx2 v[144:145], v5, s[4:7], s27 offen offset:0 sc1
  buffer_load_dwordx2 v[146:147], v5, s[4:7], s27 offen offset:128 sc1
  s_waitcnt vmcnt(0)
  v_max3_u32 v7, v131, v135, v139
  v_max3_u32 v7, v7, v143, v145
  v_max_u32 v7, v7, v147
  v_cmp_eq_u32 vcc, -1, v7
  s_cbranch_vccz Lclok_59
  s_cmp_eq_u32 s19, 0
  s_cbranch_scc1 Lclok_59
  s_sub_u32 s19, s19, 1
  s_branch Lcl_58
Lclok_59:
  s_mov_b32 s63, 1
  v_smfmac_f32_16x16x64_bf16 v[16:19], v[144:147], v[64:71], v3
  v_smfmac_f32_16x16x64_bf16 v[16:19], v[128:131], a[0:7], v3
  v_smfmac_f32_16x16x64_bf16 v[16:19], v[132:135], a[8:15], v3
  v_smfmac_f32_16x16x64_bf16 v[16:19], v[136:139], a[16:23], v3
  v_smfmac_f32_16x16x64_bf16 v[16:19], v[140:143], a[24:31], v3
  s_add_u32 s20, s43, 360448
  buffer_load_dword v103, v0, s[4:7], s20 offen sc1
  s_nop 5
  v_add_f32 v16, v16, v17
  v_add_f32 v18, v18, v19
  ds_write2_b32 v11, v16, v18 offset0:0 offset1:16
  s_waitcnt lgkmcnt(0)
  s_barrier
  s_cmp_lg_u32 s16, 0
  s_cbranch_scc1 LRw_62
  ds_read_b64 v[20:21], v12 offset:0
  ds_read_b64 v[22:23], v12 offset:512
  ds_read_b64 v[32:33], v12 offset:1024
  ds_read_b64 v[34:35], v12 offset:1536
  s_waitcnt lgkmcnt(0)
  v_add_f32 v20, v20, v22
  v_add_f32 v21, v21, v23
  v_add_f32 v32, v32, v34
  v_add_f32 v33, v33, v35
  v_add_f32 v20, v20, v32
  v_add_f32 v21, v21, v33
  v_cvt_pk_bf16_f32 v32, v20, v21
  s_nop 1
  v_mov_b32_dpp v20, v32 quad_perm:[0,0,0,0] row_mask:0xf bank_mask:0xf
  v_mov_b32_dpp v21, v32 quad_perm:[1,1,1,1] row_mask:0xf bank_mask:0xf
  v_mov_b32_dpp v22, v32 quad_perm:[2,2,2,2] row_mask:0xf bank_mask:0xf
  v_mov_b32_dpp v23, v32 quad_perm:[3,3,3,3] row_mask:0xf bank_mask:0xf
  buffer_store_dwordx4 v[20:23], v13, s[4:7], s26 offen sc1
LRw_62:
  s_barrier
  v_accvgpr_write_b32 a32, v64
  v_accvgpr_write_b32 a33, v65
  v_accvgpr_write_b32 a34, v66
  v_accvgpr_write_b32 a35, v67
  v_accvgpr_write_b32 a36, v68
  v_accvgpr_write_b32 a37, v69
  v_accvgpr_write_b32 a38, v70
  v_accvgpr_write_b32 a39, v71
  s_add_u32 s23, s18, 2
  s_min_u32 s23, s23, 64
  v_cmp_gt_u32 vcc, s23, v103
  s_cbranch_vccz LRok_63
  s_add_u32 s22, s43, 360448
Lwf_64:
  buffer_load_dword v7, v0, s[4:7], s22 offen sc1
  s_waitcnt vmcnt(0)
  v_cmp_gt_u32 vcc, s23, v7
  s_cbranch_vccz Lwfd_65
  s_sleep 2
  s_cmp_eq_u32 s19, 0
  s_cbranch_scc1 Lwfd_65
  s_sub_u32 s19, s19, 1
  s_branch Lwf_64
Lwfd_65:
LRok_63:
  s_cmp_lg_u32 s16, 1
  s_cbranch_scc1 LRq_66
  s_and_b32 s20, s18, 3
  s_mul_i32 s20, s20, 32768
  s_add_u32 s20, s20, s43
  buffer_store_dwordx4 v[92:95], v13, s[4:7], s20 offen sc1
LRq_66:
  s_cmp_lg_u32 s16, 2
  s_cbranch_scc1 LRx_67
  s_cmp_lt_u32 s18, 2
  s_cbranch_scc1 LRx_67
  s_sub_u32 s21, s18, 1
  v_mov_b32 v102, s21
  s_add_u32 s20, s43, 344064
  buffer_store_dword v102, v30, s[4:7], s20 offen sc1
LRx_67:
  buffer_store_dwordx4 v[92:95], v6, s[4:7], s28 offen sc1
  buffer_store_dwordx4 v[92:95], v6, s[4:7], s28 offen offset:1024 sc1
  s_add_u32 s20, s43, 327680
  buffer_load_dword v99, v31, s[4:7], s20 offen sc1
  s_add_u32 s30, s30, 1310720
  buffer_load_dwordx4 a[40:43], v10, s[4:7], s30 offen offset:0 sc1
  buffer_load_dwordx4 a[44:47], v10, s[4:7], s30 offen offset:1024 sc1
  buffer_load_dwordx4 a[48:51], v10, s[4:7], s30 offen offset:2048 sc1
  buffer_load_dwordx4 a[52:55], v10, s[4:7], s30 offen offset:3072 sc1
  s_add_u32 s20, s30, 4096
  buffer_load_dwordx4 a[56:59], v10, s[4:7], s20 offen offset:0 sc1
  buffer_load_dwordx4 a[60:63], v10, s[4:7], s20 offen offset:1024 sc1
  buffer_load_dwordx4 a[64:67], v10, s[4:7], s20 offen offset:2048 sc1
  buffer_load_dwordx4 a[68:71], v10, s[4:7], s20 offen offset:3072 sc1
  s_lshl_b32 s21, s16, 2
  s_add_u32 s21, s21, 16384
  v_mov_b32 v40, s21
  v_mov_b32 v41, s63
  ds_write_b32 v40, v41
  s_cmp_lt_u32 s18, 1
  s_cbranch_scc1 LRns_68
  v_mov_b32 v100, v96
  v_mov_b32 v101, v97
  v_mfma_f32_16x16x32_bf16 v[104:107], a[120:123], a[160:163], 0
  v_mfma_f32_16x16x32_bf16 v[104:107], a[124:127], a[164:167], v[104:107]
  v_mfma_f32_16x16x32_bf16 v[104:107], a[128:131], a[168:171], v[104:107]
  v_mfma_f32_16x16x32_bf16 v[104:107], a[132:135], a[172:175], v[104:107]
  v_mfma_f32_16x16x32_bf16 v[104:107], a[136:139], a[176:179], v[104:107]
  v_mfma_f32_16x16x32_bf16 v[104:107], a[140:143], a[180:183], v[104:107]
  v_mfma_f32_16x16x32_bf16 v[104:107], a[144:147], a[184:187], v[104:107]
  v_mfma_f32_16x16x32_bf16 v[104:107], a[148:151], a[188:191], v[104:107]
  v_mfma_f32_16x16x32_bf16 v[104:107], a[152:155], a[192:195], v[104:107]
  v_mfma_f32_16x16x32_bf16 v[104:107], a[156:159], a[196:199], v[104:107]
  v_mfma_f32_16x16x32_bf16 v[108:111], a[120:123], a[200:203], 0
  v_mfma_f32_16x16x32_bf16 v[108:111], a[124:127], a[204:207], v[108:111]
  v_mfma_f32_16x16x32_bf16 v[108:111], a[128:131], a[208:211], v[108:111]
  v_mfma_f32_16x16x32_bf16 v[108:111], a[132:135], a[212:215], v[108:111]
  v_mfma_f32_16x16x32_bf16 v[108:111], a[136:139], a[216:219], v[108:111]
  v_mfma_f32_16x16x32_bf16 v[108:111], a[140:143], a[220:223], v[108:111]
  v_mfma_f32_16x16x32_bf16 v[108:111], a[144:147], a[224:227], v[108:111]
  v_mfma_f32_16x16x32_bf16 v[108:111], a[148:151], a[228:231], v[108:111]
  v_mfma_f32_16x16x32_bf16 v[108:111], a[152:155], a[232:235], v[108:111]
  v_mfma_f32_16x16x32_bf16 v[108:111], a[156:159], a[236:239], v[108:111]
  ds_write_b128 v15, v[104:107]
  s_nop 6
  ds_write_b128 v15, v[108:111] offset:1024
  s_waitcnt lgkmcnt(0)
  s_barrier
  s_cmp_ge_u32 s16, 2
  s_cbranch_scc1 LRs_69
  ds_read_b128 v[104:107], v29 offset:0
  ds_read_b128 v[108:111], v29 offset:2048
  ds_read_b128 v[112:115], v29 offset:4096
  ds_read_b128 v[116:119], v29 offset:6144
  s_waitcnt lgkmcnt(0)
  v_add_f32 v104, v104, v108
  v_add_f32 v112, v112, v116
  v_add_f32 v104, v104, v112
  v_add_f32 v105, v105, v109
  v_add_f32 v113, v113, v117
  v_add_f32 v105, v105, v113
  v_add_f32 v106, v106, v110
  v_add_f32 v114, v114, v118
  v_add_f32 v106, v106, v114
  v_add_f32 v107, v107, v111
  v_add_f32 v115, v115, v119
  v_add_f32 v107, v107, v115
  v_lshlrev_b32 v108, 16, v100
  v_and_b32 v109, 0xffff0000, v100
  v_lshlrev_b32 v110, 16, v101
  v_and_b32 v111, 0xffff0000, v101
  v_fmac_f32 v108, v24, v104
  v_fmac_f32 v109, v25, v105
  v_fmac_f32 v110, v26, v106
  v_fmac_f32 v111, v27, v107
  v_cvt_pk_bf16_f32 v100, v108, v109
  v_cvt_pk_bf16_f32 v101, v110, v111
  s_mul_i32 s35, s36, 40960
  s_add_u32 s35, s35, 148373504
  buffer_store_dwordx2 v[100:101], v28, s[4:7], s35 offen sc1
LRs_69:
LRns_68:
  s_add_u32 s35, s18, 0
  s_mul_i32 s35, s35, 40960
  buffer_load_dwordx2 v[96:97], v28, s[8:11], s35 offen
  s_add_u32 s18, s18, 1
  v_mov_b32 v16, 0
  v_mov_b32 v17, 0
  v_mov_b32 v18, 0
  v_mov_b32 v19, 0
  s_add_u32 s20, s18, 1
  s_and_b32 s20, s20, 3
  s_mul_i32 s20, s20, 32768
  s_add_u32 s26, s20, s43
  s_and_b32 s20, s18, 3
  s_mul_i32 s20, s20, 49152
  s_add_u32 s27, s20, s43
  s_add_u32 s27, s27, 131072
  s_and_b32 s20, s18, 1
  s_mul_i32 s20, s20, 655360
  s_add_u32 s28, s20, s39
  s_cmp_lt_u32 s18, 1
  s_cbranch_scc1 LRn0_70
  s_sub_u32 s36, s18, 1
  s_waitcnt vmcnt(9)
  v_cmp_gt_u32 vcc, s18, v99
  s_cbranch_vccz LRfp_71
  s_mov_b32 s23, s18
  s_add_u32 s22, s43, 327680
Lwf_72:
  buffer_load_dword v7, v31, s[4:7], s22 offen sc1
  s_waitcnt vmcnt(0)
  v_cmp_gt_u32 vcc, s23, v7
  s_cbranch_vccz Lwfd_73
  s_sleep 1
  s_cmp_eq_u32 s19, 0
  s_cbranch_scc1 Lwfd_73
  s_sub_u32 s19, s19, 1
  s_branch Lwf_72
Lwfd_73:
LRfp_71:
  s_and_b32 s34, s36, 3
  s_mul_i32 s34, s34, 163840
  s_add_u32 s34, s34, s43
  s_add_u32 s34, s34, 376832
  s_lshl_b32 s20, s16, 14
  s_add_u32 s20, s20, s34
  buffer_load_dwordx4 a[160:163], v2, s[4:7], s20 offen offset:0 sc1
  buffer_load_dwordx4 a[164:167], v2, s[4:7], s20 offen offset:1024 sc1
  buffer_load_dwordx4 a[168:171], v2, s[4:7], s20 offen offset:2048 sc1
  buffer_load_dwordx4 a[172:175], v2, s[4:7], s20 offen offset:3072 sc1
  s_add_u32 s20, s20, 4096
  buffer_load_dwordx4 a[176:179], v2, s[4:7], s20 offen offset:0 sc1
  buffer_load_dwordx4 a[180:183], v2, s[4:7], s20 offen offset:1024 sc1
  buffer_load_dwordx4 a[184:187], v2, s[4:7], s20 offen offset:2048 sc1
  buffer_load_dwordx4 a[188:191], v2, s[4:7], s20 offen offset:3072 sc1
  s_lshl_b32 s20, s16, 11
  s_add_u32 s20, s20, s34
  s_add_u32 s20, s20, 131072
  buffer_load_dwordx4 a[192:195], v2, s[4:7], s20 offen offset:0 sc1
  buffer_load_dwordx4 a[196:199], v2, s[4:7], s20 offen offset:1024 sc1
  s_lshl_b32 s20, s16, 14
  s_add_u32 s20, s20, s34
  s_add_u32 s20, s20, 65536
  buffer_load_dwordx4 a[200:203], v2, s[4:7], s20 offen offset:0 sc1
  buffer_load_dwordx4 a[204:207], v2, s[4:7], s20 offen offset:1024 sc1
  buffer_load_dwordx4 a[208:211], v2, s[4:7], s20 offen offset:2048 sc1
  buffer_load_dwordx4 a[212:215], v2, s[4:7], s20 offen offset:3072 sc1
  s_add_u32 s20, s20, 4096
  buffer_load_dwordx4 a[216:219], v2, s[4:7], s20 offen offset:0 sc1
  buffer_load_dwordx4 a[220:223], v2, s[4:7], s20 offen offset:1024 sc1
  buffer_load_dwordx4 a[224:227], v2, s[4:7], s20 offen offset:2048 sc1
  buffer_load_dwordx4 a[228:231], v2, s[4:7], s20 offen offset:3072 sc1
  s_lshl_b32 s20, s16, 11
  s_add_u32 s20, s20, s34
  s_add_u32 s20, s20, 147456
  buffer_load_dwordx4 a[232:235], v2, s[4:7], s20 offen offset:0 sc1
  buffer_load_dwordx4 a[236:239], v2, s[4:7], s20 offen offset:1024 sc1
LRn0_70:
  s_sleep 1
  buffer_load_dwordx4 v[64:67], v6, s[4:7], s28 offen sc1
  buffer_load_dwordx4 v[68:71], v6, s[4:7], s28 offen offset:1024 sc1
  s_waitcnt vmcnt(0)
  v_max3_u32 v7, v67, v71, v67
  v_cmp_eq_u32 vcc, -1, v7
  s_cbranch_vccz Lzok_76
  buffer_load_dwordx4 v[64:67], v6, s[4:7], s28 offen sc1
  buffer_load_dwordx4 v[68:71], v6, s[4:7], s28 offen offset:1024 sc1
Lzt_77:
  buffer_load_dwordx4 v[64:67], v6, s[4:7], s28 offen sc1
  buffer_load_dwordx4 v[68:71], v6, s[4:7], s28 offen offset:1024 sc1
  s_waitcnt vmcnt(2)
  v_max3_u32 v7, v64, v65, v66
  v_max3_u32 v7, v7, v67, v68
  v_max3_u32 v7, v7, v69, v70
  v_max_u32 v7, v7, v71
  v_cmp_eq_u32 vcc, -1, v7
  s_cbranch_vccz Lzok_76
  s_cmp_eq_u32 s19, 0
  s_cbranch_scc1 Lzok_76
  s_sub_u32 s19, s19, 1
  s_branch Lzt_77
Lzok_76:
Lcl_74:
  buffer_load_dwordx4 v[128:131], v4, s[4:7], s27 offen offset:0 sc1
  buffer_load_dwordx4 v[132:135], v4, s[4:7], s27 offen offset:1024 sc1
  buffer_load_dwordx4 v[136:139], v4, s[4:7], s27 offen offset:2048 sc1
  buffer_load_dwordx4 v[140:143], v4, s[4:7], s27 offen offset:3072 sc1
  buffer_load_dwordx2 v[144:145], v5, s[4:7], s27 offen offset:0 sc1
  buffer_load_dwordx2 v[146:147], v5, s[4:7], s27 offen offset:128 sc1
  s_waitcnt vmcnt(0)
  v_max3_u32 v7, v131, v135, v139
  v_max3_u32 v7, v7, v143, v145
  v_max_u32 v7, v7, v147
  v_cmp_eq_u32 vcc, -1, v7
  s_cbranch_vccz Lclok_75
  s_cmp_eq_u32 s19, 0
  s_cbranch_scc1 Lclok_75
  s_sub_u32 s19, s19, 1
  s_branch Lcl_74
Lclok_75:
  s_mov_b32 s63, 1
  v_smfmac_f32_16x16x64_bf16 v[16:19], v[144:147], v[64:71], v3
  v_smfmac_f32_16x16x64_bf16 v[16:19], v[128:131], a[40:47], v3
  v_smfmac_f32_16x16x64_bf16 v[16:19], v[132:135], a[48:55], v3
  v_smfmac_f32_16x16x64_bf16 v[16:19], v[136:139], a[56:63], v3
  v_smfmac_f32_16x16x64_bf16 v[16:19], v[140:143], a[64:71], v3
  s_add_u32 s20, s43, 360448
  buffer_load_dword v103, v0, s[4:7], s20 offen sc1
  s_nop 5
  v_add_f32 v16, v16, v17
  v_add_f32 v18, v18, v19
  ds_write2_b32 v11, v16, v18 offset0:0 offset1:16
  s_waitcnt lgkmcnt(0)
  s_barrier
  s_cmp_lg_u32 s16, 0
  s_cbranch_scc1 LRw_78
  ds_read_b64 v[20:21], v12 offset:0
  ds_read_b64 v[22:23], v12 offset:512
  ds_read_b64 v[32:33], v12 offset:1024
  ds_read_b64 v[34:35], v12 offset:1536
  s_waitcnt lgkmcnt(0)
  v_add_f32 v20, v20, v22
  v_add_f32 v21, v21, v23
  v_add_f32 v32, v32, v34
  v_add_f32 v33, v33, v35
  v_add_f32 v20, v20, v32
  v_add_f32 v21, v21, v33
  v_cvt_pk_bf16_f32 v32, v20, v21
  s_nop 1
  v_mov_b32_dpp v20, v32 quad_perm:[0,0,0,0] row_mask:0xf bank_mask:0xf
  v_mov_b32_dpp v21, v32 quad_perm:[1,1,1,1] row_mask:0xf bank_mask:0xf
  v_mov_b32_dpp v22, v32 quad_perm:[2,2,2,2] row_mask:0xf bank_mask:0xf
  v_mov_b32_dpp v23, v32 quad_perm:[3,3,3,3] row_mask:0xf bank_mask:0xf
  buffer_store_dwordx4 v[20:23], v13, s[4:7], s26 offen sc1
LRw_78:
  s_barrier
  v_accvgpr_write_b32 a72, v64
  v_accvgpr_write_b32 a73, v65
  v_accvgpr_write_b32 a74, v66
  v_accvgpr_write_b32 a75, v67
  v_accvgpr_write_b32 a76, v68
  v_accvgpr_write_b32 a77, v69
  v_accvgpr_write_b32 a78, v70
  v_accvgpr_write_b32 a79, v71
  s_add_u32 s23, s18, 2
  s_min_u32 s23, s23, 64
  v_cmp_gt_u32 vcc, s23, v103
  s_cbranch_vccz LRok_79
  s_add_u32 s22, s43, 360448
Lwf_80:
  buffer_load_dword v7, v0, s[4:7], s22 offen sc1
  s_waitcnt vmcnt(0)
  v_cmp_gt_u32 vcc, s23, v7
  s_cbranch_vccz Lwfd_81
  s_sleep 2
  s_cmp_eq_u32 s19, 0
  s_cbranch_scc1 Lwfd_81
  s_sub_u32 s19, s19, 1
  s_branch Lwf_80
Lwfd_81:
LRok_79:
  s_cmp_lg_u32 s16, 1
  s_cbranch_scc1 LRq_82
  s_and_b32 s20, s18, 3
  s_mul_i32 s20, s20, 32768
  s_add_u32 s20, s20, s43
  buffer_store_dwordx4 v[92:95], v13, s[4:7], s20 offen sc1
LRq_82:
  s_cmp_lg_u32 s16, 2
  s_cbranch_scc1 LRx_83
  s_cmp_lt_u32 s18, 2
  s_cbranch_scc1 LRx_83
  s_sub_u32 s21, s18, 1
  v_mov_b32 v102, s21
  s_add_u32 s20, s43, 344064
  buffer_store_dword v102, v30, s[4:7], s20 offen sc1
LRx_83:
  buffer_store_dwordx4 v[92:95], v6, s[4:7], s28 offen sc1
  buffer_store_dwordx4 v[92:95], v6, s[4:7], s28 offen offset:1024 sc1
  s_add_u32 s20, s43, 327680
  buffer_load_dword v99, v31, s[4:7], s20 offen sc1
  s_add_u32 s30, s30, 1310720
  buffer_load_dwordx4 a[80:83], v10, s[4:7], s30 offen offset:0 sc1
  buffer_load_dwordx4 a[84:87], v10, s[4:7], s30 offen offset:1024 sc1
  buffer_load_dwordx4 a[88:91], v10, s[4:7], s30 offen offset:2048 sc1
  buffer_load_dwordx4 a[92:95], v10, s[4:7], s30 offen offset:3072 sc1
  s_add_u32 s20, s30, 4096
  buffer_load_dwordx4 a[96:99], v10, s[4:7], s20 offen offset:0 sc1
  buffer_load_dwordx4 a[100:103], v10, s[4:7], s20 offen offset:1024 sc1
  buffer_load_dwordx4 a[104:107], v10, s[4:7], s20 offen offset:2048 sc1
  buffer_load_dwordx4 a[108:111], v10, s[4:7], s20 offen offset:3072 sc1
  s_lshl_b32 s21, s16, 2
  s_add_u32 s21, s21, 16384
  v_mov_b32 v40, s21
  v_mov_b32 v41, s63
  ds_write_b32 v40, v41
  s_cmp_lt_u32 s18, 1
  s_cbranch_scc1 LRns_84
  v_mov_b32 v100, v96
  v_mov_b32 v101, v97
  v_mfma_f32_16x16x32_bf16 v[104:107], a[0:3], a[160:163], 0
  v_mfma_f32_16x16x32_bf16 v[104:107], a[4:7], a[164:167], v[104:107]
  v_mfma_f32_16x16x32_bf16 v[104:107], a[8:11], a[168:171], v[104:107]
  v_mfma_f32_16x16x32_bf16 v[104:107], a[12:15], a[172:175], v[104:107]
  v_mfma_f32_16x16x32_bf16 v[104:107], a[16:19], a[176:179], v[104:107]
  v_mfma_f32_16x16x32_bf16 v[104:107], a[20:23], a[180:183], v[104:107]
  v_mfma_f32_16x16x32_bf16 v[104:107], a[24:27], a[184:187], v[104:107]
  v_mfma_f32_16x16x32_bf16 v[104:107], a[28:31], a[188:191], v[104:107]
  v_mfma_f32_16x16x32_bf16 v[104:107], a[32:35], a[192:195], v[104:107]
  v_mfma_f32_16x16x32_bf16 v[104:107], a[36:39], a[196:199], v[104:107]
  v_mfma_f32_16x16x32_bf16 v[108:111], a[0:3], a[200:203], 0
  v_mfma_f32_16x16x32_bf16 v[108:111], a[4:7], a[204:207], v[108:111]
  v_mfma_f32_16x16x32_bf16 v[108:111], a[8:11], a[208:211], v[108:111]
  v_mfma_f32_16x16x32_bf16 v[108:111], a[12:15], a[212:215], v[108:111]
  v_mfma_f32_16x16x32_bf16 v[108:111], a[16:19], a[216:219], v[108:111]
  v_mfma_f32_16x16x32_bf16 v[108:111], a[20:23], a[220:223], v[108:111]
  v_mfma_f32_16x16x32_bf16 v[108:111], a[24:27], a[224:227], v[108:111]
  v_mfma_f32_16x16x32_bf16 v[108:111], a[28:31], a[228:231], v[108:111]
  v_mfma_f32_16x16x32_bf16 v[108:111], a[32:35], a[232:235], v[108:111]
  v_mfma_f32_16x16x32_bf16 v[108:111], a[36:39], a[236:239], v[108:111]
  ds_write_b128 v15, v[104:107]
  s_nop 6
  ds_write_b128 v15, v[108:111] offset:1024
  s_waitcnt lgkmcnt(0)
  s_barrier
  s_cmp_ge_u32 s16, 2
  s_cbranch_scc1 LRs_85
  ds_read_b128 v[104:107], v29 offset:0
  ds_read_b128 v[108:111], v29 offset:2048
  ds_read_b128 v[112:115], v29 offset:4096
  ds_read_b128 v[116:119], v29 offset:6144
  s_waitcnt lgkmcnt(0)
  v_add_f32 v104, v104, v108
  v_add_f32 v112, v112, v116
  v_add_f32 v104, v104, v112
  v_add_f32 v105, v105, v109
  v_add_f32 v113, v113, v117
  v_add_f32 v105, v105, v113
  v_add_f32 v106, v106, v110
  v_add_f32 v114, v114, v118
  v_add_f32 v106, v106, v114
  v_add_f32 v107, v107, v111
  v_add_f32 v115, v115, v119
  v_add_f32 v107, v107, v115
  v_lshlrev_b32 v108, 16, v100
  v_and_b32 v109, 0xffff0000, v100
  v_lshlrev_b32 v110, 16, v101
  v_and_b32 v111, 0xffff0000, v101
  v_fmac_f32 v108, v24, v104
  v_fmac_f32 v109, v25, v105
  v_fmac_f32 v110, v26, v106
  v_fmac_f32 v111, v27, v107
  v_cvt_pk_bf16_f32 v100, v108, v109
  v_cvt_pk_bf16_f32 v101, v110, v111
  s_mul_i32 s35, s36, 40960
  s_add_u32 s35, s35, 148373504
  buffer_store_dwordx2 v[100:101], v28, s[4:7], s35 offen sc1
LRs_85:
LRns_84:
  s_add_u32 s35, s18, 0
  s_mul_i32 s35, s35, 40960
  buffer_load_dwordx2 v[96:97], v28, s[8:11], s35 offen
  s_add_u32 s18, s18, 1
  v_mov_b32 v16, 0
  v_mov_b32 v17, 0
  v_mov_b32 v18, 0
  v_mov_b32 v19, 0
  s_add_u32 s20, s18, 1
  s_and_b32 s20, s20, 3
  s_mul_i32 s20, s20, 32768
  s_add_u32 s26, s20, s43
  s_and_b32 s20, s18, 3
  s_mul_i32 s20, s20, 49152
  s_add_u32 s27, s20, s43
  s_add_u32 s27, s27, 131072
  s_and_b32 s20, s18, 1
  s_mul_i32 s20, s20, 655360
  s_add_u32 s28, s20, s39
  s_cmp_lt_u32 s18, 1
  s_cbranch_scc1 LRn0_86
  s_sub_u32 s36, s18, 1
  s_waitcnt vmcnt(9)
  v_cmp_gt_u32 vcc, s18, v99
  s_cbranch_vccz LRfp_87
  s_mov_b32 s23, s18
  s_add_u32 s22, s43, 327680
Lwf_88:
  buffer_load_dword v7, v31, s[4:7], s22 offen sc1
  s_waitcnt vmcnt(0)
  v_cmp_gt_u32 vcc, s23, v7
  s_cbranch_vccz Lwfd_89
  s_sleep 1
  s_cmp_eq_u32 s19, 0
  s_cbranch_scc1 Lwfd_89
  s_sub_u32 s19, s19, 1
  s_branch Lwf_88
Lwfd_89:
LRfp_87:
  s_and_b32 s34, s36, 3
  s_mul_i32 s34, s34, 163840
  s_add_u32 s34, s34, s43
  s_add_u32 s34, s34, 376832
  s_lshl_b32 s20, s16, 14
  s_add_u32 s20, s20, s34
  buffer_load_dwordx4 a[160:163], v2, s[4:7], s20 offen offset:0 sc1
  buffer_load_dwordx4 a[164:167], v2, s[4:7], s20 offen offset:1024 sc1
  buffer_load_dwordx4 a[168:171], v2, s[4:7], s20 offen offset:2048 sc1
  buffer_load_dwordx4 a[172:175], v2, s[4:7], s20 offen offset:3072 sc1
  s_add_u32 s20, s20, 4096
  buffer_load_dwordx4 a[176:179], v2, s[4:7], s20 offen offset:0 sc1
  buffer_load_dwordx4 a[180:183], v2, s[4:7], s20 offen offset:1024 sc1
  buffer_load_dwordx4 a[184:187], v2, s[4:7], s20 offen offset:2048 sc1
  buffer_load_dwordx4 a[188:191], v2, s[4:7], s20 offen offset:3072 sc1
  s_lshl_b32 s20, s16, 11
  s_add_u32 s20, s20, s34
  s_add_u32 s20, s20, 131072
  buffer_load_dwordx4 a[192:195], v2, s[4:7], s20 offen offset:0 sc1
  buffer_load_dwordx4 a[196:199], v2, s[4:7], s20 offen offset:1024 sc1
  s_lshl_b32 s20, s16, 14
  s_add_u32 s20, s20, s34
  s_add_u32 s20, s20, 65536
  buffer_load_dwordx4 a[200:203], v2, s[4:7], s20 offen offset:0 sc1
  buffer_load_dwordx4 a[204:207], v2, s[4:7], s20 offen offset:1024 sc1
  buffer_load_dwordx4 a[208:211], v2, s[4:7], s20 offen offset:2048 sc1
  buffer_load_dwordx4 a[212:215], v2, s[4:7], s20 offen offset:3072 sc1
  s_add_u32 s20, s20, 4096
  buffer_load_dwordx4 a[216:219], v2, s[4:7], s20 offen offset:0 sc1
  buffer_load_dwordx4 a[220:223], v2, s[4:7], s20 offen offset:1024 sc1
  buffer_load_dwordx4 a[224:227], v2, s[4:7], s20 offen offset:2048 sc1
  buffer_load_dwordx4 a[228:231], v2, s[4:7], s20 offen offset:3072 sc1
  s_lshl_b32 s20, s16, 11
  s_add_u32 s20, s20, s34
  s_add_u32 s20, s20, 147456
  buffer_load_dwordx4 a[232:235], v2, s[4:7], s20 offen offset:0 sc1
  buffer_load_dwordx4 a[236:239], v2, s[4:7], s20 offen offset:1024 sc1
LRn0_86:
  s_sleep 1
  buffer_load_dwordx4 v[64:67], v6, s[4:7], s28 offen sc1
  buffer_load_dwordx4 v[68:71], v6, s[4:7], s28 offen offset:1024 sc1
  s_waitcnt vmcnt(0)
  v_max3_u32 v7, v67, v71, v67
  v_cmp_eq_u32 vcc, -1, v7
  s_cbranch_vccz Lzok_92
  buffer_load_dwordx4 v[64:67], v6, s[4:7], s28 offen sc1
  buffer_load_dwordx4 v[68:71], v6, s[4:7], s28 offen offset:1024 sc1
Lzt_93:
  buffer_load_dwordx4 v[64:67], v6, s[4:7], s28 offen sc1
  buffer_load_dwordx4 v[68:71], v6, s[4:7], s28 offen offset:1024 sc1
  s_waitcnt vmcnt(2)
  v_max3_u32 v7, v64, v65, v66
  v_max3_u32 v7, v7, v67, v68
  v_max3_u32 v7, v7, v69, v70
  v_max_u32 v7, v7, v71
  v_cmp_eq_u32 vcc, -1, v7
  s_cbranch_vccz Lzok_92
  s_cmp_eq_u32 s19, 0
  s_cbranch_scc1 Lzok_92
  s_sub_u32 s19, s19, 1
  s_branch Lzt_93
Lzok_92:
Lcl_90:
  buffer_load_dwordx4 v[128:131], v4, s[4:7], s27 offen offset:0 sc1
  buffer_load_dwordx4 v[132:135], v4, s[4:7], s27 offen offset:1024 sc1
  buffer_load_dwordx4 v[136:139], v4, s[4:7], s27 offen offset:2048 sc1
  buffer_load_dwordx4 v[140:143], v4, s[4:7], s27 offen offset:3072 sc1
  buffer_load_dwordx2 v[144:145], v5, s[4:7], s27 offen offset:0 sc1
  buffer_load_dwordx2 v[146:147], v5, s[4:7], s27 offen offset:128 sc1
  s_waitcnt vmcnt(0)
  v_max3_u32 v7, v131, v135, v139
  v_max3_u32 v7, v7, v143, v145
  v_max_u32 v7, v7, v147
  v_cmp_eq_u32 vcc, -1, v7
  s_cbranch_vccz Lclok_91
  s_cmp_eq_u32 s19, 0
  s_cbranch_scc1 Lclok_91
  s_sub_u32 s19, s19, 1
  s_branch Lcl_90
Lclok_91:
  s_mov_b32 s63, 1
  v_smfmac_f32_16x16x64_bf16 v[16:19], v[144:147], v[64:71], v3
  v_smfmac_f32_16x16x64_bf16 v[16:19], v[128:131], a[80:87], v3
  v_smfmac_f32_16x16x64_bf16 v[16:19], v[132:135], a[88:95], v3
  v_smfmac_f32_16x16x64_bf16 v[16:19], v[136:139], a[96:103], v3
  v_smfmac_f32_16x16x64_bf16 v[16:19], v[140:143], a[104:111], v3
  s_add_u32 s20, s43, 360448
  buffer_load_dword v103, v0, s[4:7], s20 offen sc1
  s_nop 5
  v_add_f32 v16, v16, v17
  v_add_f32 v18, v18, v19
  ds_write2_b32 v11, v16, v18 offset0:0 offset1:16
  s_waitcnt lgkmcnt(0)
  s_barrier
  s_cmp_lg_u32 s16, 0
  s_cbranch_scc1 LRw_94
  ds_read_b64 v[20:21], v12 offset:0
  ds_read_b64 v[22:23], v12 offset:512
  ds_read_b64 v[32:33], v12 offset:1024
  ds_read_b64 v[34:35], v12 offset:1536
  s_waitcnt lgkmcnt(0)
  v_add_f32 v20, v20, v22
  v_add_f32 v21, v21, v23
  v_add_f32 v32, v32, v34
  v_add_f32 v33, v33, v35
  v_add_f32 v20, v20, v32
  v_add_f32 v21, v21, v33
  v_cvt_pk_bf16_f32 v32, v20, v21
  s_nop 1
  v_mov_b32_dpp v20, v32 quad_perm:[0,0,0,0] row_mask:0xf bank_mask:0xf
  v_mov_b32_dpp v21, v32 quad_perm:[1,1,1,1] row_mask:0xf bank_mask:0xf
  v_mov_b32_dpp v22, v32 quad_perm:[2,2,2,2] row_mask:0xf bank_mask:0xf
  v_mov_b32_dpp v23, v32 quad_perm:[3,3,3,3] row_mask:0xf bank_mask:0xf
  buffer_store_dwordx4 v[20:23], v13, s[4:7], s26 offen sc1
LRw_94:
  s_barrier
  v_accvgpr_write_b32 a112, v64
  v_accvgpr_write_b32 a113, v65
  v_accvgpr_write_b32 a114, v66
  v_accvgpr_write_b32 a115, v67
  v_accvgpr_write_b32 a116, v68
  v_accvgpr_write_b32 a117, v69
  v_accvgpr_write_b32 a118, v70
  v_accvgpr_write_b32 a119, v71
  s_add_u32 s23, s18, 2
  s_min_u32 s23, s23, 64
  v_cmp_gt_u32 vcc, s23, v103
  s_cbranch_vccz LRok_95
  s_add_u32 s22, s43, 360448
Lwf_96:
  buffer_load_dword v7, v0, s[4:7], s22 offen sc1
  s_waitcnt vmcnt(0)
  v_cmp_gt_u32 vcc, s23, v7
  s_cbranch_vccz Lwfd_97
  s_sleep 2
  s_cmp_eq_u32 s19, 0
  s_cbranch_scc1 Lwfd_97
  s_sub_u32 s19, s19, 1
  s_branch Lwf_96
Lwfd_97:
LRok_95:
  s_cmp_lg_u32 s16, 1
  s_cbranch_scc1 LRq_98
  s_and_b32 s20, s18, 3
  s_mul_i32 s20, s20, 32768
  s_add_u32 s20, s20, s43
  buffer_store_dwordx4 v[92:95], v13, s[4:7], s20 offen sc1
LRq_98:
  s_cmp_lg_u32 s16, 2
  s_cbranch_scc1 LRx_99
  s_cmp_lt_u32 s18, 2
  s_cbranch_scc1 LRx_99
  s_sub_u32 s21, s18, 1
  v_mov_b32 v102, s21
  s_add_u32 s20, s43, 344064
  buffer_store_dword v102, v30, s[4:7], s20 offen sc1
LRx_99:
  buffer_store_dwordx4 v[92:95], v6, s[4:7], s28 offen sc1
  buffer_store_dwordx4 v[92:95], v6, s[4:7], s28 offen offset:1024 sc1
  s_add_u32 s20, s43, 327680
  buffer_load_dword v99, v31, s[4:7], s20 offen sc1
  s_add_u32 s30, s30, 1310720
  buffer_load_dwordx4 a[120:123], v10, s[4:7], s30 offen offset:0 sc1
  buffer_load_dwordx4 a[124:127], v10, s[4:7], s30 offen offset:1024 sc1
  buffer_load_dwordx4 a[128:131], v10, s[4:7], s30 offen offset:2048 sc1
  buffer_load_dwordx4 a[132:135], v10, s[4:7], s30 offen offset:3072 sc1
  s_add_u32 s20, s30, 4096
  buffer_load_dwordx4 a[136:139], v10, s[4:7], s20 offen offset:0 sc1
  buffer_load_dwordx4 a[140:143], v10, s[4:7], s20 offen offset:1024 sc1
  buffer_load_dwordx4 a[144:147], v10, s[4:7], s20 offen offset:2048 sc1
  buffer_load_dwordx4 a[148:151], v10, s[4:7], s20 offen offset:3072 sc1
  s_lshl_b32 s21, s16, 2
  s_add_u32 s21, s21, 16384
  v_mov_b32 v40, s21
  v_mov_b32 v41, s63
  ds_write_b32 v40, v41
  s_cmp_lt_u32 s18, 1
  s_cbranch_scc1 LRns_100
  v_mov_b32 v100, v96
  v_mov_b32 v101, v97
  v_mfma_f32_16x16x32_bf16 v[104:107], a[40:43], a[160:163], 0
  v_mfma_f32_16x16x32_bf16 v[104:107], a[44:47], a[164:167], v[104:107]
  v_mfma_f32_16x16x32_bf16 v[104:107], a[48:51], a[168:171], v[104:107]
  v_mfma_f32_16x16x32_bf16 v[104:107], a[52:55], a[172:175], v[104:107]
  v_mfma_f32_16x16x32_bf16 v[104:107], a[56:59], a[176:179], v[104:107]
  v_mfma_f32_16x16x32_bf16 v[104:107], a[60:63], a[180:183], v[104:107]
  v_mfma_f32_16x16x32_bf16 v[104:107], a[64:67], a[184:187], v[104:107]
  v_mfma_f32_16x16x32_bf16 v[104:107], a[68:71], a[188:191], v[104:107]
  v_mfma_f32_16x16x32_bf16 v[104:107], a[72:75], a[192:195], v[104:107]
  v_mfma_f32_16x16x32_bf16 v[104:107], a[76:79], a[196:199], v[104:107]
  v_mfma_f32_16x16x32_bf16 v[108:111], a[40:43], a[200:203], 0
  v_mfma_f32_16x16x32_bf16 v[108:111], a[44:47], a[204:207], v[108:111]
  v_mfma_f32_16x16x32_bf16 v[108:111], a[48:51], a[208:211], v[108:111]
  v_mfma_f32_16x16x32_bf16 v[108:111], a[52:55], a[212:215], v[108:111]
  v_mfma_f32_16x16x32_bf16 v[108:111], a[56:59], a[216:219], v[108:111]
  v_mfma_f32_16x16x32_bf16 v[108:111], a[60:63], a[220:223], v[108:111]
  v_mfma_f32_16x16x32_bf16 v[108:111], a[64:67], a[224:227], v[108:111]
  v_mfma_f32_16x16x32_bf16 v[108:111], a[68:71], a[228:231], v[108:111]
  v_mfma_f32_16x16x32_bf16 v[108:111], a[72:75], a[232:235], v[108:111]
  v_mfma_f32_16x16x32_bf16 v[108:111], a[76:79], a[236:239], v[108:111]
  ds_write_b128 v15, v[104:107]
  s_nop 6
  ds_write_b128 v15, v[108:111] offset:1024
  s_waitcnt lgkmcnt(0)
  s_barrier
  s_cmp_ge_u32 s16, 2
  s_cbranch_scc1 LRs_101
  ds_read_b128 v[104:107], v29 offset:0
  ds_read_b128 v[108:111], v29 offset:2048
  ds_read_b128 v[112:115], v29 offset:4096
  ds_read_b128 v[116:119], v29 offset:6144
  s_waitcnt lgkmcnt(0)
  v_add_f32 v104, v104, v108
  v_add_f32 v112, v112, v116
  v_add_f32 v104, v104, v112
  v_add_f32 v105, v105, v109
  v_add_f32 v113, v113, v117
  v_add_f32 v105, v105, v113
  v_add_f32 v106, v106, v110
  v_add_f32 v114, v114, v118
  v_add_f32 v106, v106, v114
  v_add_f32 v107, v107, v111
  v_add_f32 v115, v115, v119
  v_add_f32 v107, v107, v115
  v_lshlrev_b32 v108, 16, v100
  v_and_b32 v109, 0xffff0000, v100
  v_lshlrev_b32 v110, 16, v101
  v_and_b32 v111, 0xffff0000, v101
  v_fmac_f32 v108, v24, v104
  v_fmac_f32 v109, v25, v105
  v_fmac_f32 v110, v26, v106
  v_fmac_f32 v111, v27, v107
  v_cvt_pk_bf16_f32 v100, v108, v109
  v_cvt_pk_bf16_f32 v101, v110, v111
  s_mul_i32 s35, s36, 40960
  s_add_u32 s35, s35, 148373504
  buffer_store_dwordx2 v[100:101], v28, s[4:7], s35 offen sc1
LRs_101:
LRns_100:
  s_add_u32 s35, s18, 0
  s_mul_i32 s35, s35, 40960
  buffer_load_dwordx2 v[96:97], v28, s[8:11], s35 offen
  s_add_u32 s18, s18, 1
  v_mov_b32 v16, 0
  v_mov_b32 v17, 0
  v_mov_b32 v18, 0
  v_mov_b32 v19, 0
  s_add_u32 s20, s18, 1
  s_and_b32 s20, s20, 3
  s_mul_i32 s20, s20, 32768
  s_add_u32 s26, s20, s43
  s_and_b32 s20, s18, 3
  s_mul_i32 s20, s20, 49152
  s_add_u32 s27, s20, s43
  s_add_u32 s27, s27, 131072
  s_and_b32 s20, s18, 1
  s_mul_i32 s20, s20, 655360
  s_add_u32 s28, s20, s39
  s_cmp_lt_u32 s18, 1
  s_cbranch_scc1 LRn0_102
  s_sub_u32 s36, s18, 1
  s_waitcnt vmcnt(9)
  v_cmp_gt_u32 vcc, s18, v99
  s_cbranch_vccz LRfp_103
  s_mov_b32 s23, s18
  s_add_u32 s22, s43, 327680
Lwf_104:
  buffer_load_dword v7, v31, s[4:7], s22 offen sc1
  s_waitcnt vmcnt(0)
  v_cmp_gt_u32 vcc, s23, v7
  s_cbranch_vccz Lwfd_105
  s_sleep 1
  s_cmp_eq_u32 s19, 0
  s_cbranch_scc1 Lwfd_105
  s_sub_u32 s19, s19, 1
  s_branch Lwf_104
Lwfd_105:
LRfp_103:
  s_and_b32 s34, s36, 3
  s_mul_i32 s34, s34, 163840
  s_add_u32 s34, s34, s43
  s_add_u32 s34, s34, 376832
  s_lshl_b32 s20, s16, 14
  s_add_u32 s20, s20, s34
  buffer_load_dwordx4 a[160:163], v2, s[4:7], s20 offen offset:0 sc1
  buffer_load_dwordx4 a[164:167], v2, s[4:7], s20 offen offset:1024 sc1
  buffer_load_dwordx4 a[168:171], v2, s[4:7], s20 offen offset:2048 sc1
  buffer_load_dwordx4 a[172:175], v2, s[4:7], s20 offen offset:3072 sc1
  s_add_u32 s20, s20, 4096
  buffer_load_dwordx4 a[176:179], v2, s[4:7], s20 offen offset:0 sc1
  buffer_load_dwordx4 a[180:183], v2, s[4:7], s20 offen offset:1024 sc1
  buffer_load_dwordx4 a[184:187], v2, s[4:7], s20 offen offset:2048 sc1
  buffer_load_dwordx4 a[188:191], v2, s[4:7], s20 offen offset:3072 sc1
  s_lshl_b32 s20, s16, 11
  s_add_u32 s20, s20, s34
  s_add_u32 s20, s20, 131072
  buffer_load_dwordx4 a[192:195], v2, s[4:7], s20 offen offset:0 sc1
  buffer_load_dwordx4 a[196:199], v2, s[4:7], s20 offen offset:1024 sc1
  s_lshl_b32 s20, s16, 14
  s_add_u32 s20, s20, s34
  s_add_u32 s20, s20, 65536
  buffer_load_dwordx4 a[200:203], v2, s[4:7], s20 offen offset:0 sc1
  buffer_load_dwordx4 a[204:207], v2, s[4:7], s20 offen offset:1024 sc1
  buffer_load_dwordx4 a[208:211], v2, s[4:7], s20 offen offset:2048 sc1
  buffer_load_dwordx4 a[212:215], v2, s[4:7], s20 offen offset:3072 sc1
  s_add_u32 s20, s20, 4096
  buffer_load_dwordx4 a[216:219], v2, s[4:7], s20 offen offset:0 sc1
  buffer_load_dwordx4 a[220:223], v2, s[4:7], s20 offen offset:1024 sc1
  buffer_load_dwordx4 a[224:227], v2, s[4:7], s20 offen offset:2048 sc1
  buffer_load_dwordx4 a[228:231], v2, s[4:7], s20 offen offset:3072 sc1
  s_lshl_b32 s20, s16, 11
  s_add_u32 s20, s20, s34
  s_add_u32 s20, s20, 147456
  buffer_load_dwordx4 a[232:235], v2, s[4:7], s20 offen offset:0 sc1
  buffer_load_dwordx4 a[236:239], v2, s[4:7], s20 offen offset:1024 sc1
LRn0_102:
  s_cmp_eq_u32 s18, 63
  s_cbranch_scc1 LR_last
  s_sleep 1
  buffer_load_dwordx4 v[64:67], v6, s[4:7], s28 offen sc1
  buffer_load_dwordx4 v[68:71], v6, s[4:7], s28 offen offset:1024 sc1
  s_waitcnt vmcnt(0)
  v_max3_u32 v7, v67, v71, v67
  v_cmp_eq_u32 vcc, -1, v7
  s_cbranch_vccz Lzok_108
  buffer_load_dwordx4 v[64:67], v6, s[4:7], s28 offen sc1
  buffer_load_dwordx4 v[68:71], v6, s[4:7], s28 offen offset:1024 sc1
Lzt_109:
  buffer_load_dwordx4 v[64:67], v6, s[4:7], s28 offen sc1
  buffer_load_dwordx4 v[68:71], v6, s[4:7], s28 offen offset:1024 sc1
  s_waitcnt vmcnt(2)
  v_max3_u32 v7, v64, v65, v66
  v_max3_u32 v7, v7, v67, v68
  v_max3_u32 v7, v7, v69, v70
  v_max_u32 v7, v7, v71
  v_cmp_eq_u32 vcc, -1, v7
  s_cbranch_vccz Lzok_108
  s_cmp_eq_u32 s19, 0
  s_cbranch_scc1 Lzok_108
  s_sub_u32 s19, s19, 1
  s_branch Lzt_109
Lzok_108:
Lcl_106:
  buffer_load_dwordx4 v[128:131], v4, s[4:7], s27 offen offset:0 sc1
  buffer_load_dwordx4 v[132:135], v4, s[4:7], s27 offen offset:1024 sc1
  buffer_load_dwordx4 v[136:139], v4, s[4:7], s27 offen offset:2048 sc1
  buffer_load_dwordx4 v[140:143], v4, s[4:7], s27 offen offset:3072 sc1
  buffer_load_dwordx2 v[144:145], v5, s[4:7], s27 offen offset:0 sc1
  buffer_load_dwordx2 v[146:147], v5, s[4:7], s27 offen offset:128 sc1
  s_waitcnt vmcnt(0)
  v_max3_u32 v7, v131, v135, v139
  v_max3_u32 v7, v7, v143, v145
  v_max_u32 v7, v7, v147
  v_cmp_eq_u32 vcc, -1, v7
  s_cbranch_vccz Lclok_107
  s_cmp_eq_u32 s19, 0
  s_cbranch_scc1 Lclok_107
  s_sub_u32 s19, s19, 1
  s_branch Lcl_106
Lclok_107:
  s_mov_b32 s63, 1
  v_smfmac_f32_16x16x64_bf16 v[16:19], v[144:147], v[64:71], v3
  v_smfmac_f32_16x16x64_bf16 v[16:19], v[128:131], a[120:127], v3
  v_smfmac_f32_16x16x64_bf16 v[16:19], v[132:135], a[128:135], v3
  v_smfmac_f32_16x16x64_bf16 v[16:19], v[136:139], a[136:143], v3
  v_smfmac_f32_16x16x64_bf16 v[16:19], v[140:143], a[144:151], v3
  s_add_u32 s20, s43, 360448
  buffer_load_dword v103, v0, s[4:7], s20 offen sc1
  s_nop 5
  v_add_f32 v16, v16, v17
  v_add_f32 v18, v18, v19
  ds_write2_b32 v11, v16, v18 offset0:0 offset1:16
  s_waitcnt lgkmcnt(0)
  s_barrier
  s_cmp_lg_u32 s16, 0
  s_cbranch_scc1 LRw_110
  ds_read_b64 v[20:21], v12 offset:0
  ds_read_b64 v[22:23], v12 offset:512
  ds_read_b64 v[32:33], v12 offset:1024
  ds_read_b64 v[34:35], v12 offset:1536
  s_waitcnt lgkmcnt(0)
  v_add_f32 v20, v20, v22
  v_add_f32 v21, v21, v23
  v_add_f32 v32, v32, v34
  v_add_f32 v33, v33, v35
  v_add_f32 v20, v20, v32
  v_add_f32 v21, v21, v33
  v_cvt_pk_bf16_f32 v32, v20, v21
  s_nop 1
  v_mov_b32_dpp v20, v32 quad_perm:[0,0,0,0] row_mask:0xf bank_mask:0xf
  v_mov_b32_dpp v21, v32 quad_perm:[1,1,1,1] row_mask:0xf bank_mask:0xf
  v_mov_b32_dpp v22, v32 quad_perm:[2,2,2,2] row_mask:0xf bank_mask:0xf
  v_mov_b32_dpp v23, v32 quad_perm:[3,3,3,3] row_mask:0xf bank_mask:0xf
  buffer_store_dwordx4 v[20:23], v13, s[4:7], s26 offen sc1
LRw_110:
  s_barrier
  v_accvgpr_write_b32 a152, v64
  v_accvgpr_write_b32 a153, v65
  v_accvgpr_write_b32 a154, v66
  v_accvgpr_write_b32 a155, v67
  v_accvgpr_write_b32 a156, v68
  v_accvgpr_write_b32 a157, v69
  v_accvgpr_write_b32 a158, v70
  v_accvgpr_write_b32 a159, v71
  s_add_u32 s23, s18, 2
  s_min_u32 s23, s23, 64
  v_cmp_gt_u32 vcc, s23, v103
  s_cbranch_vccz LRok_111
  s_add_u32 s22, s43, 360448
Lwf_112:
  buffer_load_dword v7, v0, s[4:7], s22 offen sc1
  s_waitcnt vmcnt(0)
  v_cmp_gt_u32 vcc, s23, v7
  s_cbranch_vccz Lwfd_113
  s_sleep 2
  s_cmp_eq_u32 s19, 0
  s_cbranch_scc1 Lwfd_113
  s_sub_u32 s19, s19, 1
  s_branch Lwf_112
Lwfd_113:
LRok_111:
  s_cmp_lg_u32 s16, 1
  s_cbranch_scc1 LRq_114
  s_and_b32 s20, s18, 3
  s_mul_i32 s20, s20, 32768
  s_add_u32 s20, s20, s43
  buffer_store_dwordx4 v[92:95], v13, s[4:7], s20 offen sc1
LRq_114:
  s_cmp_lg_u32 s16, 2
  s_cbranch_scc1 LRx_115
  s_cmp_lt_u32 s18, 2
  s_cbranch_scc1 LRx_115
  s_sub_u32 s21, s18, 1
  v_mov_b32 v102, s21
  s_add_u32 s20, s43, 344064
  buffer_store_dword v102, v30, s[4:7], s20 offen sc1
LRx_115:
  buffer_store_dwordx4 v[92:95], v6, s[4:7], s28 offen sc1
  buffer_store_dwordx4 v[92:95], v6, s[4:7], s28 offen offset:1024 sc1
  s_add_u32 s20, s43, 327680
  buffer_load_dword v99, v31, s[4:7], s20 offen sc1
  s_add_u32 s30, s30, 1310720
  buffer_load_dwordx4 a[0:3], v10, s[4:7], s30 offen offset:0 sc1
  buffer_load_dwordx4 a[4:7], v10, s[4:7], s30 offen offset:1024 sc1
  buffer_load_dwordx4 a[8:11], v10, s[4:7], s30 offen offset:2048 sc1
  buffer_load_dwordx4 a[12:15], v10, s[4:7], s30 offen offset:3072 sc1
  s_add_u32 s20, s30, 4096
  buffer_load_dwordx4 a[16:19], v10, s[4:7], s20 offen offset:0 sc1
  buffer_load_dwordx4 a[20:23], v10, s[4:7], s20 offen offset:1024 sc1
  buffer_load_dwordx4 a[24:27], v10, s[4:7], s20 offen offset:2048 sc1
  buffer_load_dwordx4 a[28:31], v10, s[4:7], s20 offen offset:3072 sc1
  s_lshl_b32 s21, s16, 2
  s_add_u32 s21, s21, 16384
  v_mov_b32 v40, s21
  v_mov_b32 v41, s63
  ds_write_b32 v40, v41
  s_cmp_lt_u32 s18, 1
  s_cbranch_scc1 LRns_116
  v_mov_b32 v100, v96
  v_mov_b32 v101, v97
  v_mfma_f32_16x16x32_bf16 v[104:107], a[80:83], a[160:163], 0
  v_mfma_f32_16x16x32_bf16 v[104:107], a[84:87], a[164:167], v[104:107]
  v_mfma_f32_16x16x32_bf16 v[104:107], a[88:91], a[168:171], v[104:107]
  v_mfma_f32_16x16x32_bf16 v[104:107], a[92:95], a[172:175], v[104:107]
  v_mfma_f32_16x16x32_bf16 v[104:107], a[96:99], a[176:179], v[104:107]
  v_mfma_f32_16x16x32_bf16 v[104:107], a[100:103], a[180:183], v[104:107]
  v_mfma_f32_16x16x32_bf16 v[104:107], a[104:107], a[184:187], v[104:107]
  v_mfma_f32_16x16x32_bf16 v[104:107], a[108:111], a[188:191], v[104:107]
  v_mfma_f32_16x16x32_bf16 v[104:107], a[112:115], a[192:195], v[104:107]
  v_mfma_f32_16x16x32_bf16 v[104:107], a[116:119], a[196:199], v[104:107]
  v_mfma_f32_16x16x32_bf16 v[108:111], a[80:83], a[200:203], 0
  v_mfma_f32_16x16x32_bf16 v[108:111], a[84:87], a[204:207], v[108:111]
  v_mfma_f32_16x16x32_bf16 v[108:111], a[88:91], a[208:211], v[108:111]
  v_mfma_f32_16x16x32_bf16 v[108:111], a[92:95], a[212:215], v[108:111]
  v_mfma_f32_16x16x32_bf16 v[108:111], a[96:99], a[216:219], v[108:111]
  v_mfma_f32_16x16x32_bf16 v[108:111], a[100:103], a[220:223], v[108:111]
  v_mfma_f32_16x16x32_bf16 v[108:111], a[104:107], a[224:227], v[108:111]
  v_mfma_f32_16x16x32_bf16 v[108:111], a[108:111], a[228:231], v[108:111]
  v_mfma_f32_16x16x32_bf16 v[108:111], a[112:115], a[232:235], v[108:111]
  v_mfma_f32_16x16x32_bf16 v[108:111], a[116:119], a[236:239], v[108:111]
  ds_write_b128 v15, v[104:107]
  s_nop 6
  ds_write_b128 v15, v[108:111] offset:1024
  s_waitcnt lgkmcnt(0)
  s_barrier
  s_cmp_ge_u32 s16, 2
  s_cbranch_scc1 LRs_117
  ds_read_b128 v[104:107], v29 offset:0
  ds_read_b128 v[108:111], v29 offset:2048
  ds_read_b128 v[112:115], v29 offset:4096
  ds_read_b128 v[116:119], v29 offset:6144
  s_waitcnt lgkmcnt(0)
  v_add_f32 v104, v104, v108
  v_add_f32 v112, v112, v116
  v_add_f32 v104, v104, v112
  v_add_f32 v105, v105, v109
  v_add_f32 v113, v113, v117
  v_add_f32 v105, v105, v113
  v_add_f32 v106, v106, v110
  v_add_f32 v114, v114, v118
  v_add_f32 v106, v106, v114
  v_add_f32 v107, v107, v111
  v_add_f32 v115, v115, v119
  v_add_f32 v107, v107, v115
  v_lshlrev_b32 v108, 16, v100
  v_and_b32 v109, 0xffff0000, v100
  v_lshlrev_b32 v110, 16, v101
  v_and_b32 v111, 0xffff0000, v101
  v_fmac_f32 v108, v24, v104
  v_fmac_f32 v109, v25, v105
  v_fmac_f32 v110, v26, v106
  v_fmac_f32 v111, v27, v107
  v_cvt_pk_bf16_f32 v100, v108, v109
  v_cvt_pk_bf16_f32 v101, v110, v111
  s_mul_i32 s35, s36, 40960
  s_add_u32 s35, s35, 148373504
  buffer_store_dwordx2 v[100:101], v28, s[4:7], s35 offen sc1
LRs_117:
LRns_116:
  s_add_u32 s35, s18, 0
  s_mul_i32 s35, s35, 40960
  buffer_load_dwordx2 v[96:97], v28, s[8:11], s35 offen
  s_add_u32 s18, s18, 1
  s_branch LRloop_53
LR_last:
  s_waitcnt vmcnt(0)
  s_barrier
  s_cmp_lg_u32 s16, 2
  s_cbranch_scc1 LRf1_118
  s_mov_b32 s21, 62
  v_mov_b32 v102, s21
  s_add_u32 s20, s43, 344064
  buffer_store_dword v102, v30, s[4:7], s20 offen sc1
LRf1_118:
  v_mov_b32 v100, v96
  v_mov_b32 v101, v97
  v_mfma_f32_16x16x32_bf16 v[104:107], a[80:83], a[160:163], 0
  v_mfma_f32_16x16x32_bf16 v[104:107], a[84:87], a[164:167], v[104:107]
  v_mfma_f32_16x16x32_bf16 v[104:107], a[88:91], a[168:171], v[104:107]
  v_mfma_f32_16x16x32_bf16 v[104:107], a[92:95], a[172:175], v[104:107]
  v_mfma_f32_16x16x32_bf16 v[104:107], a[96:99], a[176:179], v[104:107]
  v_mfma_f32_16x16x32_bf16 v[104:107], a[100:103], a[180:183], v[104:107]
  v_mfma_f32_16x16x32_bf16 v[104:107], a[104:107], a[184:187], v[104:107]
  v_mfma_f32_16x16x32_bf16 v[104:107], a[108:111], a[188:191], v[104:107]
  v_mfma_f32_16x16x32_bf16 v[104:107], a[112:115], a[192:195], v[104:107]
  v_mfma_f32_16x16x32_bf16 v[104:107], a[116:119], a[196:199], v[104:107]
  v_mfma_f32_16x16x32_bf16 v[108:111], a[80:83], a[200:203], 0
  v_mfma_f32_16x16x32_bf16 v[108:111], a[84:87], a[204:207], v[108:111]
  v_mfma_f32_16x16x32_bf16 v[108:111], a[88:91], a[208:211], v[108:111]
  v_mfma_f32_16x16x32_bf16 v[108:111], a[92:95], a[212:215], v[108:111]
  v_mfma_f32_16x16x32_bf16 v[108:111], a[96:99], a[216:219], v[108:111]
  v_mfma_f32_16x16x32_bf16 v[108:111], a[100:103], a[220:223], v[108:111]
  v_mfma_f32_16x16x32_bf16 v[108:111], a[104:107], a[224:227], v[108:111]
  v_mfma_f32_16x16x32_bf16 v[108:111], a[108:111], a[228:231], v[108:111]
  v_mfma_f32_16x16x32_bf16 v[108:111], a[112:115], a[232:235], v[108:111]
  v_mfma_f32_16x16x32_bf16 v[108:111], a[116:119], a[236:239], v[108:111]
  ds_write_b128 v15, v[104:107]
  s_nop 6
  ds_write_b128 v15, v[108:111] offset:1024
  s_waitcnt lgkmcnt(0)
  s_barrier
  s_cmp_ge_u32 s16, 2
  s_cbranch_scc1 LRs_119
  ds_read_b128 v[104:107], v29 offset:0
  ds_read_b128 v[108:111], v29 offset:2048
  ds_read_b128 v[112:115], v29 offset:4096
  ds_read_b128 v[116:119], v29 offset:6144
  s_waitcnt lgkmcnt(0)
  v_add_f32 v104, v104, v108
  v_add_f32 v112, v112, v116
  v_add_f32 v104, v104, v112
  v_add_f32 v105, v105, v109
  v_add_f32 v113, v113, v117
  v_add_f32 v105, v105, v113
  v_add_f32 v106, v106, v110
  v_add_f32 v114, v114, v118
  v_add_f32 v106, v106, v114
  v_add_f32 v107, v107, v111
  v_add_f32 v115, v115, v119
  v_add_f32 v107, v107, v115
  v_lshlrev_b32 v108, 16, v100
  v_and_b32 v109, 0xffff0000, v100
  v_lshlrev_b32 v110, 16, v101
  v_and_b32 v111, 0xffff0000, v101
  v_fmac_f32 v108, v24, v104
  v_fmac_f32 v109, v25, v105
  v_fmac_f32 v110, v26, v106
  v_fmac_f32 v111, v27, v107
  v_cvt_pk_bf16_f32 v100, v108, v109
  v_cvt_pk_bf16_f32 v101, v110, v111
  s_mul_i32 s35, s36, 40960
  s_add_u32 s35, s35, 148373504
  buffer_store_dwordx2 v[100:101], v28, s[4:7], s35 offen sc1
LRs_119:
Lzl_120:
  buffer_load_dwordx4 v[64:67], v6, s[4:7], s28 offen sc1
  buffer_load_dwordx4 v[68:71], v6, s[4:7], s28 offen offset:1024 sc1
  s_waitcnt vmcnt(0)
  v_max3_u32 v7, v67, v71, v67
  v_cmp_eq_u32 vcc, -1, v7
  s_cbranch_vccz Lzlok_121
  s_cmp_eq_u32 s19, 0
  s_cbranch_scc1 Lzlok_121
  s_sub_u32 s19, s19, 1
  s_branch Lzl_120
Lzlok_121:
  v_accvgpr_write_b32 a152, v64
  v_accvgpr_write_b32 a153, v65
  v_accvgpr_write_b32 a154, v66
  v_accvgpr_write_b32 a155, v67
  v_accvgpr_write_b32 a156, v68
  v_accvgpr_write_b32 a157, v69
  v_accvgpr_write_b32 a158, v70
  v_accvgpr_write_b32 a159, v71
  s_barrier
  s_cmp_lg_u32 s16, 2
  s_cbranch_scc1 LRf2_122
  s_mov_b32 s21, 63
  v_mov_b32 v102, s21
  s_add_u32 s20, s43, 344064
  buffer_store_dword v102, v30, s[4:7], s20 offen sc1
LRf2_122:
  s_mov_b32 s36, 63
  s_add_u32 s23, s36, 1
  s_add_u32 s22, s43, 327680
Lwf_123:
  buffer_load_dword v7, v31, s[4:7], s22 offen sc1
  s_waitcnt vmcnt(0)
  v_cmp_gt_u32 vcc, s23, v7
  s_cbranch_vccz Lwfd_124
  s_sleep 1
  s_cmp_eq_u32 s19, 0
  s_cbranch_scc1 Lwfd_124
  s_sub_u32 s19, s19, 1
  s_branch Lwf_123
Lwfd_124:
  s_and_b32 s34, s36, 3
  s_mul_i32 s34, s34, 163840
  s_add_u32 s34, s34, s43
  s_add_u32 s34, s34, 376832
  s_lshl_b32 s20, s16, 14
  s_add_u32 s20, s20, s34
  buffer_load_dwordx4 a[160:163], v2, s[4:7], s20 offen offset:0 sc1
  buffer_load_dwordx4 a[164:167], v2, s[4:7], s20 offen offset:1024 sc1
  buffer_load_dwordx4 a[168:171], v2, s[4:7], s20 offen offset:2048 sc1
  buffer_load_dwordx4 a[172:175], v2, s[4:7], s20 offen offset:3072 sc1
  s_add_u32 s20, s20, 4096
  buffer_load_dwordx4 a[176:179], v2, s[4:7], s20 offen offset:0 sc1
  buffer_load_dwordx4 a[180:183], v2, s[4:7], s20 offen offset:1024 sc1
  buffer_load_dwordx4 a[184:187], v2, s[4:7], s20 offen offset:2048 sc1
  buffer_load_dwordx4 a[188:191], v2, s[4:7], s20 offen offset:3072 sc1
  s_lshl_b32 s20, s16, 11
  s_add_u32 s20, s20, s34
  s_add_u32 s20, s20, 131072
  buffer_load_dwordx4 a[192:195], v2, s[4:7], s20 offen offset:0 sc1
  buffer_load_dwordx4 a[196:199], v2, s[4:7], s20 offen offset:1024 sc1
  s_lshl_b32 s20, s16, 14
  s_add_u32 s20, s20, s34
  s_add_u32 s20, s20, 65536
  buffer_load_dwordx4 a[200:203], v2, s[4:7], s20 offen offset:0 sc1
  buffer_load_dwordx4 a[204:207], v2, s[4:7], s20 offen offset:1024 sc1
  buffer_load_dwordx4 a[208:211], v2, s[4:7], s20 offen offset:2048 sc1
  buffer_load_dwordx4 a[212:215], v2, s[4:7], s20 offen offset:3072 sc1
  s_add_u32 s20, s20, 4096
  buffer_load_dwordx4 a[216:219], v2, s[4:7], s20 offen offset:0 sc1
  buffer_load_dwordx4 a[220:223], v2, s[4:7], s20 offen offset:1024 sc1
  buffer_load_dwordx4 a[224:227], v2, s[4:7], s20 offen offset:2048 sc1
  buffer_load_dwordx4 a[228:231], v2, s[4:7], s20 offen offset:3072 sc1
  s_lshl_b32 s20, s16, 11
  s_add_u32 s20, s20, s34
  s_add_u32 s20, s20, 147456
  buffer_load_dwordx4 a[232:235], v2, s[4:7], s20 offen offset:0 sc1
  buffer_load_dwordx4 a[236:239], v2, s[4:7], s20 offen offset:1024 sc1
  s_mul_i32 s35, s36, 40960
  buffer_load_dwordx2 v[100:101], v28, s[8:11], s35 offen
  s_waitcnt vmcnt(11)
  v_mfma_f32_16x16x32_bf16 v[104:107], a[120:123], a[160:163], 0
  v_mfma_f32_16x16x32_bf16 v[104:107], a[124:127], a[164:167], v[104:107]
  v_mfma_f32_16x16x32_bf16 v[104:107], a[128:131], a[168:171], v[104:107]
  v_mfma_f32_16x16x32_bf16 v[104:107], a[132:135], a[172:175], v[104:107]
  v_mfma_f32_16x16x32_bf16 v[104:107], a[136:139], a[176:179], v[104:107]
  v_mfma_f32_16x16x32_bf16 v[104:107], a[140:143], a[180:183], v[104:107]
  v_mfma_f32_16x16x32_bf16 v[104:107], a[144:147], a[184:187], v[104:107]
  v_mfma_f32_16x16x32_bf16 v[104:107], a[148:151], a[188:191], v[104:107]
  v_mfma_f32_16x16x32_bf16 v[104:107], a[152:155], a[192:195], v[104:107]
  v_mfma_f32_16x16x32_bf16 v[104:107], a[156:159], a[196:199], v[104:107]
  s_waitcnt vmcnt(1)
  v_mfma_f32_16x16x32_bf16 v[108:111], a[120:123], a[200:203], 0
  v_mfma_f32_16x16x32_bf16 v[108:111], a[124:127], a[204:207], v[108:111]
  v_mfma_f32_16x16x32_bf16 v[108:111], a[128:131], a[208:211], v[108:111]
  v_mfma_f32_16x16x32_bf16 v[108:111], a[132:135], a[212:215], v[108:111]
  v_mfma_f32_16x16x32_bf16 v[108:111], a[136:139], a[216:219], v[108:111]
  v_mfma_f32_16x16x32_bf16 v[108:111], a[140:143], a[220:223], v[108:111]
  v_mfma_f32_16x16x32_bf16 v[108:111], a[144:147], a[224:227], v[108:111]
  v_mfma_f32_16x16x32_bf16 v[108:111], a[148:151], a[228:231], v[108:111]
  v_mfma_f32_16x16x32_bf16 v[108:111], a[152:155], a[232:235], v[108:111]
  v_mfma_f32_16x16x32_bf16 v[108:111], a[156:159], a[236:239], v[108:111]
  ds_write_b128 v15, v[104:107]
  s_nop 6
  ds_write_b128 v15, v[108:111] offset:1024
  s_waitcnt lgkmcnt(0)
  s_barrier
  s_cmp_ge_u32 s16, 2
  s_cbranch_scc1 LRs_125
  ds_read_b128 v[104:107], v29 offset:0
  ds_read_b128 v[108:111], v29 offset:2048
  ds_read_b128 v[112:115], v29 offset:4096
  ds_read_b128 v[116:119], v29 offset:6144
  s_waitcnt vmcnt(0) lgkmcnt(0)
  v_add_f32 v104, v104, v108
  v_add_f32 v112, v112, v116
  v_add_f32 v104, v104, v112
  v_add_f32 v105, v105, v109
  v_add_f32 v113, v113, v117
  v_add_f32 v105, v105, v113
  v_add_f32 v106, v106, v110
  v_add_f32 v114, v114, v118
  v_add_f32 v106, v106, v114
  v_add_f32 v107, v107, v111
  v_add_f32 v115, v115, v119
  v_add_f32 v107, v107, v115
  v_lshlrev_b32 v108, 16, v100
  v_and_b32 v109, 0xffff0000, v100
  v_lshlrev_b32 v110, 16, v101
  v_and_b32 v111, 0xffff0000, v101
  v_fmac_f32 v108, v24, v104
  v_fmac_f32 v109, v25, v105
  v_fmac_f32 v110, v26, v106
  v_fmac_f32 v111, v27, v107
  v_cvt_pk_bf16_f32 v100, v108, v109
  v_cvt_pk_bf16_f32 v101, v110, v111
  s_mul_i32 s35, s36, 40960
  s_add_u32 s35, s35, 148373504
  buffer_store_dwordx2 v[100:101], v28, s[4:7], s35 offen sc1
LRs_125:
  s_waitcnt vmcnt(0)
  s_barrier
  s_cmp_lg_u32 s16, 2
  s_cbranch_scc1 LRf_126
  s_mov_b32 s21, 64
  v_mov_b32 v102, s21
  s_add_u32 s20, s43, 344064
  buffer_store_dword v102, v30, s[4:7], s20 offen sc1
LRf_126:
  s_branch L_end
L_goAP:
  s_load_dwordx2 s[8:9], s[0:1], 16
  s_load_dwordx2 s[12:13], s[0:1], 24
  v_lshrrev_b32 v3, 6, v0
  v_and_b32 v1, 63, v0
  v_readfirstlane_b32 s16, v3
  v_lshlrev_b32 v2, 4, v1
  s_mov_b32 s19, 400000
  s_waitcnt lgkmcnt(0)
  s_nop 0
  s_cmp_ge_u32 s16, 2
  s_cselect_b32 s8, s12, s8
  s_cselect_b32 s9, s13, s9
  s_mov_b32 s10, 0x780000
  s_mov_b32 s11, 0x00020000
  v_mov_b32 v8, 0
  v_mov_b32 v80, 0x7ff00000
  v_cmp_eq_u32 vcc, 0, v0
  s_nop 1
  v_cndmask_b32 v8, v80, v8, vcc
  s_lshl_b32 s20, s17, 7
  s_add_u32 s44, s20, 0
  s_mul_i32 s20, s16, 24576
  s_add_u32 s20, s20, 65536
  v_add_u32 v15, s20, v2
  s_lshl_b32 s34, s16, 14
  v_add_u32 v83, 0, v1
  s_mov_b32 s20, 174763
  v_mul_lo_u32 v84, v83, s20
  v_lshrrev_b32 v84, 20, v84
  v_mul_u32_u24 v80, 6, v84
  v_sub_u32 v80, v83, v80
  v_lshlrev_b32 v80, 4, v80
  s_mov_b32 s20, 12288
  v_mul_lo_u32 v84, v84, s20
  v_add_u32 v80, v80, v84
  v_add_u32 v83, 64, v1
  s_mov_b32 s20, 174763
  v_mul_lo_u32 v84, v83, s20
  v_lshrrev_b32 v84, 20, v84
  v_mul_u32_u24 v81, 6, v84
  v_sub_u32 v81, v83, v81
  v_lshlrev_b32 v81, 4, v81
  s_mov_b32 s20, 12288
  v_mul_lo_u32 v84, v84, s20
  v_add_u32 v81, v81, v84
  v_add_u32 v83, 128, v1
  s_mov_b32 s20, 174763
  v_mul_lo_u32 v84, v83, s20
  v_lshrrev_b32 v84, 20, v84
  v_mul_u32_u24 v82, 6, v84
  v_sub_u32 v82, v83, v82
  v_lshlrev_b32 v82, 4, v82
  s_mov_b32 s20, 12288
  v_mul_lo_u32 v84, v84, s20
  v_add_u32 v82, v82, v84
  v_lshrrev_b32 v83, 4, v1
  v_mul_u32_u24 v83, 8, v83
  v_bfe_u32 v84, v1, 2, 2
  v_add_u32 v83, v83, v84
  v_mul_u32_u24 v83, 96, v83
  v_and_b32 v84, 3, v1
  v_lshlrev_b32 v84, 3, v84
  v_add_u32 v85, v83, v84
  v_add_u32 v85, s34, v85
  s_mul_i32 s35, s17, 384
  s_and_b32 s20, s16, 1
  s_mul_i32 s20, s20, 192
  s_add_u32 s35, s35, s20
  s_add_u32 s20, s35, 0
  s_add_u32 s21, s34, 0
  s_mov_b32 m0, s21
  s_nop 0
  buffer_load_dwordx4 v80, s[8:11], s20 offen lds
  s_add_u32 s21, s34, 1024
  s_mov_b32 m0, s21
  s_nop 0
  buffer_load_dwordx4 v81, s[8:11], s20 offen lds
  s_add_u32 s21, s34, 2048
  s_mov_b32 m0, s21
  s_nop 0
  buffer_load_dwordx4 v82, s[8:11], s20 offen lds
  s_add_u32 s20, s35, 96
  s_add_u32 s21, s34, 3072
  s_mov_b32 m0, s21
  s_nop 0
  buffer_load_dwordx4 v80, s[8:11], s20 offen lds
  s_add_u32 s21, s34, 4096
  s_mov_b32 m0, s21
  s_nop 0
  buffer_load_dwordx4 v81, s[8:11], s20 offen lds
  s_add_u32 s21, s34, 5120
  s_mov_b32 m0, s21
  s_nop 0
  buffer_load_dwordx4 v82, s[8:11], s20 offen lds
  s_add_u32 s20, s35, 393216
  s_add_u32 s21, s34, 6144
  s_mov_b32 m0, s21
  s_nop 0
  buffer_load_dwordx4 v80, s[8:11], s20 offen lds
  s_add_u32 s21, s34, 7168
  s_mov_b32 m0, s21
  s_nop 0
  buffer_load_dwordx4 v81, s[8:11], s20 offen lds
  s_add_u32 s21, s34, 8192
  s_mov_b32 m0, s21
  s_nop 0
  buffer_load_dwordx4 v82, s[8:11], s20 offen lds
  s_add_u32 s20, s35, 393312
  s_add_u32 s21, s34, 9216
  s_mov_b32 m0, s21
  s_nop 0
  buffer_load_dwordx4 v80, s[8:11], s20 offen lds
  s_add_u32 s21, s34, 10240
  s_mov_b32 m0, s21
  s_nop 0
  buffer_load_dwordx4 v81, s[8:11], s20 offen lds
  s_add_u32 s21, s34, 11264
  s_mov_b32 m0, s21
  s_nop 0
  buffer_load_dwordx4 v82, s[8:11], s20 offen lds
  s_waitcnt vmcnt(9)
  ds_read_b64_tr_b16 a[0:1], v85 offset:0
  ds_read_b64_tr_b16 a[2:3], v85 offset:384
  ds_read_b64_tr_b16 a[8:9], v85 offset:32
  ds_read_b64_tr_b16 a[10:11], v85 offset:416
  ds_read_b64_tr_b16 a[16:17], v85 offset:64
  ds_read_b64_tr_b16 a[18:19], v85 offset:448
  s_waitcnt lgkmcnt(0)
  s_add_u32 s20, s35, 786432
  s_add_u32 s21, s34, 12288
  s_mov_b32 m0, s21
  s_nop 0
  buffer_load_dwordx4 v80, s[8:11], s20 offen lds
  s_add_u32 s21, s34, 13312
  s_mov_b32 m0, s21
  s_nop 0
  buffer_load_dwordx4 v81, s[8:11], s20 offen lds
  s_add_u32 s21, s34, 14336
  s_mov_b32 m0, s21
  s_nop 0
  buffer_load_dwordx4 v82, s[8:11], s20 offen lds
  s_waitcnt vmcnt(9)
  ds_read_b64_tr_b16 a[24:25], v85 offset:3072
  ds_read_b64_tr_b16 a[26:27], v85 offset:3456
  ds_read_b64_tr_b16 v[88:89], v85 offset:3104
  ds_read_b64_tr_b16 v[90:91], v85 offset:3488
  ds_read_b64_tr_b16 a[32:33], v85 offset:3136
  ds_read_b64_tr_b16 a[34:35], v85 offset:3520
  s_waitcnt lgkmcnt(0)
  ds_write_b128 v15, v[88:91] offset:0
  s_add_u32 s20, s35, 786528
  s_add_u32 s21, s34, 0
  s_mov_b32 m0, s21
  s_nop 0
  buffer_load_dwordx4 v80, s[8:11], s20 offen lds
  s_add_u32 s21, s34, 1024
  s_mov_b32 m0, s21
  s_nop 0
  buffer_load_dwordx4 v81, s[8:11], s20 offen lds
  s_add_u32 s21, s34, 2048
  s_mov_b32 m0, s21
  s_nop 0
  buffer_load_dwordx4 v82, s[8:11], s20 offen lds
  s_waitcnt vmcnt(9)
  ds_read_b64_tr_b16 a[4:5], v85 offset:6144
  ds_read_b64_tr_b16 a[6:7], v85 offset:6528
  ds_read_b64_tr_b16 a[12:13], v85 offset:6176
  ds_read_b64_tr_b16 a[14:15], v85 offset:6560
  ds_read_b64_tr_b16 a[20:21], v85 offset:6208
  ds_read_b64_tr_b16 a[22:23], v85 offset:6592
  s_waitcnt lgkmcnt(0)
  s_add_u32 s20, s35, 1179648
  s_add_u32 s21, s34, 3072
  s_mov_b32 m0, s21
  s_nop 0
  buffer_load_dwordx4 v80, s[8:11], s20 offen lds
  s_add_u32 s21, s34, 4096
  s_mov_b32 m0, s21
  s_nop 0
  buffer_load_dwordx4 v81, s[8:11], s20 offen lds
  s_add_u32 s21, s34, 5120
  s_mov_b32 m0, s21
  s_nop 0
  buffer_load_dwordx4 v82, s[8:11], s20 offen lds
  s_waitcnt vmcnt(9)
  ds_read_b64_tr_b16 a[28:29], v85 offset:9216
  ds_read_b64_tr_b16 a[30:31], v85 offset:9600
  ds_read_b64_tr_b16 v[88:89], v85 offset:9248
  ds_read_b64_tr_b16 v[90:91], v85 offset:9632
  ds_read_b64_tr_b16 a[36:37], v85 offset:9280
  ds_read_b64_tr_b16 a[38:39], v85 offset:9664
  s_waitcnt lgkmcnt(0)
  ds_write_b128 v15, v[88:91] offset:1024
  s_add_u32 s20, s35, 1179744
  s_add_u32 s21, s34, 6144
  s_mov_b32 m0, s21
  s_nop 0
  buffer_load_dwordx4 v80, s[8:11], s20 offen lds
  s_add_u32 s21, s34, 7168
  s_mov_b32 m0, s21
  s_nop 0
  buffer_load_dwordx4 v81, s[8:11], s20 offen lds
  s_add_u32 s21, s34, 8192
  s_mov_b32 m0, s21
  s_nop 0
  buffer_load_dwordx4 v82, s[8:11], s20 offen lds
  s_waitcnt vmcnt(9)
  ds_read_b64_tr_b16 a[40:41], v85 offset:12288
  ds_read_b64_tr_b16 a[42:43], v85 offset:12672
  ds_read_b64_tr_b16 a[48:49], v85 offset:12320
  ds_read_b64_tr_b16 a[50:51], v85 offset:12704
  ds_read_b64_tr_b16 a[56:57], v85 offset:12352
  ds_read_b64_tr_b16 a[58:59], v85 offset:12736
  s_waitcnt lgkmcnt(0)
  s_add_u32 s20, s35, 1572864
  s_add_u32 s21, s34, 9216
  s_mov_b32 m0, s21
  s_nop 0
  buffer_load_dwordx4 v80, s[8:11], s20 offen lds
  s_add_u32 s21, s34, 10240
  s_mov_b32 m0, s21
  s_nop 0
  buffer_load_dwordx4 v81, s[8:11], s20 offen lds
  s_add_u32 s21, s34, 11264
  s_mov_b32 m0, s21
  s_nop 0
  buffer_load_dwordx4 v82, s[8:11], s20 offen lds
  s_waitcnt vmcnt(9)
  ds_read_b64_tr_b16 v[88:89], v85 offset:0
  ds_read_b64_tr_b16 v[90:91], v85 offset:384
  ds_read_b64_tr_b16 a[64:65], v85 offset:32
  ds_read_b64_tr_b16 a[66:67], v85 offset:416
  ds_read_b64_tr_b16 a[72:73], v85 offset:64
  ds_read_b64_tr_b16 a[74:75], v85 offset:448
  s_waitcnt lgkmcnt(0)
  ds_write_b128 v15, v[88:91] offset:2048
  s_add_u32 s20, s35, 1572960
  s_add_u32 s21, s34, 12288
  s_mov_b32 m0, s21
  s_nop 0
  buffer_load_dwordx4 v80, s[8:11], s20 offen lds
  s_add_u32 s21, s34, 13312
  s_mov_b32 m0, s21
  s_nop 0
  buffer_load_dwordx4 v81, s[8:11], s20 offen lds
  s_add_u32 s21, s34, 14336
  s_mov_b32 m0, s21
  s_nop 0
  buffer_load_dwordx4 v82, s[8:11], s20 offen lds
  s_waitcnt vmcnt(9)
  ds_read_b64_tr_b16 a[44:45], v85 offset:3072
  ds_read_b64_tr_b16 a[46:47], v85 offset:3456
  ds_read_b64_tr_b16 a[52:53], v85 offset:3104
  ds_read_b64_tr_b16 a[54:55], v85 offset:3488
  ds_read_b64_tr_b16 a[60:61], v85 offset:3136
  ds_read_b64_tr_b16 a[62:63], v85 offset:3520
  s_waitcnt lgkmcnt(0)
  s_add_u32 s20, s35, 1966080
  s_add_u32 s21, s34, 0
  s_mov_b32 m0, s21
  s_nop 0
  buffer_load_dwordx4 v80, s[8:11], s20 offen lds
  s_add_u32 s21, s34, 1024
  s_mov_b32 m0, s21
  s_nop 0
  buffer_load_dwordx4 v81, s[8:11], s20 offen lds
  s_add_u32 s21, s34, 2048
  s_mov_b32 m0, s21
  s_nop 0
  buffer_load_dwordx4 v82, s[8:11], s20 offen lds
  s_waitcnt vmcnt(9)
  ds_read_b64_tr_b16 v[88:89], v85 offset:6144
  ds_read_b64_tr_b16 v[90:91], v85 offset:6528
  ds_read_b64_tr_b16 a[68:69], v85 offset:6176
  ds_read_b64_tr_b16 a[70:71], v85 offset:6560
  ds_read_b64_tr_b16 a[76:77], v85 offset:6208
  ds_read_b64_tr_b16 a[78:79], v85 offset:6592
  s_waitcnt lgkmcnt(0)
  ds_write_b128 v15, v[88:91] offset:3072
  s_add_u32 s20, s35, 1966176
  s_add_u32 s21, s34, 3072
  s_mov_b32 m0, s21
  s_nop 0
  buffer_load_dwordx4 v80, s[8:11], s20 offen lds
  s_add_u32 s21, s34, 4096
  s_mov_b32 m0, s21
  s_nop 0
  buffer_load_dwordx4 v81, s[8:11], s20 offen lds
  s_add_u32 s21, s34, 5120
  s_mov_b32 m0, s21
  s_nop 0
  buffer_load_dwordx4 v82, s[8:11], s20 offen lds
  s_waitcnt vmcnt(9)
  ds_read_b64_tr_b16 a[80:81], v85 offset:9216
  ds_read_b64_tr_b16 a[82:83], v85 offset:9600
  ds_read_b64_tr_b16 a[88:89], v85 offset:9248
  ds_read_b64_tr_b16 a[90:91], v85 offset:9632
  ds_read_b64_tr_b16 v[88:89], v85 offset:9280
  ds_read_b64_tr_b16 v[90:91], v85 offset:9664
  s_waitcnt lgkmcnt(0)
  ds_write_b128 v15, v[88:91] offset:4096
  s_add_u32 s20, s35, 2359296
  s_add_u32 s21, s34, 6144
  s_mov_b32 m0, s21
  s_nop 0
  buffer_load_dwordx4 v80, s[8:11], s20 offen lds
  s_add_u32 s21, s34, 7168
  s_mov_b32 m0, s21
  s_nop 0
  buffer_load_dwordx4 v81, s[8:11], s20 offen lds
  s_add_u32 s21, s34, 8192
  s_mov_b32 m0, s21
  s_nop 0
  buffer_load_dwordx4 v82, s[8:11], s20 offen lds
  s_waitcnt vmcnt(9)
  ds_read_b64_tr_b16 a[96:97], v85 offset:12288
  ds_read_b64_tr_b16 a[98:99], v85 offset:12672
  ds_read_b64_tr_b16 a[104:105], v85 offset:12320
  ds_read_b64_tr_b16 a[106:107], v85 offset:12704
  ds_read_b64_tr_b16 a[112:113], v85 offset:12352
  ds_read_b64_tr_b16 a[114:115], v85 offset:12736
  s_waitcnt lgkmcnt(0)
  s_add_u32 s20, s35, 2359392
  s_add_u32 s21, s34, 9216
  s_mov_b32 m0, s21
  s_nop 0
  buffer_load_dwordx4 v80, s[8:11], s20 offen lds
  s_add_u32 s21, s34, 10240
  s_mov_b32 m0, s21
  s_nop 0
  buffer_load_dwordx4 v81, s[8:11], s20 offen lds
  s_add_u32 s21, s34, 11264
  s_mov_b32 m0, s21
  s_nop 0
  buffer_load_dwordx4 v82, s[8:11], s20 offen lds
  s_waitcnt vmcnt(9)
  ds_read_b64_tr_b16 a[84:85], v85 offset:0
  ds_read_b64_tr_b16 a[86:87], v85 offset:384
  ds_read_b64_tr_b16 a[92:93], v85 offset:32
  ds_read_b64_tr_b16 a[94:95], v85 offset:416
  ds_read_b64_tr_b16 v[88:89], v85 offset:64
  ds_read_b64_tr_b16 v[90:91], v85 offset:448
  s_waitcnt lgkmcnt(0)
  ds_write_b128 v15, v[88:91] offset:5120
  s_add_u32 s20, s35, 2752512
  s_add_u32 s21, s34, 12288
  s_mov_b32 m0, s21
  s_nop 0
  buffer_load_dwordx4 v80, s[8:11], s20 offen lds
  s_add_u32 s21, s34, 13312
  s_mov_b32 m0, s21
  s_nop 0
  buffer_load_dwordx4 v81, s[8:11], s20 offen lds
  s_add_u32 s21, s34, 14336
  s_mov_b32 m0, s21
  s_nop 0
  buffer_load_dwordx4 v82, s[8:11], s20 offen lds
  s_waitcnt vmcnt(9)
  ds_read_b64_tr_b16 a[100:101], v85 offset:3072
  ds_read_b64_tr_b16 a[102:103], v85 offset:3456
  ds_read_b64_tr_b16 a[108:109], v85 offset:3104
  ds_read_b64_tr_b16 a[110:111], v85 offset:3488
  ds_read_b64_tr_b16 a[116:117], v85 offset:3136
  ds_read_b64_tr_b16 a[118:119], v85 offset:3520
  s_waitcnt lgkmcnt(0)
  s_add_u32 s20, s35, 2752608
  s_add_u32 s21, s34, 0
  s_mov_b32 m0, s21
  s_nop 0
  buffer_load_dwordx4 v80, s[8:11], s20 offen lds
  s_add_u32 s21, s34, 1024
  s_mov_b32 m0, s21
  s_nop 0
  buffer_load_dwordx4 v81, s[8:11], s20 offen lds
  s_add_u32 s21, s34, 2048
  s_mov_b32 m0, s21
  s_nop 0
  buffer_load_dwordx4 v82, s[8:11], s20 offen lds
  s_waitcnt vmcnt(9)
  ds_read_b64_tr_b16 a[120:121], v85 offset:6144
  ds_read_b64_tr_b16 a[122:123], v85 offset:6528
  ds_read_b64_tr_b16 v[88:89], v85 offset:6176
  ds_read_b64_tr_b16 v[90:91], v85 offset:6560
  ds_read_b64_tr_b16 a[128:129], v85 offset:6208
  ds_read_b64_tr_b16 a[130:131], v85 offset:6592
  s_waitcnt lgkmcnt(0)
  ds_write_b128 v15, v[88:91] offset:6144
  s_add_u32 s20, s35, 3145728
  s_add_u32 s21, s34, 3072
  s_mov_b32 m0, s21
  s_nop 0
  buffer_load_dwordx4 v80, s[8:11], s20 offen lds
  s_add_u32 s21, s34, 4096
  s_mov_b32 m0, s21
  s_nop 0
  buffer_load_dwordx4 v81, s[8:11], s20 offen lds
  s_add_u32 s21, s34, 5120
  s_mov_b32 m0, s21
  s_nop 0
  buffer_load_dwordx4 v82, s[8:11], s20 offen lds
  s_waitcnt vmcnt(9)
  ds_read_b64_tr_b16 a[136:137], v85 offset:9216
  ds_read_b64_tr_b16 a[138:139], v85 offset:9600
  ds_read_b64_tr_b16 a[144:145], v85 offset:9248
  ds_read_b64_tr_b16 a[146:147], v85 offset:9632
  ds_read_b64_tr_b16 a[152:153], v85 offset:9280
  ds_read_b64_tr_b16 a[154:155], v85 offset:9664
  s_waitcnt lgkmcnt(0)
  s_add_u32 s20, s35, 3145824
  s_add_u32 s21, s34, 6144
  s_mov_b32 m0, s21
  s_nop 0
  buffer_load_dwordx4 v80, s[8:11], s20 offen lds
  s_add_u32 s21, s34, 7168
  s_mov_b32 m0, s21
  s_nop 0
  buffer_load_dwordx4 v81, s[8:11], s20 offen lds
  s_add_u32 s21, s34, 8192
  s_mov_b32 m0, s21
  s_nop 0
  buffer_load_dwordx4 v82, s[8:11], s20 offen lds
  s_waitcnt vmcnt(9)
  ds_read_b64_tr_b16 a[124:125], v85 offset:12288
  ds_read_b64_tr_b16 a[126:127], v85 offset:12672
  ds_read_b64_tr_b16 v[88:89], v85 offset:12320
  ds_read_b64_tr_b16 v[90:91], v85 offset:12704
  ds_read_b64_tr_b16 a[132:133], v85 offset:12352
  ds_read_b64_tr_b16 a[134:135], v85 offset:12736
  s_waitcnt lgkmcnt(0)
  ds_write_b128 v15, v[88:91] offset:7168
  s_add_u32 s20, s35, 3538944
  s_add_u32 s21, s34, 9216
  s_mov_b32 m0, s21
  s_nop 0
  buffer_load_dwordx4 v80, s[8:11], s20 offen lds
  s_add_u32 s21, s34, 10240
  s_mov_b32 m0, s21
  s_nop 0
  buffer_load_dwordx4 v81, s[8:11], s20 offen lds
  s_add_u32 s21, s34, 11264
  s_mov_b32 m0, s21
  s_nop 0
  buffer_load_dwordx4 v82, s[8:11], s20 offen lds
  s_waitcnt vmcnt(9)
  ds_read_b64_tr_b16 a[140:141], v85 offset:0
  ds_read_b64_tr_b16 a[142:143], v85 offset:384
  ds_read_b64_tr_b16 a[148:149], v85 offset:32
  ds_read_b64_tr_b16 a[150:151], v85 offset:416
  ds_read_b64_tr_b16 a[156:157], v85 offset:64
  ds_read_b64_tr_b16 a[158:159], v85 offset:448
  s_waitcnt lgkmcnt(0)
  s_add_u32 s20, s35, 3539040
  s_add_u32 s21, s34, 12288
  s_mov_b32 m0, s21
  s_nop 0
  buffer_load_dwordx4 v80, s[8:11], s20 offen lds
  s_add_u32 s21, s34, 13312
  s_mov_b32 m0, s21
  s_nop 0
  buffer_load_dwordx4 v81, s[8:11], s20 offen lds
  s_add_u32 s21, s34, 14336
  s_mov_b32 m0, s21
  s_nop 0
  buffer_load_dwordx4 v82, s[8:11], s20 offen lds
  s_waitcnt vmcnt(9)
  ds_read_b64_tr_b16 v[88:89], v85 offset:3072
  ds_read_b64_tr_b16 v[90:91], v85 offset:3456
  ds_read_b64_tr_b16 a[160:161], v85 offset:3104
  ds_read_b64_tr_b16 a[162:163], v85 offset:3488
  ds_read_b64_tr_b16 a[168:169], v85 offset:3136
  ds_read_b64_tr_b16 a[170:171], v85 offset:3520
  s_waitcnt lgkmcnt(0)
  ds_write_b128 v15, v[88:91] offset:8192
  s_add_u32 s20, s35, 3932160
  s_add_u32 s21, s34, 0
  s_mov_b32 m0, s21
  s_nop 0
  buffer_load_dwordx4 v80, s[8:11], s20 offen lds
  s_add_u32 s21, s34, 1024
  s_mov_b32 m0, s21
  s_nop 0
  buffer_load_dwordx4 v81, s[8:11], s20 offen lds
  s_add_u32 s21, s34, 2048
  s_mov_b32 m0, s21
  s_nop 0
  buffer_load_dwordx4 v82, s[8:11], s20 offen lds
  s_waitcnt vmcnt(9)
  ds_read_b64_tr_b16 a[176:177], v85 offset:6144
  ds_read_b64_tr_b16 a[178:179], v85 offset:6528
  ds_read_b64_tr_b16 a[184:185], v85 offset:6176
  ds_read_b64_tr_b16 a[186:187], v85 offset:6560
  ds_read_b64_tr_b16 v[88:89], v85 offset:6208
  ds_read_b64_tr_b16 v[90:91], v85 offset:6592
  s_waitcnt lgkmcnt(0)
  ds_write_b128 v15, v[88:91] offset:10240
  s_add_u32 s20, s35, 3932256
  s_add_u32 s21, s34, 3072
  s_mov_b32 m0, s21
  s_nop 0
  buffer_load_dwordx4 v80, s[8:11], s20 offen lds
  s_add_u32 s21, s34, 4096
  s_mov_b32 m0, s21
  s_nop 0
  buffer_load_dwordx4 v81, s[8:11], s20 offen lds
  s_add_u32 s21, s34, 5120
  s_mov_b32 m0, s21
  s_nop 0
  buffer_load_dwordx4 v82, s[8:11], s20 offen lds
  s_waitcnt vmcnt(9)
  ds_read_b64_tr_b16 v[88:89], v85 offset:9216
  ds_read_b64_tr_b16 v[90:91], v85 offset:9600
  ds_read_b64_tr_b16 a[164:165], v85 offset:9248
  ds_read_b64_tr_b16 a[166:167], v85 offset:9632
  ds_read_b64_tr_b16 a[172:173], v85 offset:9280
  ds_read_b64_tr_b16 a[174:175], v85 offset:9664
  s_waitcnt lgkmcnt(0)
  ds_write_b128 v15, v[88:91] offset:9216
  s_add_u32 s20, s35, 4325376
  s_add_u32 s21, s34, 6144
  s_mov_b32 m0, s21
  s_nop 0
  buffer_load_dwordx4 v80, s[8:11], s20 offen lds
  s_add_u32 s21, s34, 7168
  s_mov_b32 m0, s21
  s_nop 0
  buffer_load_dwordx4 v81, s[8:11], s20 offen lds
  s_add_u32 s21, s34, 8192
  s_mov_b32 m0, s21
  s_nop 0
  buffer_load_dwordx4 v82, s[8:11], s20 offen lds
  s_waitcnt vmcnt(9)
  ds_read_b64_tr_b16 a[180:181], v85 offset:12288
  ds_read_b64_tr_b16 a[182:183], v85 offset:12672
  ds_read_b64_tr_b16 a[188:189], v85 offset:12320
  ds_read_b64_tr_b16 a[190:191], v85 offset:12704
  ds_read_b64_tr_b16 v[88:89], v85 offset:12352
  ds_read_b64_tr_b16 v[90:91], v85 offset:12736
  s_waitcnt lgkmcnt(0)
  ds_write_b128 v15, v[88:91] offset:11264
  s_add_u32 s20, s35, 4325472
  s_add_u32 s21, s34, 9216
  s_mov_b32 m0, s21
  s_nop 0
  buffer_load_dwordx4 v80, s[8:11], s20 offen lds
  s_add_u32 s21, s34, 10240
  s_mov_b32 m0, s21
  s_nop 0
  buffer_load_dwordx4 v81, s[8:11], s20 offen lds
  s_add_u32 s21, s34, 11264
  s_mov_b32 m0, s21
  s_nop 0
  buffer_load_dwordx4 v82, s[8:11], s20 offen lds
  s_waitcnt vmcnt(9)
  ds_read_b64_tr_b16 a[192:193], v85 offset:0
  ds_read_b64_tr_b16 a[194:195], v85 offset:384
  ds_read_b64_tr_b16 a[200:201], v85 offset:32
  ds_read_b64_tr_b16 a[202:203], v85 offset:416
  ds_read_b64_tr_b16 a[208:209], v85 offset:64
  ds_read_b64_tr_b16 a[210:211], v85 offset:448
  s_waitcnt lgkmcnt(0)
  s_add_u32 s20, s35, 4718592
  s_add_u32 s21, s34, 12288
  s_mov_b32 m0, s21
  s_nop 0
  buffer_load_dwordx4 v80, s[8:11], s20 offen lds
  s_add_u32 s21, s34, 13312
  s_mov_b32 m0, s21
  s_nop 0
  buffer_load_dwordx4 v81, s[8:11], s20 offen lds
  s_add_u32 s21, s34, 14336
  s_mov_b32 m0, s21
  s_nop 0
  buffer_load_dwordx4 v82, s[8:11], s20 offen lds
  s_waitcnt vmcnt(9)
  ds_read_b64_tr_b16 a[216:217], v85 offset:3072
  ds_read_b64_tr_b16 a[218:219], v85 offset:3456
  ds_read_b64_tr_b16 v[88:89], v85 offset:3104
  ds_read_b64_tr_b16 v[90:91], v85 offset:3488
  ds_read_b64_tr_b16 a[224:225], v85 offset:3136
  ds_read_b64_tr_b16 a[226:227], v85 offset:3520
  s_waitcnt lgkmcnt(0)
  ds_write_b128 v15, v[88:91] offset:12288
  s_add_u32 s20, s35, 4718688
  s_add_u32 s21, s34, 0
  s_mov_b32 m0, s21
  s_nop 0
  buffer_load_dwordx4 v80, s[8:11], s20 offen lds
  s_add_u32 s21, s34, 1024
  s_mov_b32 m0, s21
  s_nop 0
  buffer_load_dwordx4 v81, s[8:11], s20 offen lds
  s_add_u32 s21, s34, 2048
  s_mov_b32 m0, s21
  s_nop 0
  buffer_load_dwordx4 v82, s[8:11], s20 offen lds
  s_waitcnt vmcnt(9)
  ds_read_b64_tr_b16 a[196:197], v85 offset:6144
  ds_read_b64_tr_b16 a[198:199], v85 offset:6528
  ds_read_b64_tr_b16 a[204:205], v85 offset:6176
  ds_read_b64_tr_b16 a[206:207], v85 offset:6560
  ds_read_b64_tr_b16 a[212:213], v85 offset:6208
  ds_read_b64_tr_b16 a[214:215], v85 offset:6592
  s_waitcnt lgkmcnt(0)
  s_add_u32 s20, s35, 5111808
  s_add_u32 s21, s34, 3072
  s_mov_b32 m0, s21
  s_nop 0
  buffer_load_dwordx4 v80, s[8:11], s20 offen lds
  s_add_u32 s21, s34, 4096
  s_mov_b32 m0, s21
  s_nop 0
  buffer_load_dwordx4 v81, s[8:11], s20 offen lds
  s_add_u32 s21, s34, 5120
  s_mov_b32 m0, s21
  s_nop 0
  buffer_load_dwordx4 v82, s[8:11], s20 offen lds
  s_waitcnt vmcnt(9)
  ds_read_b64_tr_b16 a[220:221], v85 offset:9216
  ds_read_b64_tr_b16 a[222:223], v85 offset:9600
  ds_read_b64_tr_b16 v[88:89], v85 offset:9248
  ds_read_b64_tr_b16 v[90:91], v85 offset:9632
  ds_read_b64_tr_b16 a[228:229], v85 offset:9280
  ds_read_b64_tr_b16 a[230:231], v85 offset:9664
  s_waitcnt lgkmcnt(0)
  ds_write_b128 v15, v[88:91] offset:13312
  s_add_u32 s20, s35, 5111904
  s_add_u32 s21, s34, 6144
  s_mov_b32 m0, s21
  s_nop 0
  buffer_load_dwordx4 v80, s[8:11], s20 offen lds
  s_add_u32 s21, s34, 7168
  s_mov_b32 m0, s21
  s_nop 0
  buffer_load_dwordx4 v81, s[8:11], s20 offen lds
  s_add_u32 s21, s34, 8192
  s_mov_b32 m0, s21
  s_nop 0
  buffer_load_dwordx4 v82, s[8:11], s20 offen lds
  s_waitcnt vmcnt(9)
  ds_read_b64_tr_b16 a[232:233], v85 offset:12288
  ds_read_b64_tr_b16 a[234:235], v85 offset:12672
  ds_read_b64_tr_b16 a[240:241], v85 offset:12320
  ds_read_b64_tr_b16 a[242:243], v85 offset:12704
  ds_read_b64_tr_b16 a[248:249], v85 offset:12352
  ds_read_b64_tr_b16 a[250:251], v85 offset:12736
  s_waitcnt lgkmcnt(0)
  s_add_u32 s20, s35, 5505024
  s_add_u32 s21, s34, 9216
  s_mov_b32 m0, s21
  s_nop 0
  buffer_load_dwordx4 v80, s[8:11], s20 offen lds
  s_add_u32 s21, s34, 10240
  s_mov_b32 m0, s21
  s_nop 0
  buffer_load_dwordx4 v81, s[8:11], s20 offen lds
  s_add_u32 s21, s34, 11264
  s_mov_b32 m0, s21
  s_nop 0
  buffer_load_dwordx4 v82, s[8:11], s20 offen lds
  s_waitcnt vmcnt(9)
  ds_read_b64_tr_b16 v[88:89], v85 offset:0
  ds_read_b64_tr_b16 v[90:91], v85 offset:384
  ds_read_b64_tr_b16 v[128:129], v85 offset:32
  ds_read_b64_tr_b16 v[130:131], v85 offset:416
  ds_read_b64_tr_b16 v[136:137], v85 offset:64
  ds_read_b64_tr_b16 v[138:139], v85 offset:448
  s_waitcnt lgkmcnt(0)
  ds_write_b128 v15, v[88:91] offset:14336
  s_add_u32 s20, s35, 5505120
  s_add_u32 s21, s34, 12288
  s_mov_b32 m0, s21
  s_nop 0
  buffer_load_dwordx4 v80, s[8:11], s20 offen lds
  s_add_u32 s21, s34, 13312
  s_mov_b32 m0, s21
  s_nop 0
  buffer_load_dwordx4 v81, s[8:11], s20 offen lds
  s_add_u32 s21, s34, 14336
  s_mov_b32 m0, s21
  s_nop 0
  buffer_load_dwordx4 v82, s[8:11], s20 offen lds
  s_waitcnt vmcnt(9)
  ds_read_b64_tr_b16 a[236:237], v85 offset:3072
  ds_read_b64_tr_b16 a[238:239], v85 offset:3456
  ds_read_b64_tr_b16 a[244:245], v85 offset:3104
  ds_read_b64_tr_b16 a[246:247], v85 offset:3488
  ds_read_b64_tr_b16 a[252:253], v85 offset:3136
  ds_read_b64_tr_b16 a[254:255], v85 offset:3520
  s_waitcnt lgkmcnt(0)
  s_add_u32 s20, s35, 5898240
  s_add_u32 s21, s34, 0
  s_mov_b32 m0, s21
  s_nop 0
  buffer_load_dwordx4 v80, s[8:11], s20 offen lds
  s_add_u32 s21, s34, 1024
  s_mov_b32 m0, s21
  s_nop 0
  buffer_load_dwordx4 v81, s[8:11], s20 offen lds
  s_add_u32 s21, s34, 2048
  s_mov_b32 m0, s21
  s_nop 0
  buffer_load_dwordx4 v82, s[8:11], s20 offen lds
  s_waitcnt vmcnt(9)
  ds_read_b64_tr_b16 v[88:89], v85 offset:6144
  ds_read_b64_tr_b16 v[90:91], v85 offset:6528
  ds_read_b64_tr_b16 v[132:133], v85 offset:6176
  ds_read_b64_tr_b16 v[134:135], v85 offset:6560
  ds_read_b64_tr_b16 v[140:141], v85 offset:6208
  ds_read_b64_tr_b16 v[142:143], v85 offset:6592
  s_waitcnt lgkmcnt(0)
  ds_write_b128 v15, v[88:91] offset:15360
  s_add_u32 s20, s35, 5898336
  s_add_u32 s21, s34, 3072
  s_mov_b32 m0, s21
  s_nop 0
  buffer_load_dwordx4 v80, s[8:11], s20 offen lds
  s_add_u32 s21, s34, 4096
  s_mov_b32 m0, s21
  s_nop 0
  buffer_load_dwordx4 v81, s[8:11], s20 offen lds
  s_add_u32 s21, s34, 5120
  s_mov_b32 m0, s21
  s_nop 0
  buffer_load_dwordx4 v82, s[8:11], s20 offen lds
  s_waitcnt vmcnt(9)
  ds_read_b64_tr_b16 v[144:145], v85 offset:9216
  ds_read_b64_tr_b16 v[146:147], v85 offset:9600
  ds_read_b64_tr_b16 v[152:153], v85 offset:9248
  ds_read_b64_tr_b16 v[154:155], v85 offset:9632
  ds_read_b64_tr_b16 v[88:89], v85 offset:9280
  ds_read_b64_tr_b16 v[90:91], v85 offset:9664
  s_waitcnt lgkmcnt(0)
  ds_write_b128 v15, v[88:91] offset:16384
  s_add_u32 s20, s35, 6291456
  s_add_u32 s21, s34, 6144
  s_mov_b32 m0, s21
  s_nop 0
  buffer_load_dwordx4 v80, s[8:11], s20 offen lds
  s_add_u32 s21, s34, 7168
  s_mov_b32 m0, s21
  s_nop 0
  buffer_load_dwordx4 v81, s[8:11], s20 offen lds
  s_add_u32 s21, s34, 8192
  s_mov_b32 m0, s21
  s_nop 0
  buffer_load_dwordx4 v82, s[8:11], s20 offen lds
  s_waitcnt vmcnt(9)
  ds_read_b64_tr_b16 v[160:161], v85 offset:12288
  ds_read_b64_tr_b16 v[162:163], v85 offset:12672
  ds_read_b64_tr_b16 v[168:169], v85 offset:12320
  ds_read_b64_tr_b16 v[170:171], v85 offset:12704
  ds_read_b64_tr_b16 v[176:177], v85 offset:12352
  ds_read_b64_tr_b16 v[178:179], v85 offset:12736
  s_waitcnt lgkmcnt(0)
  s_add_u32 s20, s35, 6291552
  s_add_u32 s21, s34, 9216
  s_mov_b32 m0, s21
  s_nop 0
  buffer_load_dwordx4 v80, s[8:11], s20 offen lds
  s_add_u32 s21, s34, 10240
  s_mov_b32 m0, s21
  s_nop 0
  buffer_load_dwordx4 v81, s[8:11], s20 offen lds
  s_add_u32 s21, s34, 11264
  s_mov_b32 m0, s21
  s_nop 0
  buffer_load_dwordx4 v82, s[8:11], s20 offen lds
  s_waitcnt vmcnt(9)
  ds_read_b64_tr_b16 v[148:149], v85 offset:0
  ds_read_b64_tr_b16 v[150:151], v85 offset:384
  ds_read_b64_tr_b16 v[156:157], v85 offset:32
  ds_read_b64_tr_b16 v[158:159], v85 offset:416
  ds_read_b64_tr_b16 v[88:89], v85 offset:64
  ds_read_b64_tr_b16 v[90:91], v85 offset:448
  s_waitcnt lgkmcnt(0)
  ds_write_b128 v15, v[88:91] offset:17408
  s_add_u32 s20, s35, 6684672
  s_add_u32 s21, s34, 12288
  s_mov_b32 m0, s21
  s_nop 0
  buffer_load_dwordx4 v80, s[8:11], s20 offen lds
  s_add_u32 s21, s34, 13312
  s_mov_b32 m0, s21
  s_nop 0
  buffer_load_dwordx4 v81, s[8:11], s20 offen lds
  s_add_u32 s21, s34, 14336
  s_mov_b32 m0, s21
  s_nop 0
  buffer_load_dwordx4 v82, s[8:11], s20 offen lds
  s_waitcnt vmcnt(9)
  ds_read_b64_tr_b16 v[164:165], v85 offset:3072
  ds_read_b64_tr_b16 v[166:167], v85 offset:3456
  ds_read_b64_tr_b16 v[172:173], v85 offset:3104
  ds_read_b64_tr_b16 v[174:175], v85 offset:3488
  ds_read_b64_tr_b16 v[180:181], v85 offset:3136
  ds_read_b64_tr_b16 v[182:183], v85 offset:3520
  s_waitcnt lgkmcnt(0)
  s_add_u32 s20, s35, 6684768
  s_add_u32 s21, s34, 0
  s_mov_b32 m0, s21
  s_nop 0
  buffer_load_dwordx4 v80, s[8:11], s20 offen lds
  s_add_u32 s21, s34, 1024
  s_mov_b32 m0, s21
  s_nop 0
  buffer_load_dwordx4 v81, s[8:11], s20 offen lds
  s_add_u32 s21, s34, 2048
  s_mov_b32 m0, s21
  s_nop 0
  buffer_load_dwordx4 v82, s[8:11], s20 offen lds
  s_waitcnt vmcnt(9)
  ds_read_b64_tr_b16 v[184:185], v85 offset:6144
  ds_read_b64_tr_b16 v[186:187], v85 offset:6528
  ds_read_b64_tr_b16 v[88:89], v85 offset:6176
  ds_read_b64_tr_b16 v[90:91], v85 offset:6560
  ds_read_b64_tr_b16 v[192:193], v85 offset:6208
  ds_read_b64_tr_b16 v[194:195], v85 offset:6592
  s_waitcnt lgkmcnt(0)
  ds_write_b128 v15, v[88:91] offset:18432
  s_add_u32 s20, s35, 7077888
  s_add_u32 s21, s34, 3072
  s_mov_b32 m0, s21
  s_nop 0
  buffer_load_dwordx4 v80, s[8:11], s20 offen lds
  s_add_u32 s21, s34, 4096
  s_mov_b32 m0, s21
  s_nop 0
  buffer_load_dwordx4 v81, s[8:11], s20 offen lds
  s_add_u32 s21, s34, 5120
  s_mov_b32 m0, s21
  s_nop 0
  buffer_load_dwordx4 v82, s[8:11], s20 offen lds
  s_waitcnt vmcnt(9)
  ds_read_b64_tr_b16 v[200:201], v85 offset:9216
  ds_read_b64_tr_b16 v[202:203], v85 offset:9600
  ds_read_b64_tr_b16 v[208:209], v85 offset:9248
  ds_read_b64_tr_b16 v[210:211], v85 offset:9632
  ds_read_b64_tr_b16 v[216:217], v85 offset:9280
  ds_read_b64_tr_b16 v[218:219], v85 offset:9664
  s_waitcnt lgkmcnt(0)
  s_add_u32 s20, s35, 7077984
  s_add_u32 s21, s34, 6144
  s_mov_b32 m0, s21
  s_nop 0
  buffer_load_dwordx4 v80, s[8:11], s20 offen lds
  s_add_u32 s21, s34, 7168
  s_mov_b32 m0, s21
  s_nop 0
  buffer_load_dwordx4 v81, s[8:11], s20 offen lds
  s_add_u32 s21, s34, 8192
  s_mov_b32 m0, s21
  s_nop 0
  buffer_load_dwordx4 v82, s[8:11], s20 offen lds
  s_waitcnt vmcnt(9)
  ds_read_b64_tr_b16 v[188:189], v85 offset:12288
  ds_read_b64_tr_b16 v[190:191], v85 offset:12672
  ds_read_b64_tr_b16 v[88:89], v85 offset:12320
  ds_read_b64_tr_b16 v[90:91], v85 offset:12704
  ds_read_b64_tr_b16 v[196:197], v85 offset:12352
  ds_read_b64_tr_b16 v[198:199], v85 offset:12736
  s_waitcnt lgkmcnt(0)
  ds_write_b128 v15, v[88:91] offset:19456
  s_add_u32 s20, s35, 7471104
  s_add_u32 s21, s34, 9216
  s_mov_b32 m0, s21
  s_nop 0
  buffer_load_dwordx4 v80, s[8:11], s20 offen lds
  s_add_u32 s21, s34, 10240
  s_mov_b32 m0, s21
  s_nop 0
  buffer_load_dwordx4 v81, s[8:11], s20 offen lds
  s_add_u32 s21, s34, 11264
  s_mov_b32 m0, s21
  s_nop 0
  buffer_load_dwordx4 v82, s[8:11], s20 offen lds
  s_waitcnt vmcnt(9)
  ds_read_b64_tr_b16 v[204:205], v85 offset:0
  ds_read_b64_tr_b16 v[206:207], v85 offset:384
  ds_read_b64_tr_b16 v[212:213], v85 offset:32
  ds_read_b64_tr_b16 v[214:215], v85 offset:416
  ds_read_b64_tr_b16 v[220:221], v85 offset:64
  ds_read_b64_tr_b16 v[222:223], v85 offset:448
  s_waitcnt lgkmcnt(0)
  s_add_u32 s20, s35, 7471200
  s_add_u32 s21, s34, 12288
  s_mov_b32 m0, s21
  s_nop 0
  buffer_load_dwordx4 v80, s[8:11], s20 offen lds
  s_add_u32 s21, s34, 13312
  s_mov_b32 m0, s21
  s_nop 0
  buffer_load_dwordx4 v81, s[8:11], s20 offen lds
  s_add_u32 s21, s34, 14336
  s_mov_b32 m0, s21
  s_nop 0
  buffer_load_dwordx4 v82, s[8:11], s20 offen lds
  s_waitcnt vmcnt(9)
  ds_read_b64_tr_b16 v[88:89], v85 offset:3072
  ds_read_b64_tr_b16 v[90:91], v85 offset:3456
  ds_read_b64_tr_b16 v[224:225], v85 offset:3104
  ds_read_b64_tr_b16 v[226:227], v85 offset:3488
  ds_read_b64_tr_b16 v[232:233], v85 offset:3136
  ds_read_b64_tr_b16 v[234:235], v85 offset:3520
  s_waitcnt lgkmcnt(0)
  ds_write_b128 v15, v[88:91] offset:20480
  s_waitcnt vmcnt(6)
  ds_read_b64_tr_b16 v[240:241], v85 offset:6144
  ds_read_b64_tr_b16 v[242:243], v85 offset:6528
  ds_read_b64_tr_b16 v[248:249], v85 offset:6176
  ds_read_b64_tr_b16 v[250:251], v85 offset:6560
  ds_read_b64_tr_b16 v[88:89], v85 offset:6208
  ds_read_b64_tr_b16 v[90:91], v85 offset:6592
  s_waitcnt lgkmcnt(0)
  ds_write_b128 v15, v[88:91] offset:22528
  s_waitcnt vmcnt(3)
  ds_read_b64_tr_b16 v[88:89], v85 offset:9216
  ds_read_b64_tr_b16 v[90:91], v85 offset:9600
  ds_read_b64_tr_b16 v[228:229], v85 offset:9248
  ds_read_b64_tr_b16 v[230:231], v85 offset:9632
  ds_read_b64_tr_b16 v[236:237], v85 offset:9280
  ds_read_b64_tr_b16 v[238:239], v85 offset:9664
  s_waitcnt lgkmcnt(0)
  ds_write_b128 v15, v[88:91] offset:21504
  s_waitcnt vmcnt(0)
  ds_read_b64_tr_b16 v[244:245], v85 offset:12288
  ds_read_b64_tr_b16 v[246:247], v85 offset:12672
  ds_read_b64_tr_b16 v[252:253], v85 offset:12320
  ds_read_b64_tr_b16 v[254:255], v85 offset:12704
  ds_read_b64_tr_b16 v[88:89], v85 offset:12352
  ds_read_b64_tr_b16 v[90:91], v85 offset:12736
  s_waitcnt lgkmcnt(0)
  ds_write_b128 v15, v[88:91] offset:23552
  s_waitcnt lgkmcnt(0)
  s_barrier
  s_mov_b32 s52, s32
  s_mov_b32 s53, s33
  s_mov_b32 s54, 256
  s_mov_b32 s55, 0x00020000
  s_cmp_lg_u32 s16, 0
  s_cbranch_scc1 Lwr_127
  v_lshrrev_b32 v16, 4, v2
  v_lshlrev_b32 v16, 7, v16
  v_mov_b32 v17, 196
  s_mov_b32 s51, 90112
  s_mov_b32 s50, 98304
Lwrt_128:
  buffer_load_dword v18, v16, s[4:7], s51 offen sc1
  s_waitcnt vmcnt(0)
  v_cmp_ne_u32 vcc, s70, v18
  s_cbranch_vccnz Lwra_130
  s_branch Lwrd_129
Lwra_130:
  s_sleep 2
  s_cmp_eq_u32 s19, 0
  s_cbranch_scc1 Lwrd_129
  s_sub_u32 s19, s19, 1
  s_branch Lwrt_128
Lwrd_129:
Lwr_127:
  s_barrier
  s_mul_i32 s30, s17, 24576
  s_lshr_b32 s20, s16, 1
  s_mul_i32 s20, s20, 12288
  s_add_u32 s30, s30, s20
  s_and_b32 s20, s16, 1
  s_mul_i32 s20, s20, 3072
  s_add_u32 s30, s30, s20
  s_add_u32 s30, s30, 8912896
  s_lshr_b32 s20, s16, 1
  s_and_b32 s21, s16, 1
  s_mul_i32 s21, s21, 5120
  s_mul_i32 s22, s20, 20480
  s_add_u32 s35, s22, s21
  s_add_u32 s35, s35, 6291456
  s_mul_i32 s22, s20, 10240
  s_add_u32 s36, s22, s21
  s_mov_b32 s27, 0
  s_mov_b32 s28, 20480
  s_mov_b32 s29, 40960
  s_mov_b32 s26, s35
  s_add_u32 s20, s27, s36
  s_mov_b32 m0, s20
  s_add_u32 s21, s26, 0
  buffer_load_dwordx4 v2, s[4:7], s21 offen sc1 lds
  s_add_u32 s20, s27, s36
  s_add_u32 s20, s20, 1024
  s_mov_b32 m0, s20
  s_add_u32 s21, s26, 1024
  buffer_load_dwordx4 v2, s[4:7], s21 offen sc1 lds
  s_add_u32 s20, s27, s36
  s_add_u32 s20, s20, 2048
  s_mov_b32 m0, s20
  s_add_u32 s21, s26, 2048
  buffer_load_dwordx4 v2, s[4:7], s21 offen sc1 lds
  s_add_u32 s20, s27, s36
  s_add_u32 s20, s20, 3072
  s_mov_b32 m0, s20
  s_add_u32 s21, s26, 3072
  buffer_load_dwordx4 v2, s[4:7], s21 offen sc1 lds
  s_add_u32 s20, s27, s36
  s_add_u32 s20, s20, 4096
  s_mov_b32 m0, s20
  s_add_u32 s21, s26, 4096
  buffer_load_dwordx4 v2, s[4:7], s21 offen sc1 lds
  s_add_u32 s26, s26, 10240
  s_add_u32 s20, s28, s36
  s_mov_b32 m0, s20
  s_add_u32 s21, s26, 0
  buffer_load_dwordx4 v2, s[4:7], s21 offen sc1 lds
  s_add_u32 s20, s28, s36
  s_add_u32 s20, s20, 1024
  s_mov_b32 m0, s20
  s_add_u32 s21, s26, 1024
  buffer_load_dwordx4 v2, s[4:7], s21 offen sc1 lds
  s_add_u32 s20, s28, s36
  s_add_u32 s20, s20, 2048
  s_mov_b32 m0, s20
  s_add_u32 s21, s26, 2048
  buffer_load_dwordx4 v2, s[4:7], s21 offen sc1 lds
  s_add_u32 s20, s28, s36
  s_add_u32 s20, s20, 3072
  s_mov_b32 m0, s20
  s_add_u32 s21, s26, 3072
  buffer_load_dwordx4 v2, s[4:7], s21 offen sc1 lds
  s_add_u32 s20, s28, s36
  s_add_u32 s20, s20, 4096
  s_mov_b32 m0, s20
  s_add_u32 s21, s26, 4096
  buffer_load_dwordx4 v2, s[4:7], s21 offen sc1 lds
  s_add_u32 s26, s26, 30720
  s_mov_b32 s18, 0
  ds_read_b128 v[80:83], v15 offset:0
  ds_read_b128 v[84:87], v15 offset:1024
  ds_read_b128 v[88:91], v15 offset:2048
  ds_read_b128 v[92:95], v15 offset:3072
  s_waitcnt vmcnt(5)
  s_branch LAPf_131
LAPl_132:
  s_cmp_lg_u32 s18, 16
  s_cbranch_scc1 LAPh_133
  s_mov_b32 s52, s32
  s_mov_b32 s53, s33
  s_mov_b32 s54, 256
  s_mov_b32 s55, 0x00020000
  s_cmp_lg_u32 s16, 0
  s_cbranch_scc1 Lwr_134
  v_lshrrev_b32 v16, 4, v2
  v_lshlrev_b32 v16, 7, v16
  v_mov_b32 v17, 196
  s_mov_b32 s51, 98304
  s_mov_b32 s50, 98304
Lwrt_135:
  buffer_load_dword v18, v16, s[4:7], s51 offen sc1
  s_waitcnt vmcnt(0)
  v_cmp_ne_u32 vcc, s70, v18
  s_cbranch_vccnz Lwra_137
  s_branch Lwrd_136
Lwra_137:
  s_sleep 2
  s_cmp_eq_u32 s19, 0
  s_cbranch_scc1 Lwrd_136
  s_sub_u32 s19, s19, 1
  s_branch Lwrt_135
Lwrd_136:
Lwr_134:
  s_barrier
LAPh_133:
  s_waitcnt vmcnt(12)
LAPf_131:
  s_barrier
  s_add_u32 s78, s29, s36
  s_mov_b32 s79, s26
  s_add_u32 s26, s26, 10240
  v_add_u32 v10, s27, v2
  ds_read_b128 v[64:67], v10 offset:0
  ds_read_b128 v[68:71], v10 offset:10240
  ds_read_b128 v[72:75], v10 offset:1024
  ds_read_b128 v[76:79], v10 offset:11264
  s_waitcnt lgkmcnt(2)
  v_mfma_f32_16x16x32_bf16 v[16:19], a[0:3], v[64:67], 0
  s_add_u32 s76, s78, 0
  s_mov_b32 m0, s76
  v_mfma_f32_16x16x32_bf16 v[20:23], a[0:3], v[68:71], 0
  s_add_u32 s77, s79, 0
  buffer_load_dwordx4 v2, s[4:7], s77 offen sc1 lds
  v_mfma_f32_16x16x32_bf16 v[24:27], a[8:11], v[64:67], 0
  s_add_u32 s76, s78, 1024
  s_mov_b32 m0, s76
  v_mfma_f32_16x16x32_bf16 v[28:31], a[8:11], v[68:71], 0
  s_add_u32 s77, s79, 1024
  buffer_load_dwordx4 v2, s[4:7], s77 offen sc1 lds
  v_mfma_f32_16x16x32_bf16 v[32:35], a[16:19], v[64:67], 0
  s_add_u32 s76, s78, 2048
  s_mov_b32 m0, s76
  v_mfma_f32_16x16x32_bf16 v[36:39], a[16:19], v[68:71], 0
  s_add_u32 s77, s79, 2048
  buffer_load_dwordx4 v2, s[4:7], s77 offen sc1 lds
  v_mfma_f32_16x16x32_bf16 v[40:43], a[24:27], v[64:67], 0
  s_add_u32 s76, s78, 3072
  s_mov_b32 m0, s76
  v_mfma_f32_16x16x32_bf16 v[44:47], a[24:27], v[68:71], 0
  s_add_u32 s77, s79, 3072
  buffer_load_dwordx4 v2, s[4:7], s77 offen sc1 lds
  v_mfma_f32_16x16x32_bf16 v[48:51], v[80:83], v[64:67], 0
  s_add_u32 s76, s78, 4096
  s_mov_b32 m0, s76
  v_mfma_f32_16x16x32_bf16 v[52:55], v[80:83], v[68:71], 0
  s_add_u32 s77, s79, 4096
  buffer_load_dwordx4 v2, s[4:7], s77 offen sc1 lds
  v_mfma_f32_16x16x32_bf16 v[56:59], a[32:35], v[64:67], 0
  v_mfma_f32_16x16x32_bf16 v[60:63], a[32:35], v[68:71], 0
  ds_read_b128 v[64:67], v10 offset:2048
  ds_read_b128 v[68:71], v10 offset:12288
  s_waitcnt lgkmcnt(2)
  v_mfma_f32_16x16x32_bf16 v[16:19], a[4:7], v[72:75], v[16:19]
  v_mfma_f32_16x16x32_bf16 v[20:23], a[4:7], v[76:79], v[20:23]
  v_mfma_f32_16x16x32_bf16 v[24:27], a[12:15], v[72:75], v[24:27]
  v_mfma_f32_16x16x32_bf16 v[28:31], a[12:15], v[76:79], v[28:31]
  v_mfma_f32_16x16x32_bf16 v[32:35], a[20:23], v[72:75], v[32:35]
  v_mfma_f32_16x16x32_bf16 v[36:39], a[20:23], v[76:79], v[36:39]
  v_mfma_f32_16x16x32_bf16 v[40:43], a[28:31], v[72:75], v[40:43]
  v_mfma_f32_16x16x32_bf16 v[44:47], a[28:31], v[76:79], v[44:47]
  v_mfma_f32_16x16x32_bf16 v[48:51], v[84:87], v[72:75], v[48:51]
  v_mfma_f32_16x16x32_bf16 v[52:55], v[84:87], v[76:79], v[52:55]
  ds_read_b128 v[80:83], v15 offset:4096
  ds_read_b128 v[84:87], v15 offset:5120
  v_mfma_f32_16x16x32_bf16 v[56:59], a[36:39], v[72:75], v[56:59]
  v_mfma_f32_16x16x32_bf16 v[60:63], a[36:39], v[76:79], v[60:63]
  ds_read_b128 v[72:75], v10 offset:3072
  ds_read_b128 v[76:79], v10 offset:13312
  s_waitcnt lgkmcnt(4)
  v_mfma_f32_16x16x32_bf16 v[16:19], a[40:43], v[64:67], v[16:19]
  v_mfma_f32_16x16x32_bf16 v[20:23], a[40:43], v[68:71], v[20:23]
  v_mfma_f32_16x16x32_bf16 v[24:27], a[48:51], v[64:67], v[24:27]
  v_mfma_f32_16x16x32_bf16 v[28:31], a[48:51], v[68:71], v[28:31]
  v_mfma_f32_16x16x32_bf16 v[32:35], a[56:59], v[64:67], v[32:35]
  v_mfma_f32_16x16x32_bf16 v[36:39], a[56:59], v[68:71], v[36:39]
  v_mfma_f32_16x16x32_bf16 v[40:43], v[88:91], v[64:67], v[40:43]
  v_mfma_f32_16x16x32_bf16 v[44:47], v[88:91], v[68:71], v[44:47]
  v_mfma_f32_16x16x32_bf16 v[48:51], a[64:67], v[64:67], v[48:51]
  v_mfma_f32_16x16x32_bf16 v[52:55], a[64:67], v[68:71], v[52:55]
  v_mfma_f32_16x16x32_bf16 v[56:59], a[72:75], v[64:67], v[56:59]
  v_mfma_f32_16x16x32_bf16 v[60:63], a[72:75], v[68:71], v[60:63]
  ds_read_b128 v[64:67], v10 offset:4096
  ds_read_b128 v[68:71], v10 offset:14336
  s_waitcnt lgkmcnt(2)
  v_mfma_f32_16x16x32_bf16 v[16:19], a[44:47], v[72:75], v[16:19]
  v_mfma_f32_16x16x32_bf16 v[20:23], a[44:47], v[76:79], v[20:23]
  v_mfma_f32_16x16x32_bf16 v[24:27], a[52:55], v[72:75], v[24:27]
  v_mfma_f32_16x16x32_bf16 v[28:31], a[52:55], v[76:79], v[28:31]
  v_mfma_f32_16x16x32_bf16 v[32:35], a[60:63], v[72:75], v[32:35]
  v_mfma_f32_16x16x32_bf16 v[36:39], a[60:63], v[76:79], v[36:39]
  v_mfma_f32_16x16x32_bf16 v[40:43], v[92:95], v[72:75], v[40:43]
  v_mfma_f32_16x16x32_bf16 v[44:47], v[92:95], v[76:79], v[44:47]
  ds_read_b128 v[88:91], v15 offset:6144
  ds_read_b128 v[92:95], v15 offset:7168
  v_mfma_f32_16x16x32_bf16 v[48:51], a[68:71], v[72:75], v[48:51]
  v_mfma_f32_16x16x32_bf16 v[52:55], a[68:71], v[76:79], v[52:55]
  v_mfma_f32_16x16x32_bf16 v[56:59], a[76:79], v[72:75], v[56:59]
  v_mfma_f32_16x16x32_bf16 v[60:63], a[76:79], v[76:79], v[60:63]
  ds_read_b128 v[72:75], v10 offset:5120
  ds_read_b128 v[76:79], v10 offset:15360
  s_waitcnt lgkmcnt(4)
  v_mfma_f32_16x16x32_bf16 v[16:19], a[80:83], v[64:67], v[16:19]
  v_mfma_f32_16x16x32_bf16 v[20:23], a[80:83], v[68:71], v[20:23]
  v_mfma_f32_16x16x32_bf16 v[24:27], a[88:91], v[64:67], v[24:27]
  v_mfma_f32_16x16x32_bf16 v[28:31], a[88:91], v[68:71], v[28:31]
  v_mfma_f32_16x16x32_bf16 v[32:35], v[80:83], v[64:67], v[32:35]
  v_mfma_f32_16x16x32_bf16 v[36:39], v[80:83], v[68:71], v[36:39]
  v_mfma_f32_16x16x32_bf16 v[40:43], a[96:99], v[64:67], v[40:43]
  v_mfma_f32_16x16x32_bf16 v[44:47], a[96:99], v[68:71], v[44:47]
  v_mfma_f32_16x16x32_bf16 v[48:51], a[104:107], v[64:67], v[48:51]
  v_mfma_f32_16x16x32_bf16 v[52:55], a[104:107], v[68:71], v[52:55]
  v_mfma_f32_16x16x32_bf16 v[56:59], a[112:115], v[64:67], v[56:59]
  v_mfma_f32_16x16x32_bf16 v[60:63], a[112:115], v[68:71], v[60:63]
  ds_read_b128 v[64:67], v10 offset:6144
  ds_read_b128 v[68:71], v10 offset:16384
  s_waitcnt lgkmcnt(2)
  v_mfma_f32_16x16x32_bf16 v[16:19], a[84:87], v[72:75], v[16:19]
  v_mfma_f32_16x16x32_bf16 v[20:23], a[84:87], v[76:79], v[20:23]
  v_mfma_f32_16x16x32_bf16 v[24:27], a[92:95], v[72:75], v[24:27]
  v_mfma_f32_16x16x32_bf16 v[28:31], a[92:95], v[76:79], v[28:31]
  v_mfma_f32_16x16x32_bf16 v[32:35], v[84:87], v[72:75], v[32:35]
  v_mfma_f32_16x16x32_bf16 v[36:39], v[84:87], v[76:79], v[36:39]
  ds_read_b128 v[80:83], v15 offset:8192
  ds_read_b128 v[84:87], v15 offset:9216
  v_mfma_f32_16x16x32_bf16 v[40:43], a[100:103], v[72:75], v[40:43]
  v_mfma_f32_16x16x32_bf16 v[44:47], a[100:103], v[76:79], v[44:47]
  v_mfma_f32_16x16x32_bf16 v[48:51], a[108:111], v[72:75], v[48:51]
  v_mfma_f32_16x16x32_bf16 v[52:55], a[108:111], v[76:79], v[52:55]
  v_mfma_f32_16x16x32_bf16 v[56:59], a[116:119], v[72:75], v[56:59]
  v_mfma_f32_16x16x32_bf16 v[60:63], a[116:119], v[76:79], v[60:63]
  ds_read_b128 v[72:75], v10 offset:7168
  ds_read_b128 v[76:79], v10 offset:17408
  s_waitcnt lgkmcnt(4)
  v_mfma_f32_16x16x32_bf16 v[16:19], a[120:123], v[64:67], v[16:19]
  v_mfma_f32_16x16x32_bf16 v[20:23], a[120:123], v[68:71], v[20:23]
  v_mfma_f32_16x16x32_bf16 v[24:27], v[88:91], v[64:67], v[24:27]
  v_mfma_f32_16x16x32_bf16 v[28:31], v[88:91], v[68:71], v[28:31]
  v_mfma_f32_16x16x32_bf16 v[32:35], a[128:131], v[64:67], v[32:35]
  v_mfma_f32_16x16x32_bf16 v[36:39], a[128:131], v[68:71], v[36:39]
  v_mfma_f32_16x16x32_bf16 v[40:43], a[136:139], v[64:67], v[40:43]
  v_mfma_f32_16x16x32_bf16 v[44:47], a[136:139], v[68:71], v[44:47]
  v_mfma_f32_16x16x32_bf16 v[48:51], a[144:147], v[64:67], v[48:51]
  v_mfma_f32_16x16x32_bf16 v[52:55], a[144:147], v[68:71], v[52:55]
  v_mfma_f32_16x16x32_bf16 v[56:59], a[152:155], v[64:67], v[56:59]
  v_mfma_f32_16x16x32_bf16 v[60:63], a[152:155], v[68:71], v[60:63]
  ds_read_b128 v[64:67], v10 offset:8192
  ds_read_b128 v[68:71], v10 offset:18432
  s_waitcnt lgkmcnt(2)
  v_mfma_f32_16x16x32_bf16 v[16:19], a[124:127], v[72:75], v[16:19]
  v_mfma_f32_16x16x32_bf16 v[20:23], a[124:127], v[76:79], v[20:23]
  v_mfma_f32_16x16x32_bf16 v[24:27], v[92:95], v[72:75], v[24:27]
  v_mfma_f32_16x16x32_bf16 v[28:31], v[92:95], v[76:79], v[28:31]
  ds_read_b128 v[88:91], v15 offset:10240
  ds_read_b128 v[92:95], v15 offset:11264
  v_mfma_f32_16x16x32_bf16 v[32:35], a[132:135], v[72:75], v[32:35]
  v_mfma_f32_16x16x32_bf16 v[36:39], a[132:135], v[76:79], v[36:39]
  v_mfma_f32_16x16x32_bf16 v[40:43], a[140:143], v[72:75], v[40:43]
  v_mfma_f32_16x16x32_bf16 v[44:47], a[140:143], v[76:79], v[44:47]
  v_mfma_f32_16x16x32_bf16 v[48:51], a[148:151], v[72:75], v[48:51]
  v_mfma_f32_16x16x32_bf16 v[52:55], a[148:151], v[76:79], v[52:55]
  v_mfma_f32_16x16x32_bf16 v[56:59], a[156:159], v[72:75], v[56:59]
  v_mfma_f32_16x16x32_bf16 v[60:63], a[156:159], v[76:79], v[60:63]
  ds_read_b128 v[72:75], v10 offset:9216
  ds_read_b128 v[76:79], v10 offset:19456
  s_waitcnt lgkmcnt(4)
  v_mfma_f32_16x16x32_bf16 v[16:19], v[80:83], v[64:67], v[16:19]
  v_mfma_f32_16x16x32_bf16 v[20:23], v[80:83], v[68:71], v[20:23]
  v_mfma_f32_16x16x32_bf16 v[24:27], a[160:163], v[64:67], v[24:27]
  v_mfma_f32_16x16x32_bf16 v[28:31], a[160:163], v[68:71], v[28:31]
  v_mfma_f32_16x16x32_bf16 v[32:35], a[168:171], v[64:67], v[32:35]
  v_mfma_f32_16x16x32_bf16 v[36:39], a[168:171], v[68:71], v[36:39]
  v_mfma_f32_16x16x32_bf16 v[40:43], a[176:179], v[64:67], v[40:43]
  v_mfma_f32_16x16x32_bf16 v[44:47], a[176:179], v[68:71], v[44:47]
  v_mfma_f32_16x16x32_bf16 v[48:51], a[184:187], v[64:67], v[48:51]
  v_mfma_f32_16x16x32_bf16 v[52:55], a[184:187], v[68:71], v[52:55]
  s_waitcnt lgkmcnt(2)
  v_mfma_f32_16x16x32_bf16 v[56:59], v[88:91], v[64:67], v[56:59]
  v_mfma_f32_16x16x32_bf16 v[60:63], v[88:91], v[68:71], v[60:63]
  s_waitcnt lgkmcnt(0)
  v_mfma_f32_16x16x32_bf16 v[16:19], v[84:87], v[72:75], v[16:19]
  v_mfma_f32_16x16x32_bf16 v[20:23], v[84:87], v[76:79], v[20:23]
  ds_read_b128 v[80:83], v15 offset:12288
  ds_read_b128 v[84:87], v15 offset:13312
  v_mfma_f32_16x16x32_bf16 v[24:27], a[164:167], v[72:75], v[24:27]
  v_mfma_f32_16x16x32_bf16 v[28:31], a[164:167], v[76:79], v[28:31]
  v_mfma_f32_16x16x32_bf16 v[32:35], a[172:175], v[72:75], v[32:35]
  v_mfma_f32_16x16x32_bf16 v[36:39], a[172:175], v[76:79], v[36:39]
  v_mfma_f32_16x16x32_bf16 v[40:43], a[180:183], v[72:75], v[40:43]
  v_mfma_f32_16x16x32_bf16 v[44:47], a[180:183], v[76:79], v[44:47]
  v_mfma_f32_16x16x32_bf16 v[48:51], a[188:191], v[72:75], v[48:51]
  v_mfma_f32_16x16x32_bf16 v[52:55], a[188:191], v[76:79], v[52:55]
  v_mfma_f32_16x16x32_bf16 v[56:59], v[92:95], v[72:75], v[56:59]
  v_mfma_f32_16x16x32_bf16 v[60:63], v[92:95], v[76:79], v[60:63]
  ds_read_b128 v[88:91], v15 offset:14336
  ds_read_b128 v[92:95], v15 offset:15360
  s_mov_b32 s20, s27
  s_mov_b32 s27, s28
  s_mov_b32 s28, s29
  s_mov_b32 s29, s20
  s_waitcnt vmcnt(0)
  s_barrier
  v_mov_b32 v9, s18
  buffer_store_dword v9, v8, s[4:7], s44 offen sc1
  s_add_u32 s78, s29, s36
  s_mov_b32 s79, s26
  s_add_u32 s26, s26, 30720
  v_add_u32 v10, s27, v2
  ds_read_b128 v[64:67], v10 offset:0
  ds_read_b128 v[68:71], v10 offset:10240
  ds_read_b128 v[72:75], v10 offset:1024
  ds_read_b128 v[76:79], v10 offset:11264
  s_waitcnt lgkmcnt(2)
  v_mfma_f32_16x16x32_bf16 v[16:19], a[192:195], v[64:67], v[16:19]
  s_add_u32 s76, s78, 0
  s_mov_b32 m0, s76
  v_mfma_f32_16x16x32_bf16 v[20:23], a[192:195], v[68:71], v[20:23]
  s_add_u32 s77, s79, 0
  buffer_load_dwordx4 v2, s[4:7], s77 offen sc1 lds
  v_mfma_f32_16x16x32_bf16 v[24:27], a[200:203], v[64:67], v[24:27]
  s_add_u32 s76, s78, 1024
  s_mov_b32 m0, s76
  v_mfma_f32_16x16x32_bf16 v[28:31], a[200:203], v[68:71], v[28:31]
  s_add_u32 s77, s79, 1024
  buffer_load_dwordx4 v2, s[4:7], s77 offen sc1 lds
  v_mfma_f32_16x16x32_bf16 v[32:35], a[208:211], v[64:67], v[32:35]
  s_add_u32 s76, s78, 2048
  s_mov_b32 m0, s76
  v_mfma_f32_16x16x32_bf16 v[36:39], a[208:211], v[68:71], v[36:39]
  s_add_u32 s77, s79, 2048
  buffer_load_dwordx4 v2, s[4:7], s77 offen sc1 lds
  v_mfma_f32_16x16x32_bf16 v[40:43], a[216:219], v[64:67], v[40:43]
  s_add_u32 s76, s78, 3072
  s_mov_b32 m0, s76
  v_mfma_f32_16x16x32_bf16 v[44:47], a[216:219], v[68:71], v[44:47]
  s_add_u32 s77, s79, 3072
  buffer_load_dwordx4 v2, s[4:7], s77 offen sc1 lds
  v_mfma_f32_16x16x32_bf16 v[48:51], v[80:83], v[64:67], v[48:51]
  s_add_u32 s76, s78, 4096
  s_mov_b32 m0, s76
  v_mfma_f32_16x16x32_bf16 v[52:55], v[80:83], v[68:71], v[52:55]
  s_add_u32 s77, s79, 4096
  buffer_load_dwordx4 v2, s[4:7], s77 offen sc1 lds
  v_mfma_f32_16x16x32_bf16 v[56:59], a[224:227], v[64:67], v[56:59]
  v_mfma_f32_16x16x32_bf16 v[60:63], a[224:227], v[68:71], v[60:63]
  ds_read_b128 v[64:67], v10 offset:2048
  ds_read_b128 v[68:71], v10 offset:12288
  s_waitcnt lgkmcnt(2)
  v_mfma_f32_16x16x32_bf16 v[16:19], a[196:199], v[72:75], v[16:19]
  v_mfma_f32_16x16x32_bf16 v[20:23], a[196:199], v[76:79], v[20:23]
  v_mfma_f32_16x16x32_bf16 v[24:27], a[204:207], v[72:75], v[24:27]
  v_mfma_f32_16x16x32_bf16 v[28:31], a[204:207], v[76:79], v[28:31]
  v_mfma_f32_16x16x32_bf16 v[32:35], a[212:215], v[72:75], v[32:35]
  v_mfma_f32_16x16x32_bf16 v[36:39], a[212:215], v[76:79], v[36:39]
  v_mfma_f32_16x16x32_bf16 v[40:43], a[220:223], v[72:75], v[40:43]
  v_mfma_f32_16x16x32_bf16 v[44:47], a[220:223], v[76:79], v[44:47]
  v_mfma_f32_16x16x32_bf16 v[48:51], v[84:87], v[72:75], v[48:51]
  v_mfma_f32_16x16x32_bf16 v[52:55], v[84:87], v[76:79], v[52:55]
  ds_read_b128 v[80:83], v15 offset:16384
  ds_read_b128 v[84:87], v15 offset:17408
  v_mfma_f32_16x16x32_bf16 v[56:59], a[228:231], v[72:75], v[56:59]
  v_mfma_f32_16x16x32_bf16 v[60:63], a[228:231], v[76:79], v[60:63]
  ds_read_b128 v[72:75], v10 offset:3072
  ds_read_b128 v[76:79], v10 offset:13312
  s_waitcnt lgkmcnt(4)
  v_mfma_f32_16x16x32_bf16 v[16:19], a[232:235], v[64:67], v[16:19]
  v_mfma_f32_16x16x32_bf16 v[20:23], a[232:235], v[68:71], v[20:23]
  v_mfma_f32_16x16x32_bf16 v[24:27], a[240:243], v[64:67], v[24:27]
  v_mfma_f32_16x16x32_bf16 v[28:31], a[240:243], v[68:71], v[28:31]
  v_mfma_f32_16x16x32_bf16 v[32:35], a[248:251], v[64:67], v[32:35]
  v_mfma_f32_16x16x32_bf16 v[36:39], a[248:251], v[68:71], v[36:39]
  v_mfma_f32_16x16x32_bf16 v[40:43], v[88:91], v[64:67], v[40:43]
  v_mfma_f32_16x16x32_bf16 v[44:47], v[88:91], v[68:71], v[44:47]
  v_mfma_f32_16x16x32_bf16 v[48:51], v[128:131], v[64:67], v[48:51]
  v_mfma_f32_16x16x32_bf16 v[52:55], v[128:131], v[68:71], v[52:55]
  v_mfma_f32_16x16x32_bf16 v[56:59], v[136:139], v[64:67], v[56:59]
  v_mfma_f32_16x16x32_bf16 v[60:63], v[136:139], v[68:71], v[60:63]
  ds_read_b128 v[64:67], v10 offset:4096
  ds_read_b128 v[68:71], v10 offset:14336
  s_waitcnt lgkmcnt(2)
  v_mfma_f32_16x16x32_bf16 v[16:19], a[236:239], v[72:75], v[16:19]
  v_mfma_f32_16x16x32_bf16 v[20:23], a[236:239], v[76:79], v[20:23]
  v_mfma_f32_16x16x32_bf16 v[24:27], a[244:247], v[72:75], v[24:27]
  v_mfma_f32_16x16x32_bf16 v[28:31], a[244:247], v[76:79], v[28:31]
  v_mfma_f32_16x16x32_bf16 v[32:35], a[252:255], v[72:75], v[32:35]
  v_mfma_f32_16x16x32_bf16 v[36:39], a[252:255], v[76:79], v[36:39]
  v_mfma_f32_16x16x32_bf16 v[40:43], v[92:95], v[72:75], v[40:43]
  v_mfma_f32_16x16x32_bf16 v[44:47], v[92:95], v[76:79], v[44:47]
  ds_read_b128 v[88:91], v15 offset:18432
  ds_read_b128 v[92:95], v15 offset:19456
  v_mfma_f32_16x16x32_bf16 v[48:51], v[132:135], v[72:75], v[48:51]
  v_mfma_f32_16x16x32_bf16 v[52:55], v[132:135], v[76:79], v[52:55]
  v_mfma_f32_16x16x32_bf16 v[56:59], v[140:143], v[72:75], v[56:59]
  v_mfma_f32_16x16x32_bf16 v[60:63], v[140:143], v[76:79], v[60:63]
  ds_read_b128 v[72:75], v10 offset:5120
  ds_read_b128 v[76:79], v10 offset:15360
  s_waitcnt lgkmcnt(4)
  v_mfma_f32_16x16x32_bf16 v[16:19], v[144:147], v[64:67], v[16:19]
  v_mfma_f32_16x16x32_bf16 v[20:23], v[144:147], v[68:71], v[20:23]
  v_mfma_f32_16x16x32_bf16 v[24:27], v[152:155], v[64:67], v[24:27]
  v_mfma_f32_16x16x32_bf16 v[28:31], v[152:155], v[68:71], v[28:31]
  v_mfma_f32_16x16x32_bf16 v[32:35], v[80:83], v[64:67], v[32:35]
  v_mfma_f32_16x16x32_bf16 v[36:39], v[80:83], v[68:71], v[36:39]
  v_mfma_f32_16x16x32_bf16 v[40:43], v[160:163], v[64:67], v[40:43]
  v_mfma_f32_16x16x32_bf16 v[44:47], v[160:163], v[68:71], v[44:47]
  v_mfma_f32_16x16x32_bf16 v[48:51], v[168:171], v[64:67], v[48:51]
  v_mfma_f32_16x16x32_bf16 v[52:55], v[168:171], v[68:71], v[52:55]
  v_mfma_f32_16x16x32_bf16 v[56:59], v[176:179], v[64:67], v[56:59]
  v_mfma_f32_16x16x32_bf16 v[60:63], v[176:179], v[68:71], v[60:63]
  ds_read_b128 v[64:67], v10 offset:6144
  ds_read_b128 v[68:71], v10 offset:16384
  s_waitcnt lgkmcnt(2)
  v_mfma_f32_16x16x32_bf16 v[16:19], v[148:151], v[72:75], v[16:19]
  v_mfma_f32_16x16x32_bf16 v[20:23], v[148:151], v[76:79], v[20:23]
  v_mfma_f32_16x16x32_bf16 v[24:27], v[156:159], v[72:75], v[24:27]
  v_mfma_f32_16x16x32_bf16 v[28:31], v[156:159], v[76:79], v[28:31]
  v_mfma_f32_16x16x32_bf16 v[32:35], v[84:87], v[72:75], v[32:35]
  v_mfma_f32_16x16x32_bf16 v[36:39], v[84:87], v[76:79], v[36:39]
  ds_read_b128 v[80:83], v15 offset:20480
  ds_read_b128 v[84:87], v15 offset:21504
  v_mfma_f32_16x16x32_bf16 v[40:43], v[164:167], v[72:75], v[40:43]
  v_mfma_f32_16x16x32_bf16 v[44:47], v[164:167], v[76:79], v[44:47]
  v_mfma_f32_16x16x32_bf16 v[48:51], v[172:175], v[72:75], v[48:51]
  v_mfma_f32_16x16x32_bf16 v[52:55], v[172:175], v[76:79], v[52:55]
  v_mfma_f32_16x16x32_bf16 v[56:59], v[180:183], v[72:75], v[56:59]
  v_mfma_f32_16x16x32_bf16 v[60:63], v[180:183], v[76:79], v[60:63]
  ds_read_b128 v[72:75], v10 offset:7168
  ds_read_b128 v[76:79], v10 offset:17408
  s_waitcnt lgkmcnt(4)
  v_mfma_f32_16x16x32_bf16 v[16:19], v[184:187], v[64:67], v[16:19]
  v_mfma_f32_16x16x32_bf16 v[20:23], v[184:187], v[68:71], v[20:23]
  v_mfma_f32_16x16x32_bf16 v[24:27], v[88:91], v[64:67], v[24:27]
  v_mfma_f32_16x16x32_bf16 v[28:31], v[88:91], v[68:71], v[28:31]
  v_mfma_f32_16x16x32_bf16 v[32:35], v[192:195], v[64:67], v[32:35]
  v_mfma_f32_16x16x32_bf16 v[36:39], v[192:195], v[68:71], v[36:39]
  v_mfma_f32_16x16x32_bf16 v[40:43], v[200:203], v[64:67], v[40:43]
  v_mfma_f32_16x16x32_bf16 v[44:47], v[200:203], v[68:71], v[44:47]
  v_mfma_f32_16x16x32_bf16 v[48:51], v[208:211], v[64:67], v[48:51]
  v_mfma_f32_16x16x32_bf16 v[52:55], v[208:211], v[68:71], v[52:55]
  v_mfma_f32_16x16x32_bf16 v[56:59], v[216:219], v[64:67], v[56:59]
  v_mfma_f32_16x16x32_bf16 v[60:63], v[216:219], v[68:71], v[60:63]
  ds_read_b128 v[64:67], v10 offset:8192
  ds_read_b128 v[68:71], v10 offset:18432
  s_waitcnt lgkmcnt(2)
  v_mfma_f32_16x16x32_bf16 v[16:19], v[188:191], v[72:75], v[16:19]
  v_mfma_f32_16x16x32_bf16 v[20:23], v[188:191], v[76:79], v[20:23]
  v_mfma_f32_16x16x32_bf16 v[24:27], v[92:95], v[72:75], v[24:27]
  v_mfma_f32_16x16x32_bf16 v[28:31], v[92:95], v[76:79], v[28:31]
  ds_read_b128 v[88:91], v15 offset:22528
  ds_read_b128 v[92:95], v15 offset:23552
  v_mfma_f32_16x16x32_bf16 v[32:35], v[196:199], v[72:75], v[32:35]
  v_mfma_f32_16x16x32_bf16 v[36:39], v[196:199], v[76:79], v[36:39]
  v_mfma_f32_16x16x32_bf16 v[40:43], v[204:207], v[72:75], v[40:43]
  v_mfma_f32_16x16x32_bf16 v[44:47], v[204:207], v[76:79], v[44:47]
  v_mfma_f32_16x16x32_bf16 v[48:51], v[212:215], v[72:75], v[48:51]
  v_mfma_f32_16x16x32_bf16 v[52:55], v[212:215], v[76:79], v[52:55]
  v_mfma_f32_16x16x32_bf16 v[56:59], v[220:223], v[72:75], v[56:59]
  v_mfma_f32_16x16x32_bf16 v[60:63], v[220:223], v[76:79], v[60:63]
  ds_read_b128 v[72:75], v10 offset:9216
  ds_read_b128 v[76:79], v10 offset:19456
  s_waitcnt lgkmcnt(4)
  v_mfma_f32_16x16x32_bf16 v[16:19], v[80:83], v[64:67], v[16:19]
  v_mfma_f32_16x16x32_bf16 v[20:23], v[80:83], v[68:71], v[20:23]
  v_mfma_f32_16x16x32_bf16 v[24:27], v[224:227], v[64:67], v[24:27]
  v_mfma_f32_16x16x32_bf16 v[28:31], v[224:227], v[68:71], v[28:31]
  v_mfma_f32_16x16x32_bf16 v[32:35], v[232:235], v[64:67], v[32:35]
  v_mfma_f32_16x16x32_bf16 v[36:39], v[232:235], v[68:71], v[36:39]
  v_mfma_f32_16x16x32_bf16 v[40:43], v[240:243], v[64:67], v[40:43]
  v_mfma_f32_16x16x32_bf16 v[44:47], v[240:243], v[68:71], v[44:47]
  v_mfma_f32_16x16x32_bf16 v[48:51], v[248:251], v[64:67], v[48:51]
  v_mfma_f32_16x16x32_bf16 v[52:55], v[248:251], v[68:71], v[52:55]
  s_waitcnt lgkmcnt(2)
  v_mfma_f32_16x16x32_bf16 v[56:59], v[88:91], v[64:67], v[56:59]
  v_mfma_f32_16x16x32_bf16 v[60:63], v[88:91], v[68:71], v[60:63]
  s_waitcnt lgkmcnt(0)
  v_mfma_f32_16x16x32_bf16 v[16:19], v[84:87], v[72:75], v[16:19]
  v_mfma_f32_16x16x32_bf16 v[20:23], v[84:87], v[76:79], v[20:23]
  ds_read_b128 v[80:83], v15 offset:0
  ds_read_b128 v[84:87], v15 offset:1024
  v_mfma_f32_16x16x32_bf16 v[24:27], v[228:231], v[72:75], v[24:27]
  v_mfma_f32_16x16x32_bf16 v[28:31], v[228:231], v[76:79], v[28:31]
  v_mfma_f32_16x16x32_bf16 v[32:35], v[236:239], v[72:75], v[32:35]
  v_mfma_f32_16x16x32_bf16 v[36:39], v[236:239], v[76:79], v[36:39]
  v_mfma_f32_16x16x32_bf16 v[40:43], v[244:247], v[72:75], v[40:43]
  v_mfma_f32_16x16x32_bf16 v[44:47], v[244:247], v[76:79], v[44:47]
  v_mfma_f32_16x16x32_bf16 v[48:51], v[252:255], v[72:75], v[48:51]
  v_mfma_f32_16x16x32_bf16 v[52:55], v[252:255], v[76:79], v[52:55]
  v_mfma_f32_16x16x32_bf16 v[56:59], v[92:95], v[72:75], v[56:59]
  v_mfma_f32_16x16x32_bf16 v[60:63], v[92:95], v[76:79], v[60:63]
  ds_read_b128 v[88:91], v15 offset:2048
  ds_read_b128 v[92:95], v15 offset:3072
  s_mov_b32 s20, s27
  s_mov_b32 s27, s28
  s_mov_b32 s28, s29
  s_mov_b32 s29, s20
  v_cvt_pk_bf16_f32 v96, v16, v17
  v_cvt_pk_bf16_f32 v97, v18, v19
  v_cvt_pk_bf16_f32 v98, v24, v25
  v_cvt_pk_bf16_f32 v99, v26, v27
  s_add_u32 s20, s30, 0
  buffer_store_dwordx4 v[96:99], v2, s[4:7], s20 offen sc1
  v_cvt_pk_bf16_f32 v100, v20, v21
  v_cvt_pk_bf16_f32 v101, v22, v23
  v_cvt_pk_bf16_f32 v102, v28, v29
  v_cvt_pk_bf16_f32 v103, v30, v31
  s_add_u32 s20, s30, 6144
  buffer_store_dwordx4 v[100:103], v2, s[4:7], s20 offen sc1
  v_cvt_pk_bf16_f32 v104, v32, v33
  v_cvt_pk_bf16_f32 v105, v34, v35
  v_cvt_pk_bf16_f32 v106, v40, v41
  v_cvt_pk_bf16_f32 v107, v42, v43
  s_add_u32 s20, s30, 1024
  buffer_store_dwordx4 v[104:107], v2, s[4:7], s20 offen sc1
  v_cvt_pk_bf16_f32 v108, v36, v37
  v_cvt_pk_bf16_f32 v109, v38, v39
  v_cvt_pk_bf16_f32 v110, v44, v45
  v_cvt_pk_bf16_f32 v111, v46, v47
  s_add_u32 s20, s30, 7168
  buffer_store_dwordx4 v[108:111], v2, s[4:7], s20 offen sc1
  v_cvt_pk_bf16_f32 v112, v48, v49
  v_cvt_pk_bf16_f32 v113, v50, v51
  v_cvt_pk_bf16_f32 v114, v56, v57
  v_cvt_pk_bf16_f32 v115, v58, v59
  s_add_u32 s20, s30, 2048
  buffer_store_dwordx4 v[112:115], v2, s[4:7], s20 offen sc1
  v_cvt_pk_bf16_f32 v116, v52, v53
  v_cvt_pk_bf16_f32 v117, v54, v55
  v_cvt_pk_bf16_f32 v118, v60, v61
  v_cvt_pk_bf16_f32 v119, v62, v63
  s_add_u32 s20, s30, 8192
  buffer_store_dwordx4 v[116:119], v2, s[4:7], s20 offen sc1
  s_add_u32 s30, s30, 786432
  s_add_u32 s18, s18, 1
  s_cmp_lg_u32 s18, 1
  s_cbranch_scc1 LAP0_138
  s_waitcnt vmcnt(0)
  s_mov_b32 s52, s32
  s_mov_b32 s53, s33
  s_mov_b32 s54, 256
  s_mov_b32 s55, 0x00020000
  s_cmp_lg_u32 s16, 0
  s_cbranch_scc1 Lwr_139
  v_lshrrev_b32 v16, 4, v2
  v_lshlrev_b32 v16, 7, v16
  v_mov_b32 v17, 196
  s_mov_b32 s51, 106496
  s_mov_b32 s50, 114688
Lwrt_140:
  buffer_load_dword v18, v16, s[4:7], s51 offen sc1
  buffer_load_dword v19, v16, s[4:7], s50 offen sc1
  s_waitcnt vmcnt(0)
  v_cmp_ne_u32 vcc, s70, v18
  s_cbranch_vccnz Lwra_142
  v_cmp_ne_u32 vcc, s70, v19
  s_cbranch_vccnz Lwra_142
  s_branch Lwrd_141
Lwra_142:
  s_sleep 2
  s_cmp_eq_u32 s19, 0
  s_cbranch_scc1 Lwrd_141
  s_sub_u32 s19, s19, 1
  s_branch Lwrt_140
Lwrd_141:
Lwr_139:
  s_barrier
  v_mov_b32 v9, s18
  buffer_store_dword v9, v8, s[4:7], s44 offen sc1
LAP0_138:
  s_cmp_lt_u32 s18, s31
  s_cbranch_scc1 LAPl_132
  s_waitcnt vmcnt(0) lgkmcnt(0)
  s_barrier
  v_mov_b32 v9, s18
  buffer_store_dword v9, v8, s[4:7], s44 offen sc1
  s_branch L_end
L_goBP:
  s_load_dwordx2 s[8:9], s[0:1], 32
  s_mov_b32 s10, 0x780000
  s_mov_b32 s11, 0x00020000
  s_load_dwordx2 s[12:13], s[0:1], 40
  s_mov_b32 s14, 0x780000
  s_mov_b32 s15, 0x00020000
  v_lshrrev_b32 v3, 6, v0
  v_and_b32 v1, 63, v0
  v_readfirstlane_b32 s16, v3
  v_lshlrev_b32 v2, 4, v1
  s_mov_b32 s19, 400000
  s_waitcnt lgkmcnt(0)
  v_lshlrev_b32 v8, 13, v0
  v_mov_b32 v80, 0x7ff00000
  v_cmp_gt_u32 vcc, 2, v0
  s_nop 1
  v_cndmask_b32 v8, v80, v8, vcc
  s_lshl_b32 s20, s17, 7
  s_add_u32 s44, s20, 2457600
  s_mul_i32 s20, s16, 24576
  s_add_u32 s20, s20, 65536
  v_add_u32 v15, s20, v2
  s_lshl_b32 s34, s16, 14
  v_add_u32 v83, 0, v1
  s_mov_b32 s20, 174763
  v_mul_lo_u32 v84, v83, s20
  v_lshrrev_b32 v84, 20, v84
  v_mul_u32_u24 v80, 6, v84
  v_sub_u32 v80, v83, v80
  v_lshlrev_b32 v80, 4, v80
  s_mov_b32 s20, 12288
  v_mul_lo_u32 v84, v84, s20
  v_add_u32 v80, v80, v84
  v_add_u32 v83, 64, v1
  s_mov_b32 s20, 174763
  v_mul_lo_u32 v84, v83, s20
  v_lshrrev_b32 v84, 20, v84
  v_mul_u32_u24 v81, 6, v84
  v_sub_u32 v81, v83, v81
  v_lshlrev_b32 v81, 4, v81
  s_mov_b32 s20, 12288
  v_mul_lo_u32 v84, v84, s20
  v_add_u32 v81, v81, v84
  v_add_u32 v83, 128, v1
  s_mov_b32 s20, 174763
  v_mul_lo_u32 v84, v83, s20
  v_lshrrev_b32 v84, 20, v84
  v_mul_u32_u24 v82, 6, v84
  v_sub_u32 v82, v83, v82
  v_lshlrev_b32 v82, 4, v82
  s_mov_b32 s20, 12288
  v_mul_lo_u32 v84, v84, s20
  v_add_u32 v82, v82, v84
  v_lshrrev_b32 v83, 4, v1
  v_mul_u32_u24 v83, 8, v83
  v_bfe_u32 v84, v1, 2, 2
  v_add_u32 v83, v83, v84
  v_mul_u32_u24 v83, 96, v83
  v_and_b32 v84, 3, v1
  v_lshlrev_b32 v84, 3, v84
  v_add_u32 v85, v83, v84
  v_add_u32 v85, s34, v85
  s_mul_i32 s35, s17, 384
  s_mul_i32 s20, s16, 96
  s_add_u32 s35, s35, s20
  s_sleep 80
  s_add_u32 s20, s35, 0
  s_add_u32 s21, s34, 0
  s_mov_b32 m0, s21
  s_nop 0
  buffer_load_dwordx4 v80, s[8:11], s20 offen lds
  s_add_u32 s21, s34, 1024
  s_mov_b32 m0, s21
  s_nop 0
  buffer_load_dwordx4 v81, s[8:11], s20 offen lds
  s_add_u32 s21, s34, 2048
  s_mov_b32 m0, s21
  s_nop 0
  buffer_load_dwordx4 v82, s[8:11], s20 offen lds
  s_add_u32 s20, s35, 393216
  s_add_u32 s21, s34, 3072
  s_mov_b32 m0, s21
  s_nop 0
  buffer_load_dwordx4 v80, s[8:11], s20 offen lds
  s_add_u32 s21, s34, 4096
  s_mov_b32 m0, s21
  s_nop 0
  buffer_load_dwordx4 v81, s[8:11], s20 offen lds
  s_add_u32 s21, s34, 5120
  s_mov_b32 m0, s21
  s_nop 0
  buffer_load_dwordx4 v82, s[8:11], s20 offen lds
  s_add_u32 s20, s35, 786432
  s_add_u32 s21, s34, 6144
  s_mov_b32 m0, s21
  s_nop 0
  buffer_load_dwordx4 v80, s[8:11], s20 offen lds
  s_add_u32 s21, s34, 7168
  s_mov_b32 m0, s21
  s_nop 0
  buffer_load_dwordx4 v81, s[8:11], s20 offen lds
  s_add_u32 s21, s34, 8192
  s_mov_b32 m0, s21
  s_nop 0
  buffer_load_dwordx4 v82, s[8:11], s20 offen lds
  s_add_u32 s20, s35, 1179648
  s_add_u32 s21, s34, 9216
  s_mov_b32 m0, s21
  s_nop 0
  buffer_load_dwordx4 v80, s[8:11], s20 offen lds
  s_add_u32 s21, s34, 10240
  s_mov_b32 m0, s21
  s_nop 0
  buffer_load_dwordx4 v81, s[8:11], s20 offen lds
  s_add_u32 s21, s34, 11264
  s_mov_b32 m0, s21
  s_nop 0
  buffer_load_dwordx4 v82, s[8:11], s20 offen lds
  s_waitcnt vmcnt(9)
  ds_read_b64_tr_b16 a[0:1], v85 offset:0
  ds_read_b64_tr_b16 a[2:3], v85 offset:384
  ds_read_b64_tr_b16 a[8:9], v85 offset:32
  ds_read_b64_tr_b16 a[10:11], v85 offset:416
  ds_read_b64_tr_b16 a[16:17], v85 offset:64
  ds_read_b64_tr_b16 a[18:19], v85 offset:448
  s_waitcnt lgkmcnt(0)
  s_add_u32 s20, s35, 1572864
  s_add_u32 s21, s34, 12288
  s_mov_b32 m0, s21
  s_nop 0
  buffer_load_dwordx4 v80, s[8:11], s20 offen lds
  s_add_u32 s21, s34, 13312
  s_mov_b32 m0, s21
  s_nop 0
  buffer_load_dwordx4 v81, s[8:11], s20 offen lds
  s_add_u32 s21, s34, 14336
  s_mov_b32 m0, s21
  s_nop 0
  buffer_load_dwordx4 v82, s[8:11], s20 offen lds
  s_waitcnt vmcnt(9)
  ds_read_b64_tr_b16 a[4:5], v85 offset:3072
  ds_read_b64_tr_b16 a[6:7], v85 offset:3456
  ds_read_b64_tr_b16 a[12:13], v85 offset:3104
  ds_read_b64_tr_b16 a[14:15], v85 offset:3488
  ds_read_b64_tr_b16 a[20:21], v85 offset:3136
  ds_read_b64_tr_b16 a[22:23], v85 offset:3520
  s_waitcnt lgkmcnt(0)
  s_add_u32 s20, s35, 1966080
  s_add_u32 s21, s34, 0
  s_mov_b32 m0, s21
  s_nop 0
  buffer_load_dwordx4 v80, s[8:11], s20 offen lds
  s_add_u32 s21, s34, 1024
  s_mov_b32 m0, s21
  s_nop 0
  buffer_load_dwordx4 v81, s[8:11], s20 offen lds
  s_add_u32 s21, s34, 2048
  s_mov_b32 m0, s21
  s_nop 0
  buffer_load_dwordx4 v82, s[8:11], s20 offen lds
  s_waitcnt vmcnt(9)
  ds_read_b64_tr_b16 a[24:25], v85 offset:6144
  ds_read_b64_tr_b16 a[26:27], v85 offset:6528
  ds_read_b64_tr_b16 v[88:89], v85 offset:6176
  ds_read_b64_tr_b16 v[90:91], v85 offset:6560
  ds_read_b64_tr_b16 a[32:33], v85 offset:6208
  ds_read_b64_tr_b16 a[34:35], v85 offset:6592
  s_waitcnt lgkmcnt(0)
  ds_write_b128 v15, v[88:91] offset:0
  s_add_u32 s20, s35, 2359296
  s_add_u32 s21, s34, 3072
  s_mov_b32 m0, s21
  s_nop 0
  buffer_load_dwordx4 v80, s[8:11], s20 offen lds
  s_add_u32 s21, s34, 4096
  s_mov_b32 m0, s21
  s_nop 0
  buffer_load_dwordx4 v81, s[8:11], s20 offen lds
  s_add_u32 s21, s34, 5120
  s_mov_b32 m0, s21
  s_nop 0
  buffer_load_dwordx4 v82, s[8:11], s20 offen lds
  s_waitcnt vmcnt(9)
  ds_read_b64_tr_b16 a[28:29], v85 offset:9216
  ds_read_b64_tr_b16 a[30:31], v85 offset:9600
  ds_read_b64_tr_b16 v[88:89], v85 offset:9248
  ds_read_b64_tr_b16 v[90:91], v85 offset:9632
  ds_read_b64_tr_b16 a[36:37], v85 offset:9280
  ds_read_b64_tr_b16 a[38:39], v85 offset:9664
  s_waitcnt lgkmcnt(0)
  ds_write_b128 v15, v[88:91] offset:1024
  s_add_u32 s20, s35, 2752512
  s_add_u32 s21, s34, 6144
  s_mov_b32 m0, s21
  s_nop 0
  buffer_load_dwordx4 v80, s[8:11], s20 offen lds
  s_add_u32 s21, s34, 7168
  s_mov_b32 m0, s21
  s_nop 0
  buffer_load_dwordx4 v81, s[8:11], s20 offen lds
  s_add_u32 s21, s34, 8192
  s_mov_b32 m0, s21
  s_nop 0
  buffer_load_dwordx4 v82, s[8:11], s20 offen lds
  s_waitcnt vmcnt(9)
  ds_read_b64_tr_b16 a[40:41], v85 offset:12288
  ds_read_b64_tr_b16 a[42:43], v85 offset:12672
  ds_read_b64_tr_b16 a[48:49], v85 offset:12320
  ds_read_b64_tr_b16 a[50:51], v85 offset:12704
  ds_read_b64_tr_b16 a[56:57], v85 offset:12352
  ds_read_b64_tr_b16 a[58:59], v85 offset:12736
  s_waitcnt lgkmcnt(0)
  s_add_u32 s20, s35, 3145728
  s_add_u32 s21, s34, 9216
  s_mov_b32 m0, s21
  s_nop 0
  buffer_load_dwordx4 v80, s[8:11], s20 offen lds
  s_add_u32 s21, s34, 10240
  s_mov_b32 m0, s21
  s_nop 0
  buffer_load_dwordx4 v81, s[8:11], s20 offen lds
  s_add_u32 s21, s34, 11264
  s_mov_b32 m0, s21
  s_nop 0
  buffer_load_dwordx4 v82, s[8:11], s20 offen lds
  s_waitcnt vmcnt(9)
  ds_read_b64_tr_b16 a[44:45], v85 offset:0
  ds_read_b64_tr_b16 a[46:47], v85 offset:384
  ds_read_b64_tr_b16 a[52:53], v85 offset:32
  ds_read_b64_tr_b16 a[54:55], v85 offset:416
  ds_read_b64_tr_b16 a[60:61], v85 offset:64
  ds_read_b64_tr_b16 a[62:63], v85 offset:448
  s_waitcnt lgkmcnt(0)
  s_add_u32 s20, s35, 3538944
  s_add_u32 s21, s34, 12288
  s_mov_b32 m0, s21
  s_nop 0
  buffer_load_dwordx4 v80, s[8:11], s20 offen lds
  s_add_u32 s21, s34, 13312
  s_mov_b32 m0, s21
  s_nop 0
  buffer_load_dwordx4 v81, s[8:11], s20 offen lds
  s_add_u32 s21, s34, 14336
  s_mov_b32 m0, s21
  s_nop 0
  buffer_load_dwordx4 v82, s[8:11], s20 offen lds
  s_waitcnt vmcnt(9)
  ds_read_b64_tr_b16 v[88:89], v85 offset:3072
  ds_read_b64_tr_b16 v[90:91], v85 offset:3456
  ds_read_b64_tr_b16 a[64:65], v85 offset:3104
  ds_read_b64_tr_b16 a[66:67], v85 offset:3488
  ds_read_b64_tr_b16 a[72:73], v85 offset:3136
  ds_read_b64_tr_b16 a[74:75], v85 offset:3520
  s_waitcnt lgkmcnt(0)
  ds_write_b128 v15, v[88:91] offset:2048
  s_add_u32 s20, s35, 3932160
  s_add_u32 s21, s34, 0
  s_mov_b32 m0, s21
  s_nop 0
  buffer_load_dwordx4 v80, s[8:11], s20 offen lds
  s_add_u32 s21, s34, 1024
  s_mov_b32 m0, s21
  s_nop 0
  buffer_load_dwordx4 v81, s[8:11], s20 offen lds
  s_add_u32 s21, s34, 2048
  s_mov_b32 m0, s21
  s_nop 0
  buffer_load_dwordx4 v82, s[8:11], s20 offen lds
  s_waitcnt vmcnt(9)
  ds_read_b64_tr_b16 v[88:89], v85 offset:6144
  ds_read_b64_tr_b16 v[90:91], v85 offset:6528
  ds_read_b64_tr_b16 a[68:69], v85 offset:6176
  ds_read_b64_tr_b16 a[70:71], v85 offset:6560
  ds_read_b64_tr_b16 a[76:77], v85 offset:6208
  ds_read_b64_tr_b16 a[78:79], v85 offset:6592
  s_waitcnt lgkmcnt(0)
  ds_write_b128 v15, v[88:91] offset:3072
  s_add_u32 s20, s35, 4325376
  s_add_u32 s21, s34, 3072
  s_mov_b32 m0, s21
  s_nop 0
  buffer_load_dwordx4 v80, s[8:11], s20 offen lds
  s_add_u32 s21, s34, 4096
  s_mov_b32 m0, s21
  s_nop 0
  buffer_load_dwordx4 v81, s[8:11], s20 offen lds
  s_add_u32 s21, s34, 5120
  s_mov_b32 m0, s21
  s_nop 0
  buffer_load_dwordx4 v82, s[8:11], s20 offen lds
  s_waitcnt vmcnt(9)
  ds_read_b64_tr_b16 a[80:81], v85 offset:9216
  ds_read_b64_tr_b16 a[82:83], v85 offset:9600
  ds_read_b64_tr_b16 a[88:89], v85 offset:9248
  ds_read_b64_tr_b16 a[90:91], v85 offset:9632
  ds_read_b64_tr_b16 v[88:89], v85 offset:9280
  ds_read_b64_tr_b16 v[90:91], v85 offset:9664
  s_waitcnt lgkmcnt(0)
  ds_write_b128 v15, v[88:91] offset:4096
  s_add_u32 s20, s35, 4718592
  s_add_u32 s21, s34, 6144
  s_mov_b32 m0, s21
  s_nop 0
  buffer_load_dwordx4 v80, s[8:11], s20 offen lds
  s_add_u32 s21, s34, 7168
  s_mov_b32 m0, s21
  s_nop 0
  buffer_load_dwordx4 v81, s[8:11], s20 offen lds
  s_add_u32 s21, s34, 8192
  s_mov_b32 m0, s21
  s_nop 0
  buffer_load_dwordx4 v82, s[8:11], s20 offen lds
  s_waitcnt vmcnt(9)
  ds_read_b64_tr_b16 a[84:85], v85 offset:12288
  ds_read_b64_tr_b16 a[86:87], v85 offset:12672
  ds_read_b64_tr_b16 a[92:93], v85 offset:12320
  ds_read_b64_tr_b16 a[94:95], v85 offset:12704
  ds_read_b64_tr_b16 v[88:89], v85 offset:12352
  ds_read_b64_tr_b16 v[90:91], v85 offset:12736
  s_waitcnt lgkmcnt(0)
  ds_write_b128 v15, v[88:91] offset:5120
  s_add_u32 s20, s35, 5111808
  s_add_u32 s21, s34, 9216
  s_mov_b32 m0, s21
  s_nop 0
  buffer_load_dwordx4 v80, s[8:11], s20 offen lds
  s_add_u32 s21, s34, 10240
  s_mov_b32 m0, s21
  s_nop 0
  buffer_load_dwordx4 v81, s[8:11], s20 offen lds
  s_add_u32 s21, s34, 11264
  s_mov_b32 m0, s21
  s_nop 0
  buffer_load_dwordx4 v82, s[8:11], s20 offen lds
  s_waitcnt vmcnt(9)
  ds_read_b64_tr_b16 a[96:97], v85 offset:0
  ds_read_b64_tr_b16 a[98:99], v85 offset:384
  ds_read_b64_tr_b16 a[104:105], v85 offset:32
  ds_read_b64_tr_b16 a[106:107], v85 offset:416
  ds_read_b64_tr_b16 a[112:113], v85 offset:64
  ds_read_b64_tr_b16 a[114:115], v85 offset:448
  s_waitcnt lgkmcnt(0)
  s_add_u32 s20, s35, 5505024
  s_add_u32 s21, s34, 12288
  s_mov_b32 m0, s21
  s_nop 0
  buffer_load_dwordx4 v80, s[8:11], s20 offen lds
  s_add_u32 s21, s34, 13312
  s_mov_b32 m0, s21
  s_nop 0
  buffer_load_dwordx4 v81, s[8:11], s20 offen lds
  s_add_u32 s21, s34, 14336
  s_mov_b32 m0, s21
  s_nop 0
  buffer_load_dwordx4 v82, s[8:11], s20 offen lds
  s_waitcnt vmcnt(9)
  ds_read_b64_tr_b16 a[100:101], v85 offset:3072
  ds_read_b64_tr_b16 a[102:103], v85 offset:3456
  ds_read_b64_tr_b16 a[108:109], v85 offset:3104
  ds_read_b64_tr_b16 a[110:111], v85 offset:3488
  ds_read_b64_tr_b16 a[116:117], v85 offset:3136
  ds_read_b64_tr_b16 a[118:119], v85 offset:3520
  s_waitcnt lgkmcnt(0)
  s_add_u32 s20, s35, 5898240
  s_add_u32 s21, s34, 0
  s_mov_b32 m0, s21
  s_nop 0
  buffer_load_dwordx4 v80, s[8:11], s20 offen lds
  s_add_u32 s21, s34, 1024
  s_mov_b32 m0, s21
  s_nop 0
  buffer_load_dwordx4 v81, s[8:11], s20 offen lds
  s_add_u32 s21, s34, 2048
  s_mov_b32 m0, s21
  s_nop 0
  buffer_load_dwordx4 v82, s[8:11], s20 offen lds
  s_waitcnt vmcnt(9)
  ds_read_b64_tr_b16 a[120:121], v85 offset:6144
  ds_read_b64_tr_b16 a[122:123], v85 offset:6528
  ds_read_b64_tr_b16 v[88:89], v85 offset:6176
  ds_read_b64_tr_b16 v[90:91], v85 offset:6560
  ds_read_b64_tr_b16 a[128:129], v85 offset:6208
  ds_read_b64_tr_b16 a[130:131], v85 offset:6592
  s_waitcnt lgkmcnt(0)
  ds_write_b128 v15, v[88:91] offset:6144
  s_add_u32 s20, s35, 6291456
  s_add_u32 s21, s34, 3072
  s_mov_b32 m0, s21
  s_nop 0
  buffer_load_dwordx4 v80, s[8:11], s20 offen lds
  s_add_u32 s21, s34, 4096
  s_mov_b32 m0, s21
  s_nop 0
  buffer_load_dwordx4 v81, s[8:11], s20 offen lds
  s_add_u32 s21, s34, 5120
  s_mov_b32 m0, s21
  s_nop 0
  buffer_load_dwordx4 v82, s[8:11], s20 offen lds
  s_waitcnt vmcnt(9)
  ds_read_b64_tr_b16 a[124:125], v85 offset:9216
  ds_read_b64_tr_b16 a[126:127], v85 offset:9600
  ds_read_b64_tr_b16 v[88:89], v85 offset:9248
  ds_read_b64_tr_b16 v[90:91], v85 offset:9632
  ds_read_b64_tr_b16 a[132:133], v85 offset:9280
  ds_read_b64_tr_b16 a[134:135], v85 offset:9664
  s_waitcnt lgkmcnt(0)
  ds_write_b128 v15, v[88:91] offset:7168
  s_add_u32 s20, s35, 6684672
  s_add_u32 s21, s34, 6144
  s_mov_b32 m0, s21
  s_nop 0
  buffer_load_dwordx4 v80, s[8:11], s20 offen lds
  s_add_u32 s21, s34, 7168
  s_mov_b32 m0, s21
  s_nop 0
  buffer_load_dwordx4 v81, s[8:11], s20 offen lds
  s_add_u32 s21, s34, 8192
  s_mov_b32 m0, s21
  s_nop 0
  buffer_load_dwordx4 v82, s[8:11], s20 offen lds
  s_waitcnt vmcnt(9)
  ds_read_b64_tr_b16 a[136:137], v85 offset:12288
  ds_read_b64_tr_b16 a[138:139], v85 offset:12672
  ds_read_b64_tr_b16 a[144:145], v85 offset:12320
  ds_read_b64_tr_b16 a[146:147], v85 offset:12704
  ds_read_b64_tr_b16 a[152:153], v85 offset:12352
  ds_read_b64_tr_b16 a[154:155], v85 offset:12736
  s_waitcnt lgkmcnt(0)
  s_add_u32 s20, s35, 7077888
  s_add_u32 s21, s34, 9216
  s_mov_b32 m0, s21
  s_nop 0
  buffer_load_dwordx4 v80, s[8:11], s20 offen lds
  s_add_u32 s21, s34, 10240
  s_mov_b32 m0, s21
  s_nop 0
  buffer_load_dwordx4 v81, s[8:11], s20 offen lds
  s_add_u32 s21, s34, 11264
  s_mov_b32 m0, s21
  s_nop 0
  buffer_load_dwordx4 v82, s[8:11], s20 offen lds
  s_waitcnt vmcnt(9)
  ds_read_b64_tr_b16 a[140:141], v85 offset:0
  ds_read_b64_tr_b16 a[142:143], v85 offset:384
  ds_read_b64_tr_b16 a[148:149], v85 offset:32
  ds_read_b64_tr_b16 a[150:151], v85 offset:416
  ds_read_b64_tr_b16 a[156:157], v85 offset:64
  ds_read_b64_tr_b16 a[158:159], v85 offset:448
  s_waitcnt lgkmcnt(0)
  s_add_u32 s20, s35, 7471104
  s_add_u32 s21, s34, 12288
  s_mov_b32 m0, s21
  s_nop 0
  buffer_load_dwordx4 v80, s[8:11], s20 offen lds
  s_add_u32 s21, s34, 13312
  s_mov_b32 m0, s21
  s_nop 0
  buffer_load_dwordx4 v81, s[8:11], s20 offen lds
  s_add_u32 s21, s34, 14336
  s_mov_b32 m0, s21
  s_nop 0
  buffer_load_dwordx4 v82, s[8:11], s20 offen lds
  s_waitcnt vmcnt(9)
  ds_read_b64_tr_b16 v[88:89], v85 offset:3072
  ds_read_b64_tr_b16 v[90:91], v85 offset:3456
  ds_read_b64_tr_b16 a[160:161], v85 offset:3104
  ds_read_b64_tr_b16 a[162:163], v85 offset:3488
  ds_read_b64_tr_b16 a[168:169], v85 offset:3136
  ds_read_b64_tr_b16 a[170:171], v85 offset:3520
  s_waitcnt lgkmcnt(0)
  ds_write_b128 v15, v[88:91] offset:8192
  s_waitcnt vmcnt(6)
  ds_read_b64_tr_b16 v[88:89], v85 offset:6144
  ds_read_b64_tr_b16 v[90:91], v85 offset:6528
  ds_read_b64_tr_b16 a[164:165], v85 offset:6176
  ds_read_b64_tr_b16 a[166:167], v85 offset:6560
  ds_read_b64_tr_b16 a[172:173], v85 offset:6208
  ds_read_b64_tr_b16 a[174:175], v85 offset:6592
  s_waitcnt lgkmcnt(0)
  ds_write_b128 v15, v[88:91] offset:9216
  s_waitcnt vmcnt(3)
  ds_read_b64_tr_b16 a[176:177], v85 offset:9216
  ds_read_b64_tr_b16 a[178:179], v85 offset:9600
  ds_read_b64_tr_b16 a[184:185], v85 offset:9248
  ds_read_b64_tr_b16 a[186:187], v85 offset:9632
  ds_read_b64_tr_b16 v[88:89], v85 offset:9280
  ds_read_b64_tr_b16 v[90:91], v85 offset:9664
  s_waitcnt lgkmcnt(0)
  ds_write_b128 v15, v[88:91] offset:10240
  s_waitcnt vmcnt(0)
  ds_read_b64_tr_b16 a[180:181], v85 offset:12288
  ds_read_b64_tr_b16 a[182:183], v85 offset:12672
  ds_read_b64_tr_b16 a[188:189], v85 offset:12320
  ds_read_b64_tr_b16 a[190:191], v85 offset:12704
  ds_read_b64_tr_b16 v[88:89], v85 offset:12352
  ds_read_b64_tr_b16 v[90:91], v85 offset:12736
  s_waitcnt lgkmcnt(0)
  ds_write_b128 v15, v[88:91] offset:11264
  s_waitcnt lgkmcnt(0)
  v_add_u32 v83, 0, v1
  s_mov_b32 s20, 104858
  v_mul_lo_u32 v84, v83, s20
  v_lshrrev_b32 v84, 20, v84
  v_mul_u32_u24 v100, 10, v84
  v_sub_u32 v100, v83, v100
  v_lshlrev_b32 v100, 4, v100
  s_mov_b32 s20, 1280
  v_mul_lo_u32 v84, v84, s20
  v_add_u32 v100, v100, v84
  v_add_u32 v83, 64, v1
  s_mov_b32 s20, 104858
  v_mul_lo_u32 v84, v83, s20
  v_lshrrev_b32 v84, 20, v84
  v_mul_u32_u24 v101, 10, v84
  v_sub_u32 v101, v83, v101
  v_lshlrev_b32 v101, 4, v101
  s_mov_b32 s20, 1280
  v_mul_lo_u32 v84, v84, s20
  v_add_u32 v101, v101, v84
  v_add_u32 v83, 128, v1
  s_mov_b32 s20, 104858
  v_mul_lo_u32 v84, v83, s20
  v_lshrrev_b32 v84, 20, v84
  v_mul_u32_u24 v102, 10, v84
  v_sub_u32 v102, v83, v102
  v_lshlrev_b32 v102, 4, v102
  s_mov_b32 s20, 1280
  v_mul_lo_u32 v84, v84, s20
  v_add_u32 v102, v102, v84
  v_add_u32 v83, 192, v1
  s_mov_b32 s20, 104858
  v_mul_lo_u32 v84, v83, s20
  v_lshrrev_b32 v84, 20, v84
  v_mul_u32_u24 v103, 10, v84
  v_sub_u32 v103, v83, v103
  v_lshlrev_b32 v103, 4, v103
  s_mov_b32 s20, 1280
  v_mul_lo_u32 v84, v84, s20
  v_add_u32 v103, v103, v84
  v_add_u32 v83, 256, v1
  s_mov_b32 s20, 104858
  v_mul_lo_u32 v84, v83, s20
  v_lshrrev_b32 v84, 20, v84
  v_mul_u32_u24 v104, 10, v84
  v_sub_u32 v104, v83, v104
  v_lshlrev_b32 v104, 4, v104
  s_mov_b32 s20, 1280
  v_mul_lo_u32 v84, v84, s20
  v_add_u32 v104, v104, v84
  v_lshrrev_b32 v83, 4, v1
  v_mul_u32_u24 v83, 4, v83
  v_bfe_u32 v84, v1, 2, 2
  v_add_u32 v83, v83, v84
  v_mul_u32_u24 v83, 160, v83
  v_and_b32 v84, 3, v1
  v_lshlrev_b32 v84, 3, v84
  v_add_u32 v86, v83, v84
  v_add_u32 v86, s34, v86
  s_mul_i32 s35, s17, 245760
  s_mul_i32 s20, s16, 320
  s_add_u32 s35, s35, s20
  s_add_u32 s20, s35, 0
  s_add_u32 s21, s34, 0
  s_mov_b32 m0, s21
  s_nop 0
  buffer_load_dwordx4 v100, s[12:15], s20 offen lds
  s_add_u32 s21, s34, 1024
  s_mov_b32 m0, s21
  s_nop 0
  buffer_load_dwordx4 v101, s[12:15], s20 offen lds
  s_add_u32 s21, s34, 2048
  s_mov_b32 m0, s21
  s_nop 0
  buffer_load_dwordx4 v102, s[12:15], s20 offen lds
  s_add_u32 s21, s34, 3072
  s_mov_b32 m0, s21
  s_nop 0
  buffer_load_dwordx4 v103, s[12:15], s20 offen lds
  s_add_u32 s21, s34, 4096
  s_mov_b32 m0, s21
  s_nop 0
  buffer_load_dwordx4 v104, s[12:15], s20 offen lds
  s_add_u32 s20, s35, 160
  s_add_u32 s21, s34, 5120
  s_mov_b32 m0, s21
  s_nop 0
  buffer_load_dwordx4 v100, s[12:15], s20 offen lds
  s_add_u32 s21, s34, 6144
  s_mov_b32 m0, s21
  s_nop 0
  buffer_load_dwordx4 v101, s[12:15], s20 offen lds
  s_add_u32 s21, s34, 7168
  s_mov_b32 m0, s21
  s_nop 0
  buffer_load_dwordx4 v102, s[12:15], s20 offen lds
  s_add_u32 s21, s34, 8192
  s_mov_b32 m0, s21
  s_nop 0
  buffer_load_dwordx4 v103, s[12:15], s20 offen lds
  s_add_u32 s21, s34, 9216
  s_mov_b32 m0, s21
  s_nop 0
  buffer_load_dwordx4 v104, s[12:15], s20 offen lds
  s_waitcnt vmcnt(5)
  ds_read_b64_tr_b16 a[192:193], v86 offset:0
  ds_read_b64_tr_b16 a[194:195], v86 offset:2560
  ds_read_b64_tr_b16 a[216:217], v86 offset:32
  ds_read_b64_tr_b16 a[218:219], v86 offset:2592
  ds_read_b64_tr_b16 a[232:233], v86 offset:64
  ds_read_b64_tr_b16 a[234:235], v86 offset:2624
  ds_read_b64_tr_b16 v[88:89], v86 offset:96
  ds_read_b64_tr_b16 v[90:91], v86 offset:2656
  ds_read_b64_tr_b16 v[144:145], v86 offset:128
  ds_read_b64_tr_b16 v[146:147], v86 offset:2688
  s_waitcnt lgkmcnt(0)
  ds_write_b128 v15, v[88:91] offset:14336
  s_add_u32 s20, s35, 40960
  s_add_u32 s21, s34, 10240
  s_mov_b32 m0, s21
  s_nop 0
  buffer_load_dwordx4 v100, s[12:15], s20 offen lds
  s_add_u32 s21, s34, 11264
  s_mov_b32 m0, s21
  s_nop 0
  buffer_load_dwordx4 v101, s[12:15], s20 offen lds
  s_add_u32 s21, s34, 12288
  s_mov_b32 m0, s21
  s_nop 0
  buffer_load_dwordx4 v102, s[12:15], s20 offen lds
  s_add_u32 s21, s34, 13312
  s_mov_b32 m0, s21
  s_nop 0
  buffer_load_dwordx4 v103, s[12:15], s20 offen lds
  s_add_u32 s21, s34, 14336
  s_mov_b32 m0, s21
  s_nop 0
  buffer_load_dwordx4 v104, s[12:15], s20 offen lds
  s_waitcnt vmcnt(5)
  ds_read_b64_tr_b16 v[160:161], v86 offset:5120
  ds_read_b64_tr_b16 v[162:163], v86 offset:7680
  ds_read_b64_tr_b16 v[184:185], v86 offset:5152
  ds_read_b64_tr_b16 v[186:187], v86 offset:7712
  ds_read_b64_tr_b16 v[200:201], v86 offset:5184
  ds_read_b64_tr_b16 v[202:203], v86 offset:7744
  ds_read_b64_tr_b16 v[88:89], v86 offset:5216
  ds_read_b64_tr_b16 v[90:91], v86 offset:7776
  ds_read_b64_tr_b16 v[240:241], v86 offset:5248
  ds_read_b64_tr_b16 v[242:243], v86 offset:7808
  s_waitcnt lgkmcnt(0)
  ds_write_b128 v15, v[88:91] offset:20480
  s_add_u32 s20, s35, 41120
  s_add_u32 s21, s34, 0
  s_mov_b32 m0, s21
  s_nop 0
  buffer_load_dwordx4 v100, s[12:15], s20 offen lds
  s_add_u32 s21, s34, 1024
  s_mov_b32 m0, s21
  s_nop 0
  buffer_load_dwordx4 v101, s[12:15], s20 offen lds
  s_add_u32 s21, s34, 2048
  s_mov_b32 m0, s21
  s_nop 0
  buffer_load_dwordx4 v102, s[12:15], s20 offen lds
  s_add_u32 s21, s34, 3072
  s_mov_b32 m0, s21
  s_nop 0
  buffer_load_dwordx4 v103, s[12:15], s20 offen lds
  s_add_u32 s21, s34, 4096
  s_mov_b32 m0, s21
  s_nop 0
  buffer_load_dwordx4 v104, s[12:15], s20 offen lds
  s_waitcnt vmcnt(5)
  ds_read_b64_tr_b16 a[196:197], v86 offset:10240
  ds_read_b64_tr_b16 a[198:199], v86 offset:12800
  ds_read_b64_tr_b16 a[220:221], v86 offset:10272
  ds_read_b64_tr_b16 a[222:223], v86 offset:12832
  ds_read_b64_tr_b16 a[236:237], v86 offset:10304
  ds_read_b64_tr_b16 a[238:239], v86 offset:12864
  ds_read_b64_tr_b16 v[88:89], v86 offset:10336
  ds_read_b64_tr_b16 v[90:91], v86 offset:12896
  ds_read_b64_tr_b16 v[148:149], v86 offset:10368
  ds_read_b64_tr_b16 v[150:151], v86 offset:12928
  s_waitcnt lgkmcnt(0)
  ds_write_b128 v15, v[88:91] offset:15360
  s_add_u32 s20, s35, 81920
  s_add_u32 s21, s34, 5120
  s_mov_b32 m0, s21
  s_nop 0
  buffer_load_dwordx4 v100, s[12:15], s20 offen lds
  s_add_u32 s21, s34, 6144
  s_mov_b32 m0, s21
  s_nop 0
  buffer_load_dwordx4 v101, s[12:15], s20 offen lds
  s_add_u32 s21, s34, 7168
  s_mov_b32 m0, s21
  s_nop 0
  buffer_load_dwordx4 v102, s[12:15], s20 offen lds
  s_add_u32 s21, s34, 8192
  s_mov_b32 m0, s21
  s_nop 0
  buffer_load_dwordx4 v103, s[12:15], s20 offen lds
  s_add_u32 s21, s34, 9216
  s_mov_b32 m0, s21
  s_nop 0
  buffer_load_dwordx4 v104, s[12:15], s20 offen lds
  s_waitcnt vmcnt(5)
  ds_read_b64_tr_b16 v[164:165], v86 offset:0
  ds_read_b64_tr_b16 v[166:167], v86 offset:2560
  ds_read_b64_tr_b16 v[188:189], v86 offset:32
  ds_read_b64_tr_b16 v[190:191], v86 offset:2592
  ds_read_b64_tr_b16 v[204:205], v86 offset:64
  ds_read_b64_tr_b16 v[206:207], v86 offset:2624
  ds_read_b64_tr_b16 v[88:89], v86 offset:96
  ds_read_b64_tr_b16 v[90:91], v86 offset:2656
  ds_read_b64_tr_b16 v[244:245], v86 offset:128
  ds_read_b64_tr_b16 v[246:247], v86 offset:2688
  s_waitcnt lgkmcnt(0)
  ds_write_b128 v15, v[88:91] offset:21504
  s_add_u32 s20, s35, 82080
  s_add_u32 s21, s34, 10240
  s_mov_b32 m0, s21
  s_nop 0
  buffer_load_dwordx4 v100, s[12:15], s20 offen lds
  s_add_u32 s21, s34, 11264
  s_mov_b32 m0, s21
  s_nop 0
  buffer_load_dwordx4 v101, s[12:15], s20 offen lds
  s_add_u32 s21, s34, 12288
  s_mov_b32 m0, s21
  s_nop 0
  buffer_load_dwordx4 v102, s[12:15], s20 offen lds
  s_add_u32 s21, s34, 13312
  s_mov_b32 m0, s21
  s_nop 0
  buffer_load_dwordx4 v103, s[12:15], s20 offen lds
  s_add_u32 s21, s34, 14336
  s_mov_b32 m0, s21
  s_nop 0
  buffer_load_dwordx4 v104, s[12:15], s20 offen lds
  s_waitcnt vmcnt(5)
  ds_read_b64_tr_b16 a[200:201], v86 offset:5120
  ds_read_b64_tr_b16 a[202:203], v86 offset:7680
  ds_read_b64_tr_b16 v[88:89], v86 offset:5152
  ds_read_b64_tr_b16 v[90:91], v86 offset:7712
  ds_read_b64_tr_b16 a[240:241], v86 offset:5184
  ds_read_b64_tr_b16 a[242:243], v86 offset:7744
  ds_read_b64_tr_b16 v[128:129], v86 offset:5216
  ds_read_b64_tr_b16 v[130:131], v86 offset:7776
  ds_read_b64_tr_b16 v[152:153], v86 offset:5248
  ds_read_b64_tr_b16 v[154:155], v86 offset:7808
  s_waitcnt lgkmcnt(0)
  ds_write_b128 v15, v[88:91] offset:12288
  s_add_u32 s20, s35, 122880
  s_add_u32 s21, s34, 0
  s_mov_b32 m0, s21
  s_nop 0
  buffer_load_dwordx4 v100, s[12:15], s20 offen lds
  s_add_u32 s21, s34, 1024
  s_mov_b32 m0, s21
  s_nop 0
  buffer_load_dwordx4 v101, s[12:15], s20 offen lds
  s_add_u32 s21, s34, 2048
  s_mov_b32 m0, s21
  s_nop 0
  buffer_load_dwordx4 v102, s[12:15], s20 offen lds
  s_add_u32 s21, s34, 3072
  s_mov_b32 m0, s21
  s_nop 0
  buffer_load_dwordx4 v103, s[12:15], s20 offen lds
  s_add_u32 s21, s34, 4096
  s_mov_b32 m0, s21
  s_nop 0
  buffer_load_dwordx4 v104, s[12:15], s20 offen lds
  s_waitcnt vmcnt(5)
  ds_read_b64_tr_b16 v[168:169], v86 offset:10240
  ds_read_b64_tr_b16 v[170:171], v86 offset:12800
  ds_read_b64_tr_b16 v[88:89], v86 offset:10272
  ds_read_b64_tr_b16 v[90:91], v86 offset:12832
  ds_read_b64_tr_b16 v[208:209], v86 offset:10304
  ds_read_b64_tr_b16 v[210:211], v86 offset:12864
  ds_read_b64_tr_b16 v[224:225], v86 offset:10336
  ds_read_b64_tr_b16 v[226:227], v86 offset:12896
  ds_read_b64_tr_b16 v[248:249], v86 offset:10368
  ds_read_b64_tr_b16 v[250:251], v86 offset:12928
  s_waitcnt lgkmcnt(0)
  ds_write_b128 v15, v[88:91] offset:18432
  s_add_u32 s20, s35, 123040
  s_add_u32 s21, s34, 5120
  s_mov_b32 m0, s21
  s_nop 0
  buffer_load_dwordx4 v100, s[12:15], s20 offen lds
  s_add_u32 s21, s34, 6144
  s_mov_b32 m0, s21
  s_nop 0
  buffer_load_dwordx4 v101, s[12:15], s20 offen lds
  s_add_u32 s21, s34, 7168
  s_mov_b32 m0, s21
  s_nop 0
  buffer_load_dwordx4 v102, s[12:15], s20 offen lds
  s_add_u32 s21, s34, 8192
  s_mov_b32 m0, s21
  s_nop 0
  buffer_load_dwordx4 v103, s[12:15], s20 offen lds
  s_add_u32 s21, s34, 9216
  s_mov_b32 m0, s21
  s_nop 0
  buffer_load_dwordx4 v104, s[12:15], s20 offen lds
  s_waitcnt vmcnt(5)
  ds_read_b64_tr_b16 a[204:205], v86 offset:0
  ds_read_b64_tr_b16 a[206:207], v86 offset:2560
  ds_read_b64_tr_b16 v[88:89], v86 offset:32
  ds_read_b64_tr_b16 v[90:91], v86 offset:2592
  ds_read_b64_tr_b16 a[244:245], v86 offset:64
  ds_read_b64_tr_b16 a[246:247], v86 offset:2624
  ds_read_b64_tr_b16 v[132:133], v86 offset:96
  ds_read_b64_tr_b16 v[134:135], v86 offset:2656
  ds_read_b64_tr_b16 v[156:157], v86 offset:128
  ds_read_b64_tr_b16 v[158:159], v86 offset:2688
  s_waitcnt lgkmcnt(0)
  ds_write_b128 v15, v[88:91] offset:13312
  s_add_u32 s20, s35, 163840
  s_add_u32 s21, s34, 10240
  s_mov_b32 m0, s21
  s_nop 0
  buffer_load_dwordx4 v100, s[12:15], s20 offen lds
  s_add_u32 s21, s34, 11264
  s_mov_b32 m0, s21
  s_nop 0
  buffer_load_dwordx4 v101, s[12:15], s20 offen lds
  s_add_u32 s21, s34, 12288
  s_mov_b32 m0, s21
  s_nop 0
  buffer_load_dwordx4 v102, s[12:15], s20 offen lds
  s_add_u32 s21, s34, 13312
  s_mov_b32 m0, s21
  s_nop 0
  buffer_load_dwordx4 v103, s[12:15], s20 offen lds
  s_add_u32 s21, s34, 14336
  s_mov_b32 m0, s21
  s_nop 0
  buffer_load_dwordx4 v104, s[12:15], s20 offen lds
  s_waitcnt vmcnt(5)
  ds_read_b64_tr_b16 v[172:173], v86 offset:5120
  ds_read_b64_tr_b16 v[174:175], v86 offset:7680
  ds_read_b64_tr_b16 v[88:89], v86 offset:5152
  ds_read_b64_tr_b16 v[90:91], v86 offset:7712
  ds_read_b64_tr_b16 v[212:213], v86 offset:5184
  ds_read_b64_tr_b16 v[214:215], v86 offset:7744
  ds_read_b64_tr_b16 v[228:229], v86 offset:5216
  ds_read_b64_tr_b16 v[230:231], v86 offset:7776
  ds_read_b64_tr_b16 v[252:253], v86 offset:5248
  ds_read_b64_tr_b16 v[254:255], v86 offset:7808
  s_waitcnt lgkmcnt(0)
  ds_write_b128 v15, v[88:91] offset:19456
  s_add_u32 s20, s35, 164000
  s_add_u32 s21, s34, 0
  s_mov_b32 m0, s21
  s_nop 0
  buffer_load_dwordx4 v100, s[12:15], s20 offen lds
  s_add_u32 s21, s34, 1024
  s_mov_b32 m0, s21
  s_nop 0
  buffer_load_dwordx4 v101, s[12:15], s20 offen lds
  s_add_u32 s21, s34, 2048
  s_mov_b32 m0, s21
  s_nop 0
  buffer_load_dwordx4 v102, s[12:15], s20 offen lds
  s_add_u32 s21, s34, 3072
  s_mov_b32 m0, s21
  s_nop 0
  buffer_load_dwordx4 v103, s[12:15], s20 offen lds
  s_add_u32 s21, s34, 4096
  s_mov_b32 m0, s21
  s_nop 0
  buffer_load_dwordx4 v104, s[12:15], s20 offen lds
  s_waitcnt vmcnt(5)
  ds_read_b64_tr_b16 a[208:209], v86 offset:10240
  ds_read_b64_tr_b16 a[210:211], v86 offset:12800
  ds_read_b64_tr_b16 a[224:225], v86 offset:10272
  ds_read_b64_tr_b16 a[226:227], v86 offset:12832
  ds_read_b64_tr_b16 a[248:249], v86 offset:10304
  ds_read_b64_tr_b16 a[250:251], v86 offset:12864
  ds_read_b64_tr_b16 v[136:137], v86 offset:10336
  ds_read_b64_tr_b16 v[138:139], v86 offset:12896
  ds_read_b64_tr_b16 v[88:89], v86 offset:10368
  ds_read_b64_tr_b16 v[90:91], v86 offset:12928
  s_waitcnt lgkmcnt(0)
  ds_write_b128 v15, v[88:91] offset:16384
  s_add_u32 s20, s35, 204800
  s_add_u32 s21, s34, 5120
  s_mov_b32 m0, s21
  s_nop 0
  buffer_load_dwordx4 v100, s[12:15], s20 offen lds
  s_add_u32 s21, s34, 6144
  s_mov_b32 m0, s21
  s_nop 0
  buffer_load_dwordx4 v101, s[12:15], s20 offen lds
  s_add_u32 s21, s34, 7168
  s_mov_b32 m0, s21
  s_nop 0
  buffer_load_dwordx4 v102, s[12:15], s20 offen lds
  s_add_u32 s21, s34, 8192
  s_mov_b32 m0, s21
  s_nop 0
  buffer_load_dwordx4 v103, s[12:15], s20 offen lds
  s_add_u32 s21, s34, 9216
  s_mov_b32 m0, s21
  s_nop 0
  buffer_load_dwordx4 v104, s[12:15], s20 offen lds
  s_waitcnt vmcnt(5)
  ds_read_b64_tr_b16 v[176:177], v86 offset:0
  ds_read_b64_tr_b16 v[178:179], v86 offset:2560
  ds_read_b64_tr_b16 v[192:193], v86 offset:32
  ds_read_b64_tr_b16 v[194:195], v86 offset:2592
  ds_read_b64_tr_b16 v[216:217], v86 offset:64
  ds_read_b64_tr_b16 v[218:219], v86 offset:2624
  ds_read_b64_tr_b16 v[232:233], v86 offset:96
  ds_read_b64_tr_b16 v[234:235], v86 offset:2656
  ds_read_b64_tr_b16 v[88:89], v86 offset:128
  ds_read_b64_tr_b16 v[90:91], v86 offset:2688
  s_waitcnt lgkmcnt(0)
  ds_write_b128 v15, v[88:91] offset:22528
  s_add_u32 s20, s35, 204960
  s_add_u32 s21, s34, 10240
  s_mov_b32 m0, s21
  s_nop 0
  buffer_load_dwordx4 v100, s[12:15], s20 offen lds
  s_add_u32 s21, s34, 11264
  s_mov_b32 m0, s21
  s_nop 0
  buffer_load_dwordx4 v101, s[12:15], s20 offen lds
  s_add_u32 s21, s34, 12288
  s_mov_b32 m0, s21
  s_nop 0
  buffer_load_dwordx4 v102, s[12:15], s20 offen lds
  s_add_u32 s21, s34, 13312
  s_mov_b32 m0, s21
  s_nop 0
  buffer_load_dwordx4 v103, s[12:15], s20 offen lds
  s_add_u32 s21, s34, 14336
  s_mov_b32 m0, s21
  s_nop 0
  buffer_load_dwordx4 v104, s[12:15], s20 offen lds
  s_waitcnt vmcnt(5)
  ds_read_b64_tr_b16 a[212:213], v86 offset:5120
  ds_read_b64_tr_b16 a[214:215], v86 offset:7680
  ds_read_b64_tr_b16 a[228:229], v86 offset:5152
  ds_read_b64_tr_b16 a[230:231], v86 offset:7712
  ds_read_b64_tr_b16 a[252:253], v86 offset:5184
  ds_read_b64_tr_b16 a[254:255], v86 offset:7744
  ds_read_b64_tr_b16 v[140:141], v86 offset:5216
  ds_read_b64_tr_b16 v[142:143], v86 offset:7776
  ds_read_b64_tr_b16 v[88:89], v86 offset:5248
  ds_read_b64_tr_b16 v[90:91], v86 offset:7808
  s_waitcnt lgkmcnt(0)
  ds_write_b128 v15, v[88:91] offset:17408
  s_waitcnt vmcnt(0)
  ds_read_b64_tr_b16 v[180:181], v86 offset:10240
  ds_read_b64_tr_b16 v[182:183], v86 offset:12800
  ds_read_b64_tr_b16 v[196:197], v86 offset:10272
  ds_read_b64_tr_b16 v[198:199], v86 offset:12832
  ds_read_b64_tr_b16 v[220:221], v86 offset:10304
  ds_read_b64_tr_b16 v[222:223], v86 offset:12864
  ds_read_b64_tr_b16 v[236:237], v86 offset:10336
  ds_read_b64_tr_b16 v[238:239], v86 offset:12896
  ds_read_b64_tr_b16 v[88:89], v86 offset:10368
  ds_read_b64_tr_b16 v[90:91], v86 offset:12928
  s_waitcnt lgkmcnt(0)
  ds_write_b128 v15, v[88:91] offset:23552
  s_waitcnt lgkmcnt(0)
  s_barrier
  s_mov_b32 s52, s32
  s_mov_b32 s53, s33
  s_mov_b32 s54, 256
  s_mov_b32 s55, 0x00020000
  s_cmp_lg_u32 s16, 0
  s_cbranch_scc1 Lwr_143
  v_lshrrev_b32 v16, 4, v2
  v_lshlrev_b32 v16, 7, v16
  v_mov_b32 v17, 196
  s_mov_b32 s51, 90112
  s_mov_b32 s50, 98304
Lwrt_144:
  buffer_load_dword v18, v16, s[4:7], s51 offen sc1
  s_waitcnt vmcnt(0)
  v_cmp_ne_u32 vcc, s70, v18
  s_cbranch_vccnz Lwra_146
  s_branch Lwrd_145
Lwra_146:
  s_sleep 2
  s_cmp_eq_u32 s19, 0
  s_cbranch_scc1 Lwrd_145
  s_sub_u32 s19, s19, 1
  s_branch Lwrt_144
Lwrd_145:
Lwr_143:
  s_barrier
  s_mul_i32 s20, s16, 3
  s_add_u32 s20, s20, 0
  s_lshr_b32 s21, s20, 1
  s_lshl_b32 s21, s21, 10
  s_and_b32 s20, s20, 1
  s_lshl_b32 s20, s20, 3
  s_add_u32 s20, s20, s21
  s_add_u32 s20, s20, 40960
  v_add_u32 v10, s20, v2
  s_mul_i32 s20, s16, 3
  s_add_u32 s20, s20, 1
  s_lshr_b32 s21, s20, 1
  s_lshl_b32 s21, s21, 10
  s_and_b32 s20, s20, 1
  s_lshl_b32 s20, s20, 3
  s_add_u32 s20, s20, s21
  s_add_u32 s20, s20, 40960
  v_add_u32 v11, s20, v2
  s_mul_i32 s20, s16, 3
  s_add_u32 s20, s20, 2
  s_lshr_b32 s21, s20, 1
  s_lshl_b32 s21, s21, 10
  s_and_b32 s20, s20, 1
  s_lshl_b32 s20, s20, 3
  s_add_u32 s20, s20, s21
  s_add_u32 s20, s20, 40960
  v_add_u32 v12, s20, v2
  v_add_u32 v13, 40960, v2
  s_mul_i32 s36, s16, 10240
  s_add_u32 s26, s36, 6291456
  s_add_u32 s20, s36, 0
  s_mov_b32 m0, s20
  s_add_u32 s21, s26, 0
  buffer_load_dwordx4 v2, s[4:7], s21 offen sc1 lds
  s_add_u32 s20, s36, 1024
  s_mov_b32 m0, s20
  s_add_u32 s21, s26, 1024
  buffer_load_dwordx4 v2, s[4:7], s21 offen sc1 lds
  s_add_u32 s20, s36, 2048
  s_mov_b32 m0, s20
  s_add_u32 s21, s26, 2048
  buffer_load_dwordx4 v2, s[4:7], s21 offen sc1 lds
  s_add_u32 s20, s36, 3072
  s_mov_b32 m0, s20
  s_add_u32 s21, s26, 3072
  buffer_load_dwordx4 v2, s[4:7], s21 offen sc1 lds
  s_add_u32 s20, s36, 4096
  s_mov_b32 m0, s20
  s_add_u32 s21, s26, 4096
  buffer_load_dwordx4 v2, s[4:7], s21 offen sc1 lds
  s_add_u32 s20, s36, 5120
  s_mov_b32 m0, s20
  s_add_u32 s21, s26, 5120
  buffer_load_dwordx4 v2, s[4:7], s21 offen sc1 lds
  s_add_u32 s20, s36, 6144
  s_mov_b32 m0, s20
  s_add_u32 s21, s26, 6144
  buffer_load_dwordx4 v2, s[4:7], s21 offen sc1 lds
  s_add_u32 s20, s36, 7168
  s_mov_b32 m0, s20
  s_add_u32 s21, s26, 7168
  buffer_load_dwordx4 v2, s[4:7], s21 offen sc1 lds
  s_add_u32 s20, s36, 8192
  s_mov_b32 m0, s20
  s_add_u32 s21, s26, 8192
  buffer_load_dwordx4 v2, s[4:7], s21 offen sc1 lds
  s_add_u32 s20, s36, 9216
  s_mov_b32 m0, s20
  s_add_u32 s21, s26, 9216
  buffer_load_dwordx4 v2, s[4:7], s21 offen sc1 lds
  s_mul_i32 s30, s16, 327680
  s_lshl_b32 s20, s17, 10
  s_add_u32 s30, s30, s20
  s_add_u32 s30, s30, 59244544
  s_mov_b32 s18, 0
  ds_read_b128 v[56:59], v15 offset:0
  ds_read_b128 v[60:63], v15 offset:1024
  ds_read_b128 v[64:67], v15 offset:2048
  ds_read_b128 v[68:71], v15 offset:3072
  s_waitcnt vmcnt(0)
  s_branch LBPf_147
LBPl_148:
  s_cmp_lg_u32 s18, 16
  s_cbranch_scc1 LBPh_149
  s_mov_b32 s52, s32
  s_mov_b32 s53, s33
  s_mov_b32 s54, 256
  s_mov_b32 s55, 0x00020000
  s_cmp_lg_u32 s16, 0
  s_cbranch_scc1 Lwr_150
  v_lshrrev_b32 v16, 4, v2
  v_lshlrev_b32 v16, 7, v16
  v_mov_b32 v17, 196
  s_mov_b32 s51, 98304
  s_mov_b32 s50, 98304
Lwrt_151:
  buffer_load_dword v18, v16, s[4:7], s51 offen sc1
  s_waitcnt vmcnt(0)
  v_cmp_ne_u32 vcc, s70, v18
  s_cbranch_vccnz Lwra_153
  s_branch Lwrd_152
Lwra_153:
  s_sleep 2
  s_cmp_eq_u32 s19, 0
  s_cbranch_scc1 Lwrd_152
  s_sub_u32 s19, s19, 1
  s_branch Lwrt_151
Lwrd_152:
Lwr_150:
  s_barrier
LBPh_149:
  s_waitcnt vmcnt(10)
LBPf_147:
  s_barrier
  ds_read_b128 v[40:43], v2 offset:0
  ds_read_b128 v[44:47], v2 offset:20480
  ds_read_b128 v[48:51], v2 offset:1024
  ds_read_b128 v[52:55], v2 offset:21504
  s_waitcnt lgkmcnt(2)
  v_mfma_f32_16x16x32_bf16 v[16:19], a[0:3], v[40:43], 0
  v_mfma_f32_16x16x32_bf16 v[20:23], a[0:3], v[44:47], 0
  v_mfma_f32_16x16x32_bf16 v[24:27], a[8:11], v[40:43], 0
  v_mfma_f32_16x16x32_bf16 v[28:31], a[8:11], v[44:47], 0
  v_mfma_f32_16x16x32_bf16 v[32:35], a[16:19], v[40:43], 0
  v_mfma_f32_16x16x32_bf16 v[36:39], a[16:19], v[44:47], 0
  ds_read_b128 v[40:43], v2 offset:2048
  ds_read_b128 v[44:47], v2 offset:22528
  s_waitcnt lgkmcnt(2)
  v_mfma_f32_16x16x32_bf16 v[16:19], a[4:7], v[48:51], v[16:19]
  v_mfma_f32_16x16x32_bf16 v[20:23], a[4:7], v[52:55], v[20:23]
  v_mfma_f32_16x16x32_bf16 v[24:27], a[12:15], v[48:51], v[24:27]
  v_mfma_f32_16x16x32_bf16 v[28:31], a[12:15], v[52:55], v[28:31]
  v_mfma_f32_16x16x32_bf16 v[32:35], a[20:23], v[48:51], v[32:35]
  v_mfma_f32_16x16x32_bf16 v[36:39], a[20:23], v[52:55], v[36:39]
  ds_read_b128 v[48:51], v2 offset:3072
  ds_read_b128 v[52:55], v2 offset:23552
  s_waitcnt lgkmcnt(2)
  v_mfma_f32_16x16x32_bf16 v[16:19], a[24:27], v[40:43], v[16:19]
  v_mfma_f32_16x16x32_bf16 v[20:23], a[24:27], v[44:47], v[20:23]
  v_mfma_f32_16x16x32_bf16 v[24:27], v[56:59], v[40:43], v[24:27]
  v_mfma_f32_16x16x32_bf16 v[28:31], v[56:59], v[44:47], v[28:31]
  v_mfma_f32_16x16x32_bf16 v[32:35], a[32:35], v[40:43], v[32:35]
  v_mfma_f32_16x16x32_bf16 v[36:39], a[32:35], v[44:47], v[36:39]
  ds_read_b128 v[40:43], v2 offset:4096
  ds_read_b128 v[44:47], v2 offset:24576
  s_waitcnt lgkmcnt(2)
  v_mfma_f32_16x16x32_bf16 v[16:19], a[28:31], v[48:51], v[16:19]
  v_mfma_f32_16x16x32_bf16 v[20:23], a[28:31], v[52:55], v[20:23]
  v_mfma_f32_16x16x32_bf16 v[24:27], v[60:63], v[48:51], v[24:27]
  v_mfma_f32_16x16x32_bf16 v[28:31], v[60:63], v[52:55], v[28:31]
  ds_read_b128 v[56:59], v15 offset:4096
  ds_read_b128 v[60:63], v15 offset:5120
  v_mfma_f32_16x16x32_bf16 v[32:35], a[36:39], v[48:51], v[32:35]
  v_mfma_f32_16x16x32_bf16 v[36:39], a[36:39], v[52:55], v[36:39]
  ds_read_b128 v[48:51], v2 offset:5120
  ds_read_b128 v[52:55], v2 offset:25600
  s_waitcnt lgkmcnt(4)
  v_mfma_f32_16x16x32_bf16 v[16:19], a[40:43], v[40:43], v[16:19]
  v_mfma_f32_16x16x32_bf16 v[20:23], a[40:43], v[44:47], v[20:23]
  v_mfma_f32_16x16x32_bf16 v[24:27], a[48:51], v[40:43], v[24:27]
  v_mfma_f32_16x16x32_bf16 v[28:31], a[48:51], v[44:47], v[28:31]
  v_mfma_f32_16x16x32_bf16 v[32:35], a[56:59], v[40:43], v[32:35]
  v_mfma_f32_16x16x32_bf16 v[36:39], a[56:59], v[44:47], v[36:39]
  ds_read_b128 v[40:43], v2 offset:6144
  ds_read_b128 v[44:47], v2 offset:26624
  s_waitcnt lgkmcnt(2)
  v_mfma_f32_16x16x32_bf16 v[16:19], a[44:47], v[48:51], v[16:19]
  v_mfma_f32_16x16x32_bf16 v[20:23], a[44:47], v[52:55], v[20:23]
  v_mfma_f32_16x16x32_bf16 v[24:27], a[52:55], v[48:51], v[24:27]
  v_mfma_f32_16x16x32_bf16 v[28:31], a[52:55], v[52:55], v[28:31]
  v_mfma_f32_16x16x32_bf16 v[32:35], a[60:63], v[48:51], v[32:35]
  v_mfma_f32_16x16x32_bf16 v[36:39], a[60:63], v[52:55], v[36:39]
  ds_read_b128 v[48:51], v2 offset:7168
  ds_read_b128 v[52:55], v2 offset:27648
  s_waitcnt lgkmcnt(2)
  v_mfma_f32_16x16x32_bf16 v[16:19], v[64:67], v[40:43], v[16:19]
  v_mfma_f32_16x16x32_bf16 v[20:23], v[64:67], v[44:47], v[20:23]
  v_mfma_f32_16x16x32_bf16 v[24:27], a[64:67], v[40:43], v[24:27]
  v_mfma_f32_16x16x32_bf16 v[28:31], a[64:67], v[44:47], v[28:31]
  v_mfma_f32_16x16x32_bf16 v[32:35], a[72:75], v[40:43], v[32:35]
  v_mfma_f32_16x16x32_bf16 v[36:39], a[72:75], v[44:47], v[36:39]
  ds_read_b128 v[40:43], v2 offset:8192
  ds_read_b128 v[44:47], v2 offset:28672
  s_waitcnt lgkmcnt(2)
  v_mfma_f32_16x16x32_bf16 v[16:19], v[68:71], v[48:51], v[16:19]
  v_mfma_f32_16x16x32_bf16 v[20:23], v[68:71], v[52:55], v[20:23]
  ds_read_b128 v[64:67], v15 offset:6144
  ds_read_b128 v[68:71], v15 offset:7168
  v_mfma_f32_16x16x32_bf16 v[24:27], a[68:71], v[48:51], v[24:27]
  v_mfma_f32_16x16x32_bf16 v[28:31], a[68:71], v[52:55], v[28:31]
  v_mfma_f32_16x16x32_bf16 v[32:35], a[76:79], v[48:51], v[32:35]
  v_mfma_f32_16x16x32_bf16 v[36:39], a[76:79], v[52:55], v[36:39]
  ds_read_b128 v[48:51], v2 offset:9216
  ds_read_b128 v[52:55], v2 offset:29696
  s_waitcnt lgkmcnt(4)
  v_mfma_f32_16x16x32_bf16 v[16:19], a[80:83], v[40:43], v[16:19]
  v_mfma_f32_16x16x32_bf16 v[20:23], a[80:83], v[44:47], v[20:23]
  v_mfma_f32_16x16x32_bf16 v[24:27], a[88:91], v[40:43], v[24:27]
  v_mfma_f32_16x16x32_bf16 v[28:31], a[88:91], v[44:47], v[28:31]
  v_mfma_f32_16x16x32_bf16 v[32:35], v[56:59], v[40:43], v[32:35]
  v_mfma_f32_16x16x32_bf16 v[36:39], v[56:59], v[44:47], v[36:39]
  ds_read_b128 v[40:43], v2 offset:10240
  ds_read_b128 v[44:47], v2 offset:30720
  s_waitcnt lgkmcnt(2)
  v_mfma_f32_16x16x32_bf16 v[16:19], a[84:87], v[48:51], v[16:19]
  v_mfma_f32_16x16x32_bf16 v[20:23], a[84:87], v[52:55], v[20:23]
  v_mfma_f32_16x16x32_bf16 v[24:27], a[92:95], v[48:51], v[24:27]
  v_mfma_f32_16x16x32_bf16 v[28:31], a[92:95], v[52:55], v[28:31]
  v_mfma_f32_16x16x32_bf16 v[32:35], v[60:63], v[48:51], v[32:35]
  v_mfma_f32_16x16x32_bf16 v[36:39], v[60:63], v[52:55], v[36:39]
  ds_read_b128 v[56:59], v15 offset:8192
  ds_read_b128 v[60:63], v15 offset:9216
  ds_read_b128 v[48:51], v2 offset:11264
  ds_read_b128 v[52:55], v2 offset:31744
  s_waitcnt lgkmcnt(4)
  v_mfma_f32_16x16x32_bf16 v[16:19], a[96:99], v[40:43], v[16:19]
  v_mfma_f32_16x16x32_bf16 v[20:23], a[96:99], v[44:47], v[20:23]
  v_mfma_f32_16x16x32_bf16 v[24:27], a[104:107], v[40:43], v[24:27]
  v_mfma_f32_16x16x32_bf16 v[28:31], a[104:107], v[44:47], v[28:31]
  v_mfma_f32_16x16x32_bf16 v[32:35], a[112:115], v[40:43], v[32:35]
  v_mfma_f32_16x16x32_bf16 v[36:39], a[112:115], v[44:47], v[36:39]
  ds_read_b128 v[40:43], v2 offset:12288
  ds_read_b128 v[44:47], v2 offset:32768
  s_waitcnt lgkmcnt(2)
  v_mfma_f32_16x16x32_bf16 v[16:19], a[100:103], v[48:51], v[16:19]
  v_mfma_f32_16x16x32_bf16 v[20:23], a[100:103], v[52:55], v[20:23]
  v_mfma_f32_16x16x32_bf16 v[24:27], a[108:111], v[48:51], v[24:27]
  v_mfma_f32_16x16x32_bf16 v[28:31], a[108:111], v[52:55], v[28:31]
  v_mfma_f32_16x16x32_bf16 v[32:35], a[116:119], v[48:51], v[32:35]
  v_mfma_f32_16x16x32_bf16 v[36:39], a[116:119], v[52:55], v[36:39]
  ds_read_b128 v[48:51], v2 offset:13312
  ds_read_b128 v[52:55], v2 offset:33792
  s_waitcnt lgkmcnt(2)
  v_mfma_f32_16x16x32_bf16 v[16:19], a[120:123], v[40:43], v[16:19]
  v_mfma_f32_16x16x32_bf16 v[20:23], a[120:123], v[44:47], v[20:23]
  v_mfma_f32_16x16x32_bf16 v[24:27], v[64:67], v[40:43], v[24:27]
  v_mfma_f32_16x16x32_bf16 v[28:31], v[64:67], v[44:47], v[28:31]
  v_mfma_f32_16x16x32_bf16 v[32:35], a[128:131], v[40:43], v[32:35]
  v_mfma_f32_16x16x32_bf16 v[36:39], a[128:131], v[44:47], v[36:39]
  ds_read_b128 v[40:43], v2 offset:14336
  ds_read_b128 v[44:47], v2 offset:34816
  s_waitcnt lgkmcnt(2)
  v_mfma_f32_16x16x32_bf16 v[16:19], a[124:127], v[48:51], v[16:19]
  v_mfma_f32_16x16x32_bf16 v[20:23], a[124:127], v[52:55], v[20:23]
  v_mfma_f32_16x16x32_bf16 v[24:27], v[68:71], v[48:51], v[24:27]
  v_mfma_f32_16x16x32_bf16 v[28:31], v[68:71], v[52:55], v[28:31]
  ds_read_b128 v[64:67], v15 offset:10240
  ds_read_b128 v[68:71], v15 offset:11264
  v_mfma_f32_16x16x32_bf16 v[32:35], a[132:135], v[48:51], v[32:35]
  v_mfma_f32_16x16x32_bf16 v[36:39], a[132:135], v[52:55], v[36:39]
  ds_read_b128 v[48:51], v2 offset:15360
  ds_read_b128 v[52:55], v2 offset:35840
  s_waitcnt lgkmcnt(4)
  v_mfma_f32_16x16x32_bf16 v[16:19], a[136:139], v[40:43], v[16:19]
  v_mfma_f32_16x16x32_bf16 v[20:23], a[136:139], v[44:47], v[20:23]
  v_mfma_f32_16x16x32_bf16 v[24:27], a[144:147], v[40:43], v[24:27]
  v_mfma_f32_16x16x32_bf16 v[28:31], a[144:147], v[44:47], v[28:31]
  v_mfma_f32_16x16x32_bf16 v[32:35], a[152:155], v[40:43], v[32:35]
  v_mfma_f32_16x16x32_bf16 v[36:39], a[152:155], v[44:47], v[36:39]
  ds_read_b128 v[40:43], v2 offset:16384
  ds_read_b128 v[44:47], v2 offset:36864
  s_waitcnt lgkmcnt(2)
  v_mfma_f32_16x16x32_bf16 v[16:19], a[140:143], v[48:51], v[16:19]
  v_mfma_f32_16x16x32_bf16 v[20:23], a[140:143], v[52:55], v[20:23]
  v_mfma_f32_16x16x32_bf16 v[24:27], a[148:151], v[48:51], v[24:27]
  v_mfma_f32_16x16x32_bf16 v[28:31], a[148:151], v[52:55], v[28:31]
  v_mfma_f32_16x16x32_bf16 v[32:35], a[156:159], v[48:51], v[32:35]
  v_mfma_f32_16x16x32_bf16 v[36:39], a[156:159], v[52:55], v[36:39]
  ds_read_b128 v[48:51], v2 offset:17408
  ds_read_b128 v[52:55], v2 offset:37888
  s_waitcnt lgkmcnt(2)
  v_mfma_f32_16x16x32_bf16 v[16:19], v[56:59], v[40:43], v[16:19]
  v_mfma_f32_16x16x32_bf16 v[20:23], v[56:59], v[44:47], v[20:23]
  v_mfma_f32_16x16x32_bf16 v[24:27], a[160:163], v[40:43], v[24:27]
  v_mfma_f32_16x16x32_bf16 v[28:31], a[160:163], v[44:47], v[28:31]
  v_mfma_f32_16x16x32_bf16 v[32:35], a[168:171], v[40:43], v[32:35]
  v_mfma_f32_16x16x32_bf16 v[36:39], a[168:171], v[44:47], v[36:39]
  ds_read_b128 v[40:43], v2 offset:18432
  ds_read_b128 v[44:47], v2 offset:38912
  s_waitcnt lgkmcnt(2)
  v_mfma_f32_16x16x32_bf16 v[16:19], v[60:63], v[48:51], v[16:19]
  v_mfma_f32_16x16x32_bf16 v[20:23], v[60:63], v[52:55], v[20:23]
  ds_read_b128 v[56:59], v15 offset:12288
  ds_read_b128 v[60:63], v15 offset:13312
  v_mfma_f32_16x16x32_bf16 v[24:27], a[164:167], v[48:51], v[24:27]
  v_mfma_f32_16x16x32_bf16 v[28:31], a[164:167], v[52:55], v[28:31]
  v_mfma_f32_16x16x32_bf16 v[32:35], a[172:175], v[48:51], v[32:35]
  v_mfma_f32_16x16x32_bf16 v[36:39], a[172:175], v[52:55], v[36:39]
  ds_read_b128 v[48:51], v2 offset:19456
  ds_read_b128 v[52:55], v2 offset:39936
  s_waitcnt lgkmcnt(4)
  v_mfma_f32_16x16x32_bf16 v[16:19], a[176:179], v[40:43], v[16:19]
  v_mfma_f32_16x16x32_bf16 v[20:23], a[176:179], v[44:47], v[20:23]
  v_mfma_f32_16x16x32_bf16 v[24:27], a[184:187], v[40:43], v[24:27]
  v_mfma_f32_16x16x32_bf16 v[28:31], a[184:187], v[44:47], v[28:31]
  v_mfma_f32_16x16x32_bf16 v[32:35], v[64:67], v[40:43], v[32:35]
  v_mfma_f32_16x16x32_bf16 v[36:39], v[64:67], v[44:47], v[36:39]
  s_waitcnt lgkmcnt(0)
  v_mfma_f32_16x16x32_bf16 v[16:19], a[180:183], v[48:51], v[16:19]
  v_mfma_f32_16x16x32_bf16 v[20:23], a[180:183], v[52:55], v[20:23]
  v_mfma_f32_16x16x32_bf16 v[24:27], a[188:191], v[48:51], v[24:27]
  v_mfma_f32_16x16x32_bf16 v[28:31], a[188:191], v[52:55], v[28:31]
  v_mfma_f32_16x16x32_bf16 v[32:35], v[68:71], v[48:51], v[32:35]
  v_mfma_f32_16x16x32_bf16 v[36:39], v[68:71], v[52:55], v[36:39]
  ds_read_b128 v[64:67], v15 offset:14336
  ds_read_b128 v[68:71], v15 offset:15360
  v_cvt_pk_bf16_f32 v16, v16, v17
  v_cvt_pk_bf16_f32 v17, v18, v19
  ds_write_b64 v10, v[16:17] offset:0
  v_cvt_pk_bf16_f32 v20, v20, v21
  v_cvt_pk_bf16_f32 v21, v22, v23
  ds_write_b64 v10, v[20:21] offset:6144
  v_cvt_pk_bf16_f32 v24, v24, v25
  v_cvt_pk_bf16_f32 v25, v26, v27
  ds_write_b64 v11, v[24:25] offset:0
  v_cvt_pk_bf16_f32 v28, v28, v29
  v_cvt_pk_bf16_f32 v29, v30, v31
  ds_write_b64 v11, v[28:29] offset:6144
  v_cvt_pk_bf16_f32 v32, v32, v33
  v_cvt_pk_bf16_f32 v33, v34, v35
  ds_write_b64 v12, v[32:33] offset:0
  v_cvt_pk_bf16_f32 v36, v36, v37
  v_cvt_pk_bf16_f32 v37, v38, v39
  ds_write_b64 v12, v[36:37] offset:6144
  s_waitcnt vmcnt(0)
  s_waitcnt lgkmcnt(0)
  s_barrier
  v_mov_b32 v9, s18
  buffer_store_dword v9, v8, s[4:7], s44 offen sc1
  s_add_u32 s26, s26, 40960
  ds_read_b128 v[72:75], v13 offset:0
  ds_read_b128 v[96:99], v13 offset:6144
  ds_read_b128 v[76:79], v13 offset:1024
  ds_read_b128 v[100:103], v13 offset:7168
  ds_read_b128 v[80:83], v13 offset:2048
  ds_read_b128 v[104:107], v13 offset:8192
  ds_read_b128 v[84:87], v13 offset:3072
  ds_read_b128 v[108:111], v13 offset:9216
  ds_read_b128 v[88:91], v13 offset:4096
  ds_read_b128 v[112:115], v13 offset:10240
  ds_read_b128 v[92:95], v13 offset:5120
  ds_read_b128 v[116:119], v13 offset:11264
  s_waitcnt lgkmcnt(11)
  v_mfma_f32_16x16x32_bf16 v[16:19], v[72:75], a[192:195], 0
  s_add_u32 s76, s36, 0
  s_mov_b32 m0, s76
  s_add_u32 s77, s26, 0
  s_waitcnt lgkmcnt(10)
  v_mfma_f32_16x16x32_bf16 v[20:23], v[96:99], a[192:195], 0
  buffer_load_dwordx4 v2, s[4:7], s77 offen sc1 lds
  s_add_u32 s76, s36, 1024
  s_mov_b32 m0, s76
  s_waitcnt lgkmcnt(9)
  v_mfma_f32_16x16x32_bf16 v[16:19], v[76:79], a[196:199], v[16:19]
  s_add_u32 s77, s26, 1024
  buffer_load_dwordx4 v2, s[4:7], s77 offen sc1 lds
  s_add_u32 s76, s36, 2048
  s_waitcnt lgkmcnt(8)
  v_mfma_f32_16x16x32_bf16 v[20:23], v[100:103], a[196:199], v[20:23]
  s_mov_b32 m0, s76
  s_add_u32 s77, s26, 2048
  buffer_load_dwordx4 v2, s[4:7], s77 offen sc1 lds
  s_waitcnt lgkmcnt(7)
  v_mfma_f32_16x16x32_bf16 v[16:19], v[80:83], a[200:203], v[16:19]
  s_add_u32 s76, s36, 3072
  s_mov_b32 m0, s76
  s_add_u32 s77, s26, 3072
  s_waitcnt lgkmcnt(6)
  v_mfma_f32_16x16x32_bf16 v[20:23], v[104:107], a[200:203], v[20:23]
  buffer_load_dwordx4 v2, s[4:7], s77 offen sc1 lds
  s_add_u32 s76, s36, 4096
  s_mov_b32 m0, s76
  s_waitcnt lgkmcnt(5)
  v_mfma_f32_16x16x32_bf16 v[16:19], v[84:87], a[204:207], v[16:19]
  s_add_u32 s77, s26, 4096
  buffer_load_dwordx4 v2, s[4:7], s77 offen sc1 lds
  s_add_u32 s76, s36, 5120
  s_waitcnt lgkmcnt(4)
  v_mfma_f32_16x16x32_bf16 v[20:23], v[108:111], a[204:207], v[20:23]
  s_mov_b32 m0, s76
  s_add_u32 s77, s26, 5120
  buffer_load_dwordx4 v2, s[4:7], s77 offen sc1 lds
  s_waitcnt lgkmcnt(3)
  v_mfma_f32_16x16x32_bf16 v[16:19], v[88:91], a[208:211], v[16:19]
  s_add_u32 s76, s36, 6144
  s_mov_b32 m0, s76
  s_add_u32 s77, s26, 6144
  s_waitcnt lgkmcnt(2)
  v_mfma_f32_16x16x32_bf16 v[20:23], v[112:115], a[208:211], v[20:23]
  buffer_load_dwordx4 v2, s[4:7], s77 offen sc1 lds
  s_add_u32 s76, s36, 7168
  s_mov_b32 m0, s76
  s_waitcnt lgkmcnt(1)
  v_mfma_f32_16x16x32_bf16 v[16:19], v[92:95], a[212:215], v[16:19]
  s_add_u32 s77, s26, 7168
  buffer_load_dwordx4 v2, s[4:7], s77 offen sc1 lds
  s_add_u32 s76, s36, 8192
  s_waitcnt lgkmcnt(0)
  v_mfma_f32_16x16x32_bf16 v[20:23], v[116:119], a[212:215], v[20:23]
  s_mov_b32 m0, s76
  s_add_u32 s77, s26, 8192
  buffer_load_dwordx4 v2, s[4:7], s77 offen sc1 lds
  v_mfma_f32_16x16x32_bf16 v[24:27], v[72:75], a[216:219], 0
  s_add_u32 s76, s36, 9216
  s_mov_b32 m0, s76
  s_add_u32 s77, s26, 9216
  v_mfma_f32_16x16x32_bf16 v[28:31], v[96:99], a[216:219], 0
  buffer_load_dwordx4 v2, s[4:7], s77 offen sc1 lds
  v_mfma_f32_16x16x32_bf16 v[24:27], v[76:79], a[220:223], v[24:27]
  v_mfma_f32_16x16x32_bf16 v[28:31], v[100:103], a[220:223], v[28:31]
  v_mfma_f32_16x16x32_bf16 v[24:27], v[80:83], v[56:59], v[24:27]
  v_mfma_f32_16x16x32_bf16 v[28:31], v[104:107], v[56:59], v[28:31]
  v_cvt_pk_bf16_f32 v32, v16, v17
  v_cvt_pk_bf16_f32 v33, v18, v19
  v_cvt_pk_bf16_f32 v34, v20, v21
  v_cvt_pk_bf16_f32 v35, v22, v23
  s_add_u32 s20, s30, 0
  buffer_store_dwordx4 v[32:35], v2, s[4:7], s20 offen sc1
  v_mfma_f32_16x16x32_bf16 v[24:27], v[84:87], v[60:63], v[24:27]
  v_mfma_f32_16x16x32_bf16 v[28:31], v[108:111], v[60:63], v[28:31]
  ds_read_b128 v[56:59], v15 offset:16384
  ds_read_b128 v[60:63], v15 offset:17408
  v_mfma_f32_16x16x32_bf16 v[24:27], v[88:91], a[224:227], v[24:27]
  v_mfma_f32_16x16x32_bf16 v[28:31], v[112:115], a[224:227], v[28:31]
  v_mfma_f32_16x16x32_bf16 v[24:27], v[92:95], a[228:231], v[24:27]
  v_mfma_f32_16x16x32_bf16 v[28:31], v[116:119], a[228:231], v[28:31]
  v_mfma_f32_16x16x32_bf16 v[16:19], v[72:75], a[232:235], 0
  v_mfma_f32_16x16x32_bf16 v[20:23], v[96:99], a[232:235], 0
  v_mfma_f32_16x16x32_bf16 v[16:19], v[76:79], a[236:239], v[16:19]
  v_mfma_f32_16x16x32_bf16 v[20:23], v[100:103], a[236:239], v[20:23]
  v_mfma_f32_16x16x32_bf16 v[16:19], v[80:83], a[240:243], v[16:19]
  v_mfma_f32_16x16x32_bf16 v[20:23], v[104:107], a[240:243], v[20:23]
  v_cvt_pk_bf16_f32 v36, v24, v25
  v_cvt_pk_bf16_f32 v37, v26, v27
  v_cvt_pk_bf16_f32 v38, v28, v29
  v_cvt_pk_bf16_f32 v39, v30, v31
  s_add_u32 s20, s30, 32768
  buffer_store_dwordx4 v[36:39], v2, s[4:7], s20 offen sc1
  v_mfma_f32_16x16x32_bf16 v[16:19], v[84:87], a[244:247], v[16:19]
  v_mfma_f32_16x16x32_bf16 v[20:23], v[108:111], a[244:247], v[20:23]
  v_mfma_f32_16x16x32_bf16 v[16:19], v[88:91], a[248:251], v[16:19]
  v_mfma_f32_16x16x32_bf16 v[20:23], v[112:115], a[248:251], v[20:23]
  v_mfma_f32_16x16x32_bf16 v[16:19], v[92:95], a[252:255], v[16:19]
  v_mfma_f32_16x16x32_bf16 v[20:23], v[116:119], a[252:255], v[20:23]
  v_mfma_f32_16x16x32_bf16 v[24:27], v[72:75], v[64:67], 0
  v_mfma_f32_16x16x32_bf16 v[28:31], v[96:99], v[64:67], 0
  v_mfma_f32_16x16x32_bf16 v[24:27], v[76:79], v[68:71], v[24:27]
  v_mfma_f32_16x16x32_bf16 v[28:31], v[100:103], v[68:71], v[28:31]
  ds_read_b128 v[64:67], v15 offset:18432
  ds_read_b128 v[68:71], v15 offset:19456
  v_mfma_f32_16x16x32_bf16 v[24:27], v[80:83], v[128:131], v[24:27]
  v_mfma_f32_16x16x32_bf16 v[28:31], v[104:107], v[128:131], v[28:31]
  v_cvt_pk_bf16_f32 v32, v16, v17
  v_cvt_pk_bf16_f32 v33, v18, v19
  v_cvt_pk_bf16_f32 v34, v20, v21
  v_cvt_pk_bf16_f32 v35, v22, v23
  s_add_u32 s20, s30, 65536
  buffer_store_dwordx4 v[32:35], v2, s[4:7], s20 offen sc1
  v_mfma_f32_16x16x32_bf16 v[24:27], v[84:87], v[132:135], v[24:27]
  v_mfma_f32_16x16x32_bf16 v[28:31], v[108:111], v[132:135], v[28:31]
  v_mfma_f32_16x16x32_bf16 v[24:27], v[88:91], v[136:139], v[24:27]
  v_mfma_f32_16x16x32_bf16 v[28:31], v[112:115], v[136:139], v[28:31]
  v_mfma_f32_16x16x32_bf16 v[24:27], v[92:95], v[140:143], v[24:27]
  v_mfma_f32_16x16x32_bf16 v[28:31], v[116:119], v[140:143], v[28:31]
  v_mfma_f32_16x16x32_bf16 v[16:19], v[72:75], v[144:147], 0
  v_mfma_f32_16x16x32_bf16 v[20:23], v[96:99], v[144:147], 0
  v_mfma_f32_16x16x32_bf16 v[16:19], v[76:79], v[148:151], v[16:19]
  v_mfma_f32_16x16x32_bf16 v[20:23], v[100:103], v[148:151], v[20:23]
  v_mfma_f32_16x16x32_bf16 v[16:19], v[80:83], v[152:155], v[16:19]
  v_mfma_f32_16x16x32_bf16 v[20:23], v[104:107], v[152:155], v[20:23]
  v_cvt_pk_bf16_f32 v36, v24, v25
  v_cvt_pk_bf16_f32 v37, v26, v27
  v_cvt_pk_bf16_f32 v38, v28, v29
  v_cvt_pk_bf16_f32 v39, v30, v31
  s_add_u32 s20, s30, 98304
  buffer_store_dwordx4 v[36:39], v2, s[4:7], s20 offen sc1
  v_mfma_f32_16x16x32_bf16 v[16:19], v[84:87], v[156:159], v[16:19]
  v_mfma_f32_16x16x32_bf16 v[20:23], v[108:111], v[156:159], v[20:23]
  s_waitcnt lgkmcnt(2)
  v_mfma_f32_16x16x32_bf16 v[16:19], v[88:91], v[56:59], v[16:19]
  v_mfma_f32_16x16x32_bf16 v[20:23], v[112:115], v[56:59], v[20:23]
  v_mfma_f32_16x16x32_bf16 v[16:19], v[92:95], v[60:63], v[16:19]
  v_mfma_f32_16x16x32_bf16 v[20:23], v[116:119], v[60:63], v[20:23]
  ds_read_b128 v[56:59], v15 offset:20480
  ds_read_b128 v[60:63], v15 offset:21504
  v_mfma_f32_16x16x32_bf16 v[24:27], v[72:75], v[160:163], 0
  v_mfma_f32_16x16x32_bf16 v[28:31], v[96:99], v[160:163], 0
  v_mfma_f32_16x16x32_bf16 v[24:27], v[76:79], v[164:167], v[24:27]
  v_mfma_f32_16x16x32_bf16 v[28:31], v[100:103], v[164:167], v[28:31]
  v_mfma_f32_16x16x32_bf16 v[24:27], v[80:83], v[168:171], v[24:27]
  v_mfma_f32_16x16x32_bf16 v[28:31], v[104:107], v[168:171], v[28:31]
  v_cvt_pk_bf16_f32 v32, v16, v17
  v_cvt_pk_bf16_f32 v33, v18, v19
  v_cvt_pk_bf16_f32 v34, v20, v21
  v_cvt_pk_bf16_f32 v35, v22, v23
  s_add_u32 s20, s30, 131072
  buffer_store_dwordx4 v[32:35], v2, s[4:7], s20 offen sc1
  v_mfma_f32_16x16x32_bf16 v[24:27], v[84:87], v[172:175], v[24:27]
  v_mfma_f32_16x16x32_bf16 v[28:31], v[108:111], v[172:175], v[28:31]
  v_mfma_f32_16x16x32_bf16 v[24:27], v[88:91], v[176:179], v[24:27]
  v_mfma_f32_16x16x32_bf16 v[28:31], v[112:115], v[176:179], v[28:31]
  v_mfma_f32_16x16x32_bf16 v[24:27], v[92:95], v[180:183], v[24:27]
  v_mfma_f32_16x16x32_bf16 v[28:31], v[116:119], v[180:183], v[28:31]
  v_mfma_f32_16x16x32_bf16 v[16:19], v[72:75], v[184:187], 0
  v_mfma_f32_16x16x32_bf16 v[20:23], v[96:99], v[184:187], 0
  v_mfma_f32_16x16x32_bf16 v[16:19], v[76:79], v[188:191], v[16:19]
  v_mfma_f32_16x16x32_bf16 v[20:23], v[100:103], v[188:191], v[20:23]
  s_waitcnt lgkmcnt(2)
  v_mfma_f32_16x16x32_bf16 v[16:19], v[80:83], v[64:67], v[16:19]
  v_mfma_f32_16x16x32_bf16 v[20:23], v[104:107], v[64:67], v[20:23]
  v_cvt_pk_bf16_f32 v36, v24, v25
  v_cvt_pk_bf16_f32 v37, v26, v27
  v_cvt_pk_bf16_f32 v38, v28, v29
  v_cvt_pk_bf16_f32 v39, v30, v31
  s_add_u32 s20, s30, 163840
  buffer_store_dwordx4 v[36:39], v2, s[4:7], s20 offen sc1
  v_mfma_f32_16x16x32_bf16 v[16:19], v[84:87], v[68:71], v[16:19]
  v_mfma_f32_16x16x32_bf16 v[20:23], v[108:111], v[68:71], v[20:23]
  ds_read_b128 v[64:67], v15 offset:22528
  ds_read_b128 v[68:71], v15 offset:23552
  v_mfma_f32_16x16x32_bf16 v[16:19], v[88:91], v[192:195], v[16:19]
  v_mfma_f32_16x16x32_bf16 v[20:23], v[112:115], v[192:195], v[20:23]
  v_mfma_f32_16x16x32_bf16 v[16:19], v[92:95], v[196:199], v[16:19]
  v_mfma_f32_16x16x32_bf16 v[20:23], v[116:119], v[196:199], v[20:23]
  v_mfma_f32_16x16x32_bf16 v[24:27], v[72:75], v[200:203], 0
  v_mfma_f32_16x16x32_bf16 v[28:31], v[96:99], v[200:203], 0
  v_mfma_f32_16x16x32_bf16 v[24:27], v[76:79], v[204:207], v[24:27]
  v_mfma_f32_16x16x32_bf16 v[28:31], v[100:103], v[204:207], v[28:31]
  v_mfma_f32_16x16x32_bf16 v[24:27], v[80:83], v[208:211], v[24:27]
  v_mfma_f32_16x16x32_bf16 v[28:31], v[104:107], v[208:211], v[28:31]
  v_cvt_pk_bf16_f32 v32, v16, v17
  v_cvt_pk_bf16_f32 v33, v18, v19
  v_cvt_pk_bf16_f32 v34, v20, v21
  v_cvt_pk_bf16_f32 v35, v22, v23
  s_add_u32 s20, s30, 196608
  buffer_store_dwordx4 v[32:35], v2, s[4:7], s20 offen sc1
  v_mfma_f32_16x16x32_bf16 v[24:27], v[84:87], v[212:215], v[24:27]
  v_mfma_f32_16x16x32_bf16 v[28:31], v[108:111], v[212:215], v[28:31]
  v_mfma_f32_16x16x32_bf16 v[24:27], v[88:91], v[216:219], v[24:27]
  v_mfma_f32_16x16x32_bf16 v[28:31], v[112:115], v[216:219], v[28:31]
  v_mfma_f32_16x16x32_bf16 v[24:27], v[92:95], v[220:223], v[24:27]
  v_mfma_f32_16x16x32_bf16 v[28:31], v[116:119], v[220:223], v[28:31]
  s_waitcnt lgkmcnt(2)
  v_mfma_f32_16x16x32_bf16 v[16:19], v[72:75], v[56:59], 0
  v_mfma_f32_16x16x32_bf16 v[20:23], v[96:99], v[56:59], 0
  v_mfma_f32_16x16x32_bf16 v[16:19], v[76:79], v[60:63], v[16:19]
  v_mfma_f32_16x16x32_bf16 v[20:23], v[100:103], v[60:63], v[20:23]
  ds_read_b128 v[56:59], v15 offset:0
  ds_read_b128 v[60:63], v15 offset:1024
  v_mfma_f32_16x16x32_bf16 v[16:19], v[80:83], v[224:227], v[16:19]
  v_mfma_f32_16x16x32_bf16 v[20:23], v[104:107], v[224:227], v[20:23]
  v_cvt_pk_bf16_f32 v36, v24, v25
  v_cvt_pk_bf16_f32 v37, v26, v27
  v_cvt_pk_bf16_f32 v38, v28, v29
  v_cvt_pk_bf16_f32 v39, v30, v31
  s_add_u32 s20, s30, 229376
  buffer_store_dwordx4 v[36:39], v2, s[4:7], s20 offen sc1
  v_mfma_f32_16x16x32_bf16 v[16:19], v[84:87], v[228:231], v[16:19]
  v_mfma_f32_16x16x32_bf16 v[20:23], v[108:111], v[228:231], v[20:23]
  v_mfma_f32_16x16x32_bf16 v[16:19], v[88:91], v[232:235], v[16:19]
  v_mfma_f32_16x16x32_bf16 v[20:23], v[112:115], v[232:235], v[20:23]
  v_mfma_f32_16x16x32_bf16 v[16:19], v[92:95], v[236:239], v[16:19]
  v_mfma_f32_16x16x32_bf16 v[20:23], v[116:119], v[236:239], v[20:23]
  v_mfma_f32_16x16x32_bf16 v[24:27], v[72:75], v[240:243], 0
  v_mfma_f32_16x16x32_bf16 v[28:31], v[96:99], v[240:243], 0
  v_mfma_f32_16x16x32_bf16 v[24:27], v[76:79], v[244:247], v[24:27]
  v_mfma_f32_16x16x32_bf16 v[28:31], v[100:103], v[244:247], v[28:31]
  v_mfma_f32_16x16x32_bf16 v[24:27], v[80:83], v[248:251], v[24:27]
  v_mfma_f32_16x16x32_bf16 v[28:31], v[104:107], v[248:251], v[28:31]
  v_cvt_pk_bf16_f32 v32, v16, v17
  v_cvt_pk_bf16_f32 v33, v18, v19
  v_cvt_pk_bf16_f32 v34, v20, v21
  v_cvt_pk_bf16_f32 v35, v22, v23
  s_add_u32 s20, s30, 262144
  buffer_store_dwordx4 v[32:35], v2, s[4:7], s20 offen sc1
  v_mfma_f32_16x16x32_bf16 v[24:27], v[84:87], v[252:255], v[24:27]
  v_mfma_f32_16x16x32_bf16 v[28:31], v[108:111], v[252:255], v[28:31]
  s_waitcnt lgkmcnt(2)
  v_mfma_f32_16x16x32_bf16 v[24:27], v[88:91], v[64:67], v[24:27]
  v_mfma_f32_16x16x32_bf16 v[28:31], v[112:115], v[64:67], v[28:31]
  v_mfma_f32_16x16x32_bf16 v[24:27], v[92:95], v[68:71], v[24:27]
  v_mfma_f32_16x16x32_bf16 v[28:31], v[116:119], v[68:71], v[28:31]
  ds_read_b128 v[64:67], v15 offset:2048
  ds_read_b128 v[68:71], v15 offset:3072
  s_nop 2
  v_cvt_pk_bf16_f32 v36, v24, v25
  v_cvt_pk_bf16_f32 v37, v26, v27
  s_nop 0
  v_cvt_pk_bf16_f32 v38, v28, v29
  v_cvt_pk_bf16_f32 v39, v30, v31
  s_add_u32 s20, s30, 294912
  buffer_store_dwordx4 v[36:39], v2, s[4:7], s20 offen sc1
  s_add_u32 s30, s30, 1310720
  s_add_u32 s18, s18, 1
  s_cmp_lg_u32 s18, 1
  s_cbranch_scc1 LBP0_154
  s_waitcnt vmcnt(0)
  s_mov_b32 s52, s32
  s_mov_b32 s53, s33
  s_mov_b32 s54, 256
  s_mov_b32 s55, 0x00020000
  s_cmp_lg_u32 s16, 0
  s_cbranch_scc1 Lwr_155
  v_lshrrev_b32 v16, 4, v2
  v_lshlrev_b32 v16, 7, v16
  v_mov_b32 v17, 196
  s_mov_b32 s51, 106496
  s_mov_b32 s50, 114688
Lwrt_156:
  buffer_load_dword v18, v16, s[4:7], s51 offen sc1
  buffer_load_dword v19, v16, s[4:7], s50 offen sc1
  s_waitcnt vmcnt(0)
  v_cmp_ne_u32 vcc, s70, v18
  s_cbranch_vccnz Lwra_158
  v_cmp_ne_u32 vcc, s70, v19
  s_cbranch_vccnz Lwra_158
  s_branch Lwrd_157
Lwra_158:
  s_sleep 2
  s_cmp_eq_u32 s19, 0
  s_cbranch_scc1 Lwrd_157
  s_sub_u32 s19, s19, 1
  s_branch Lwrt_156
Lwrd_157:
Lwr_155:
  s_barrier
  v_mov_b32 v9, s18
  buffer_store_dword v9, v8, s[4:7], s44 offen sc1
LBP0_154:
  s_cmp_lt_u32 s18, s31
  s_cbranch_scc1 LBPl_148
  s_waitcnt vmcnt(0) lgkmcnt(0)
  s_barrier
  v_mov_b32 v9, s18
  buffer_store_dword v9, v8, s[4:7], s44 offen sc1
  s_branch L_end
L_goF2:
  s_load_dwordx2 s[8:9], s[0:1], 80
  s_mov_b32 s10, 0x1e0000
  s_mov_b32 s11, 0x00020000
  s_load_dwordx2 s[12:13], s[0:1], 104
  s_mov_b32 s14, 0x280000
  s_mov_b32 s15, 0x00020000
  v_lshrrev_b32 v3, 6, v0
  v_and_b32 v1, 63, v0
  v_readfirstlane_b32 s16, v3
  v_lshlrev_b32 v2, 4, v1
  s_mov_b32 s19, 400000
  s_waitcnt lgkmcnt(0)
  s_cmp_ge_u32 s17, 10
  s_cselect_b32 s45, 1, 0
  s_mul_i32 s20, s45, 10
  s_sub_u32 s27, s17, s20
  v_min_u32 v0, 23, v1
  s_mul_i32 s20, s45, 24
  v_add_u32 v0, s20, v0
  v_lshlrev_b32 v0, 7, v0
  s_lshl_b32 s34, s16, 14
  v_add_u32 v83, 0, v1
  s_mov_b32 s20, 524289
  v_mul_lo_u32 v84, v83, s20
  v_lshrrev_b32 v84, 20, v84
  v_mul_u32_u24 v80, 2, v84
  v_sub_u32 v80, v83, v80
  v_lshlrev_b32 v80, 4, v80
  s_mov_b32 s20, 1280
  v_mul_lo_u32 v84, v84, s20
  v_add_u32 v80, v80, v84
  v_lshrrev_b32 v83, 4, v1
  v_mul_u32_u24 v83, 4, v83
  v_bfe_u32 v84, v1, 2, 2
  v_add_u32 v83, v83, v84
  v_mul_u32_u24 v83, 32, v83
  v_and_b32 v84, 3, v1
  v_lshlrev_b32 v84, 3, v84
  v_add_u32 v85, v83, v84
  v_add_u32 v85, s34, v85
  s_lshl_b32 s35, s27, 2
  s_add_u32 s35, s35, s16
  s_lshl_b32 s35, s35, 5
  s_mov_b32 s38, s35
  s_mov_b32 s52, s32
  s_mov_b32 s53, s33
  s_mov_b32 s54, 256
  s_mov_b32 s55, 0x00020000
  s_cmp_lg_u32 s16, 0
  s_cbranch_scc1 Lwr_159
  v_lshrrev_b32 v16, 4, v2
  v_lshlrev_b32 v16, 7, v16
  v_mov_b32 v17, 196
  s_mov_b32 s51, 106496
  s_mov_b32 s50, 114688
Lwrt_160:
  buffer_load_dword v18, v16, s[4:7], s51 offen sc1
  buffer_load_dword v19, v16, s[4:7], s50 offen sc1
  s_waitcnt vmcnt(0)
  v_cmp_ne_u32 vcc, s70, v18
  s_cbranch_vccnz Lwra_162
  v_cmp_ne_u32 vcc, s70, v19
  s_cbranch_vccnz Lwra_162
  s_branch Lwrd_161
Lwra_162:
  s_sleep 2
  s_cmp_eq_u32 s19, 0
  s_cbranch_scc1 Lwrd_161
  s_sub_u32 s19, s19, 1
  s_branch Lwrt_160
Lwrd_161:
Lwr_159:
  s_barrier
  s_sleep 100
  s_add_u32 s20, s35, 0
  s_add_u32 s21, s34, 0
  s_mov_b32 m0, s21
  s_nop 0
  buffer_load_dwordx4 v80, s[8:11], s20 offen lds
  s_add_u32 s20, s35, 40960
  s_add_u32 s21, s34, 1024
  s_mov_b32 m0, s21
  s_nop 0
  buffer_load_dwordx4 v80, s[8:11], s20 offen lds
  s_add_u32 s20, s35, 81920
  s_add_u32 s21, s34, 2048
  s_mov_b32 m0, s21
  s_nop 0
  buffer_load_dwordx4 v80, s[8:11], s20 offen lds
  s_add_u32 s20, s35, 122880
  s_add_u32 s21, s34, 3072
  s_mov_b32 m0, s21
  s_nop 0
  buffer_load_dwordx4 v80, s[8:11], s20 offen lds
  s_add_u32 s20, s35, 163840
  s_add_u32 s21, s34, 4096
  s_mov_b32 m0, s21
  s_nop 0
  buffer_load_dwordx4 v80, s[8:11], s20 offen lds
  s_add_u32 s20, s35, 204800
  s_add_u32 s21, s34, 5120
  s_mov_b32 m0, s21
  s_nop 0
  buffer_load_dwordx4 v80, s[8:11], s20 offen lds
  s_add_u32 s20, s35, 245760
  s_add_u32 s21, s34, 6144
  s_mov_b32 m0, s21
  s_nop 0
  buffer_load_dwordx4 v80, s[8:11], s20 offen lds
  s_add_u32 s20, s35, 286720
  s_add_u32 s21, s34, 7168
  s_mov_b32 m0, s21
  s_nop 0
  buffer_load_dwordx4 v80, s[8:11], s20 offen lds
  s_add_u32 s20, s35, 327680
  s_add_u32 s21, s34, 8192
  s_mov_b32 m0, s21
  s_nop 0
  buffer_load_dwordx4 v80, s[8:11], s20 offen lds
  s_add_u32 s20, s35, 368640
  s_add_u32 s21, s34, 9216
  s_mov_b32 m0, s21
  s_nop 0
  buffer_load_dwordx4 v80, s[8:11], s20 offen lds
  s_add_u32 s20, s35, 409600
  s_add_u32 s21, s34, 10240
  s_mov_b32 m0, s21
  s_nop 0
  buffer_load_dwordx4 v80, s[8:11], s20 offen lds
  s_add_u32 s20, s35, 450560
  s_add_u32 s21, s34, 11264
  s_mov_b32 m0, s21
  s_nop 0
  buffer_load_dwordx4 v80, s[8:11], s20 offen lds
  s_add_u32 s20, s35, 491520
  s_add_u32 s21, s34, 12288
  s_mov_b32 m0, s21
  s_nop 0
  buffer_load_dwordx4 v80, s[8:11], s20 offen lds
  s_add_u32 s20, s35, 532480
  s_add_u32 s21, s34, 13312
  s_mov_b32 m0, s21
  s_nop 0
  buffer_load_dwordx4 v80, s[8:11], s20 offen lds
  s_add_u32 s20, s35, 573440
  s_add_u32 s21, s34, 14336
  s_mov_b32 m0, s21
  s_nop 0
  buffer_load_dwordx4 v80, s[8:11], s20 offen lds
  s_waitcnt vmcnt(14)
  ds_read_b64_tr_b16 a[0:1], v85 offset:0
  ds_read_b64_tr_b16 a[2:3], v85 offset:512
  s_waitcnt lgkmcnt(0)
  s_add_u32 s20, s35, 614400
  s_add_u32 s21, s34, 15360
  s_mov_b32 m0, s21
  s_nop 0
  buffer_load_dwordx4 v80, s[8:11], s20 offen lds
  s_waitcnt vmcnt(14)
  ds_read_b64_tr_b16 a[4:5], v85 offset:1024
  ds_read_b64_tr_b16 a[6:7], v85 offset:1536
  s_waitcnt lgkmcnt(0)
  s_add_u32 s20, s35, 655360
  s_add_u32 s21, s34, 0
  s_mov_b32 m0, s21
  s_nop 0
  buffer_load_dwordx4 v80, s[8:11], s20 offen lds
  s_waitcnt vmcnt(14)
  ds_read_b64_tr_b16 a[8:9], v85 offset:2048
  ds_read_b64_tr_b16 a[10:11], v85 offset:2560
  s_waitcnt lgkmcnt(0)
  s_add_u32 s20, s35, 696320
  s_add_u32 s21, s34, 1024
  s_mov_b32 m0, s21
  s_nop 0
  buffer_load_dwordx4 v80, s[8:11], s20 offen lds
  s_waitcnt vmcnt(14)
  ds_read_b64_tr_b16 a[12:13], v85 offset:3072
  ds_read_b64_tr_b16 a[14:15], v85 offset:3584
  s_waitcnt lgkmcnt(0)
  s_add_u32 s20, s35, 737280
  s_add_u32 s21, s34, 2048
  s_mov_b32 m0, s21
  s_nop 0
  buffer_load_dwordx4 v80, s[8:11], s20 offen lds
  s_waitcnt vmcnt(14)
  ds_read_b64_tr_b16 a[16:17], v85 offset:4096
  ds_read_b64_tr_b16 a[18:19], v85 offset:4608
  s_waitcnt lgkmcnt(0)
  s_add_u32 s20, s35, 778240
  s_add_u32 s21, s34, 3072
  s_mov_b32 m0, s21
  s_nop 0
  buffer_load_dwordx4 v80, s[8:11], s20 offen lds
  s_waitcnt vmcnt(14)
  ds_read_b64_tr_b16 a[20:21], v85 offset:5120
  ds_read_b64_tr_b16 a[22:23], v85 offset:5632
  s_waitcnt lgkmcnt(0)
  s_add_u32 s20, s35, 819200
  s_add_u32 s21, s34, 4096
  s_mov_b32 m0, s21
  s_nop 0
  buffer_load_dwordx4 v80, s[8:11], s20 offen lds
  s_waitcnt vmcnt(14)
  ds_read_b64_tr_b16 a[24:25], v85 offset:6144
  ds_read_b64_tr_b16 a[26:27], v85 offset:6656
  s_waitcnt lgkmcnt(0)
  s_add_u32 s20, s35, 860160
  s_add_u32 s21, s34, 5120
  s_mov_b32 m0, s21
  s_nop 0
  buffer_load_dwordx4 v80, s[8:11], s20 offen lds
  s_waitcnt vmcnt(14)
  ds_read_b64_tr_b16 a[28:29], v85 offset:7168
  ds_read_b64_tr_b16 a[30:31], v85 offset:7680
  s_waitcnt lgkmcnt(0)
  s_add_u32 s20, s35, 901120
  s_add_u32 s21, s34, 6144
  s_mov_b32 m0, s21
  s_nop 0
  buffer_load_dwordx4 v80, s[8:11], s20 offen lds
  s_waitcnt vmcnt(14)
  ds_read_b64_tr_b16 a[32:33], v85 offset:8192
  ds_read_b64_tr_b16 a[34:35], v85 offset:8704
  s_waitcnt lgkmcnt(0)
  s_add_u32 s20, s35, 942080
  s_add_u32 s21, s34, 7168
  s_mov_b32 m0, s21
  s_nop 0
  buffer_load_dwordx4 v80, s[8:11], s20 offen lds
  s_waitcnt vmcnt(14)
  ds_read_b64_tr_b16 a[36:37], v85 offset:9216
  ds_read_b64_tr_b16 a[38:39], v85 offset:9728
  s_waitcnt lgkmcnt(0)
  s_add_u32 s20, s35, 983040
  s_add_u32 s21, s34, 8192
  s_mov_b32 m0, s21
  s_nop 0
  buffer_load_dwordx4 v80, s[8:11], s20 offen lds
  s_waitcnt vmcnt(14)
  ds_read_b64_tr_b16 a[40:41], v85 offset:10240
  ds_read_b64_tr_b16 a[42:43], v85 offset:10752
  s_waitcnt lgkmcnt(0)
  s_add_u32 s20, s35, 1024000
  s_add_u32 s21, s34, 9216
  s_mov_b32 m0, s21
  s_nop 0
  buffer_load_dwordx4 v80, s[8:11], s20 offen lds
  s_waitcnt vmcnt(14)
  ds_read_b64_tr_b16 a[44:45], v85 offset:11264
  ds_read_b64_tr_b16 a[46:47], v85 offset:11776
  s_waitcnt lgkmcnt(0)
  s_add_u32 s20, s35, 1064960
  s_add_u32 s21, s34, 10240
  s_mov_b32 m0, s21
  s_nop 0
  buffer_load_dwordx4 v80, s[8:11], s20 offen lds
  s_waitcnt vmcnt(14)
  ds_read_b64_tr_b16 a[48:49], v85 offset:12288
  ds_read_b64_tr_b16 a[50:51], v85 offset:12800
  s_waitcnt lgkmcnt(0)
  s_add_u32 s20, s35, 1105920
  s_add_u32 s21, s34, 11264
  s_mov_b32 m0, s21
  s_nop 0
  buffer_load_dwordx4 v80, s[8:11], s20 offen lds
  s_waitcnt vmcnt(14)
  ds_read_b64_tr_b16 a[52:53], v85 offset:13312
  ds_read_b64_tr_b16 a[54:55], v85 offset:13824
  s_waitcnt lgkmcnt(0)
  s_add_u32 s20, s35, 1146880
  s_add_u32 s21, s34, 12288
  s_mov_b32 m0, s21
  s_nop 0
  buffer_load_dwordx4 v80, s[8:11], s20 offen lds
  s_waitcnt vmcnt(14)
  ds_read_b64_tr_b16 a[56:57], v85 offset:14336
  ds_read_b64_tr_b16 a[58:59], v85 offset:14848
  s_waitcnt lgkmcnt(0)
  s_add_u32 s20, s35, 1187840
  s_add_u32 s21, s34, 13312
  s_mov_b32 m0, s21
  s_nop 0
  buffer_load_dwordx4 v80, s[8:11], s20 offen lds
  s_waitcnt vmcnt(14)
  ds_read_b64_tr_b16 a[60:61], v85 offset:15360
  ds_read_b64_tr_b16 a[62:63], v85 offset:15872
  s_waitcnt lgkmcnt(0)
  s_add_u32 s20, s35, 1228800
  s_add_u32 s21, s34, 14336
  s_mov_b32 m0, s21
  s_nop 0
  buffer_load_dwordx4 v80, s[8:11], s20 offen lds
  s_waitcnt vmcnt(14)
  ds_read_b64_tr_b16 a[64:65], v85 offset:0
  ds_read_b64_tr_b16 a[66:67], v85 offset:512
  s_waitcnt lgkmcnt(0)
  s_add_u32 s20, s35, 1269760
  s_add_u32 s21, s34, 15360
  s_mov_b32 m0, s21
  s_nop 0
  buffer_load_dwordx4 v80, s[8:11], s20 offen lds
  s_waitcnt vmcnt(14)
  ds_read_b64_tr_b16 a[68:69], v85 offset:1024
  ds_read_b64_tr_b16 a[70:71], v85 offset:1536
  s_waitcnt lgkmcnt(0)
  s_add_u32 s20, s35, 1310720
  s_add_u32 s21, s34, 0
  s_mov_b32 m0, s21
  s_nop 0
  buffer_load_dwordx4 v80, s[8:11], s20 offen lds
  s_waitcnt vmcnt(14)
  ds_read_b64_tr_b16 a[72:73], v85 offset:2048
  ds_read_b64_tr_b16 a[74:75], v85 offset:2560
  s_waitcnt lgkmcnt(0)
  s_add_u32 s20, s35, 1351680
  s_add_u32 s21, s34, 1024
  s_mov_b32 m0, s21
  s_nop 0
  buffer_load_dwordx4 v80, s[8:11], s20 offen lds
  s_waitcnt vmcnt(14)
  ds_read_b64_tr_b16 a[76:77], v85 offset:3072
  ds_read_b64_tr_b16 a[78:79], v85 offset:3584
  s_waitcnt lgkmcnt(0)
  s_add_u32 s20, s35, 1392640
  s_add_u32 s21, s34, 2048
  s_mov_b32 m0, s21
  s_nop 0
  buffer_load_dwordx4 v80, s[8:11], s20 offen lds
  s_waitcnt vmcnt(14)
  ds_read_b64_tr_b16 a[80:81], v85 offset:4096
  ds_read_b64_tr_b16 a[82:83], v85 offset:4608
  s_waitcnt lgkmcnt(0)
  s_add_u32 s20, s35, 1433600
  s_add_u32 s21, s34, 3072
  s_mov_b32 m0, s21
  s_nop 0
  buffer_load_dwordx4 v80, s[8:11], s20 offen lds
  s_waitcnt vmcnt(14)
  ds_read_b64_tr_b16 a[84:85], v85 offset:5120
  ds_read_b64_tr_b16 a[86:87], v85 offset:5632
  s_waitcnt lgkmcnt(0)
  s_add_u32 s20, s35, 1474560
  s_add_u32 s21, s34, 4096
  s_mov_b32 m0, s21
  s_nop 0
  buffer_load_dwordx4 v80, s[8:11], s20 offen lds
  s_waitcnt vmcnt(14)
  ds_read_b64_tr_b16 a[88:89], v85 offset:6144
  ds_read_b64_tr_b16 a[90:91], v85 offset:6656
  s_waitcnt lgkmcnt(0)
  s_add_u32 s20, s35, 1515520
  s_add_u32 s21, s34, 5120
  s_mov_b32 m0, s21
  s_nop 0
  buffer_load_dwordx4 v80, s[8:11], s20 offen lds
  s_waitcnt vmcnt(14)
  ds_read_b64_tr_b16 a[92:93], v85 offset:7168
  ds_read_b64_tr_b16 a[94:95], v85 offset:7680
  s_waitcnt lgkmcnt(0)
  s_add_u32 s20, s35, 1556480
  s_add_u32 s21, s34, 6144
  s_mov_b32 m0, s21
  s_nop 0
  buffer_load_dwordx4 v80, s[8:11], s20 offen lds
  s_waitcnt vmcnt(14)
  ds_read_b64_tr_b16 a[96:97], v85 offset:8192
  ds_read_b64_tr_b16 a[98:99], v85 offset:8704
  s_waitcnt lgkmcnt(0)
  s_add_u32 s20, s35, 1597440
  s_add_u32 s21, s34, 7168
  s_mov_b32 m0, s21
  s_nop 0
  buffer_load_dwordx4 v80, s[8:11], s20 offen lds
  s_waitcnt vmcnt(14)
  ds_read_b64_tr_b16 a[100:101], v85 offset:9216
  ds_read_b64_tr_b16 a[102:103], v85 offset:9728
  s_waitcnt lgkmcnt(0)
  s_add_u32 s20, s35, 1638400
  s_add_u32 s21, s34, 8192
  s_mov_b32 m0, s21
  s_nop 0
  buffer_load_dwordx4 v80, s[8:11], s20 offen lds
  s_waitcnt vmcnt(14)
  ds_read_b64_tr_b16 a[104:105], v85 offset:10240
  ds_read_b64_tr_b16 a[106:107], v85 offset:10752
  s_waitcnt lgkmcnt(0)
  s_add_u32 s20, s35, 1679360
  s_add_u32 s21, s34, 9216
  s_mov_b32 m0, s21
  s_nop 0
  buffer_load_dwordx4 v80, s[8:11], s20 offen lds
  s_waitcnt vmcnt(14)
  ds_read_b64_tr_b16 a[108:109], v85 offset:11264
  ds_read_b64_tr_b16 a[110:111], v85 offset:11776
  s_waitcnt lgkmcnt(0)
  s_add_u32 s20, s35, 1720320
  s_add_u32 s21, s34, 10240
  s_mov_b32 m0, s21
  s_nop 0
  buffer_load_dwordx4 v80, s[8:11], s20 offen lds
  s_waitcnt vmcnt(14)
  ds_read_b64_tr_b16 a[112:113], v85 offset:12288
  ds_read_b64_tr_b16 a[114:115], v85 offset:12800
  s_waitcnt lgkmcnt(0)
  s_add_u32 s20, s35, 1761280
  s_add_u32 s21, s34, 11264
  s_mov_b32 m0, s21
  s_nop 0
  buffer_load_dwordx4 v80, s[8:11], s20 offen lds
  s_waitcnt vmcnt(14)
  ds_read_b64_tr_b16 a[116:117], v85 offset:13312
  ds_read_b64_tr_b16 a[118:119], v85 offset:13824
  s_waitcnt lgkmcnt(0)
  s_add_u32 s20, s35, 1802240
  s_add_u32 s21, s34, 12288
  s_mov_b32 m0, s21
  s_nop 0
  buffer_load_dwordx4 v80, s[8:11], s20 offen lds
  s_waitcnt vmcnt(14)
  ds_read_b64_tr_b16 a[120:121], v85 offset:14336
  ds_read_b64_tr_b16 a[122:123], v85 offset:14848
  s_waitcnt lgkmcnt(0)
  s_add_u32 s20, s35, 1843200
  s_add_u32 s21, s34, 13312
  s_mov_b32 m0, s21
  s_nop 0
  buffer_load_dwordx4 v80, s[8:11], s20 offen lds
  s_waitcnt vmcnt(14)
  ds_read_b64_tr_b16 a[124:125], v85 offset:15360
  ds_read_b64_tr_b16 a[126:127], v85 offset:15872
  s_waitcnt lgkmcnt(0)
  s_add_u32 s20, s35, 1884160
  s_add_u32 s21, s34, 14336
  s_mov_b32 m0, s21
  s_nop 0
  buffer_load_dwordx4 v80, s[8:11], s20 offen lds
  s_waitcnt vmcnt(14)
  ds_read_b64_tr_b16 a[128:129], v85 offset:0
  ds_read_b64_tr_b16 a[130:131], v85 offset:512
  s_waitcnt lgkmcnt(0)
  s_add_u32 s20, s35, 1925120
  s_add_u32 s21, s34, 15360
  s_mov_b32 m0, s21
  s_nop 0
  buffer_load_dwordx4 v80, s[8:11], s20 offen lds
  s_waitcnt vmcnt(14)
  ds_read_b64_tr_b16 a[132:133], v85 offset:1024
  ds_read_b64_tr_b16 a[134:135], v85 offset:1536
  s_waitcnt lgkmcnt(0)
  s_waitcnt vmcnt(13)
  ds_read_b64_tr_b16 a[136:137], v85 offset:2048
  ds_read_b64_tr_b16 a[138:139], v85 offset:2560
  s_waitcnt lgkmcnt(0)
  s_waitcnt vmcnt(12)
  ds_read_b64_tr_b16 a[140:141], v85 offset:3072
  ds_read_b64_tr_b16 a[142:143], v85 offset:3584
  s_waitcnt lgkmcnt(0)
  s_waitcnt vmcnt(11)
  ds_read_b64_tr_b16 a[144:145], v85 offset:4096
  ds_read_b64_tr_b16 a[146:147], v85 offset:4608
  s_waitcnt lgkmcnt(0)
  s_waitcnt vmcnt(10)
  ds_read_b64_tr_b16 a[148:149], v85 offset:5120
  ds_read_b64_tr_b16 a[150:151], v85 offset:5632
  s_waitcnt lgkmcnt(0)
  s_waitcnt vmcnt(9)
  ds_read_b64_tr_b16 a[152:153], v85 offset:6144
  ds_read_b64_tr_b16 a[154:155], v85 offset:6656
  s_waitcnt lgkmcnt(0)
  s_waitcnt vmcnt(8)
  ds_read_b64_tr_b16 a[156:157], v85 offset:7168
  ds_read_b64_tr_b16 a[158:159], v85 offset:7680
  s_waitcnt lgkmcnt(0)
  s_waitcnt vmcnt(7)
  ds_read_b64_tr_b16 a[160:161], v85 offset:8192
  ds_read_b64_tr_b16 a[162:163], v85 offset:8704
  s_waitcnt lgkmcnt(0)
  s_waitcnt vmcnt(6)
  ds_read_b64_tr_b16 a[164:165], v85 offset:9216
  ds_read_b64_tr_b16 a[166:167], v85 offset:9728
  s_waitcnt lgkmcnt(0)
  s_waitcnt vmcnt(5)
  ds_read_b64_tr_b16 a[168:169], v85 offset:10240
  ds_read_b64_tr_b16 a[170:171], v85 offset:10752
  s_waitcnt lgkmcnt(0)
  s_waitcnt vmcnt(4)
  ds_read_b64_tr_b16 a[172:173], v85 offset:11264
  ds_read_b64_tr_b16 a[174:175], v85 offset:11776
  s_waitcnt lgkmcnt(0)
  s_waitcnt vmcnt(3)
  ds_read_b64_tr_b16 a[176:177], v85 offset:12288
  ds_read_b64_tr_b16 a[178:179], v85 offset:12800
  s_waitcnt lgkmcnt(0)
  s_waitcnt vmcnt(2)
  ds_read_b64_tr_b16 a[180:181], v85 offset:13312
  ds_read_b64_tr_b16 a[182:183], v85 offset:13824
  s_waitcnt lgkmcnt(0)
  s_waitcnt vmcnt(1)
  ds_read_b64_tr_b16 a[184:185], v85 offset:14336
  ds_read_b64_tr_b16 a[186:187], v85 offset:14848
  s_waitcnt lgkmcnt(0)
  s_waitcnt vmcnt(0)
  ds_read_b64_tr_b16 a[188:189], v85 offset:15360
  ds_read_b64_tr_b16 a[190:191], v85 offset:15872
  s_waitcnt lgkmcnt(0)
  s_waitcnt lgkmcnt(0)
  s_barrier
  v_lshrrev_b32 v9, 4, v1
  v_lshlrev_b32 v9, 3, v9
  v_add_u32 v9, s35, v9
  v_and_b32 v11, 15, v1
  v_mul_u32_u24 v11, 1280, v11
  v_add_u32 v11, v11, v9
  s_mov_b32 s20, 71936
  buffer_load_dwordx2 v[30:31], v9, s[4:7], s20 offen sc1
  s_waitcnt vmcnt(0)
  v_lshlrev_b32 v24, 16, v30
  v_and_b32 v25, 0xffff0000, v30
  v_lshlrev_b32 v26, 16, v31
  v_and_b32 v27, 0xffff0000, v31
  s_mul_i32 s36, s16, 24576
  s_mov_b32 s18, s45
LF2_163:
  s_add_u32 s23, s18, 1
  s_cmp_lg_u32 s16, 0
  s_cbranch_scc1 Lw0_164
  s_mov_b32 s22, 22016
Lwf_165:
  buffer_load_dword v7, v0, s[4:7], s22 offen sc1
  s_waitcnt vmcnt(0)
  v_cmp_gt_u32 vcc, s23, v7
  s_cbranch_vccz Lwfd_166
  s_sleep 1
  s_cmp_eq_u32 s19, 0
  s_cbranch_scc1 Lwfd_166
  s_sub_u32 s19, s19, 1
  s_branch Lwf_165
Lwfd_166:
Lw0_164:
  s_barrier
  s_mul_i32 s26, s18, 98304
  s_add_u32 s26, s26, 150994944
  s_and_b32 s20, s16, 1
  s_mul_i32 s20, s20, 49152
  s_lshr_b32 s21, s16, 1
  s_mul_i32 s21, s21, 24576
  s_add_u32 s36, s20, s21
  s_add_u32 s26, s26, s36
  s_add_u32 s20, s36, 0
  s_mov_b32 m0, s20
  s_add_u32 s21, s26, 0
  buffer_load_dwordx4 v2, s[4:7], s21 offen sc1 lds
  s_add_u32 s20, s36, 1024
  s_mov_b32 m0, s20
  s_add_u32 s21, s26, 1024
  buffer_load_dwordx4 v2, s[4:7], s21 offen sc1 lds
  s_add_u32 s20, s36, 2048
  s_mov_b32 m0, s20
  s_add_u32 s21, s26, 2048
  buffer_load_dwordx4 v2, s[4:7], s21 offen sc1 lds
  s_add_u32 s20, s36, 3072
  s_mov_b32 m0, s20
  s_add_u32 s21, s26, 3072
  buffer_load_dwordx4 v2, s[4:7], s21 offen sc1 lds
  s_add_u32 s20, s36, 4096
  s_mov_b32 m0, s20
  s_add_u32 s21, s26, 4096
  buffer_load_dwordx4 v2, s[4:7], s21 offen sc1 lds
  s_add_u32 s20, s36, 5120
  s_mov_b32 m0, s20
  s_add_u32 s21, s26, 5120
  buffer_load_dwordx4 v2, s[4:7], s21 offen sc1 lds
  s_add_u32 s20, s36, 6144
  s_mov_b32 m0, s20
  s_add_u32 s21, s26, 6144
  buffer_load_dwordx4 v2, s[4:7], s21 offen sc1 lds
  s_add_u32 s20, s36, 7168
  s_mov_b32 m0, s20
  s_add_u32 s21, s26, 7168
  buffer_load_dwordx4 v2, s[4:7], s21 offen sc1 lds
  s_add_u32 s20, s36, 8192
  s_mov_b32 m0, s20
  s_add_u32 s21, s26, 8192
  buffer_load_dwordx4 v2, s[4:7], s21 offen sc1 lds
  s_add_u32 s20, s36, 9216
  s_mov_b32 m0, s20
  s_add_u32 s21, s26, 9216
  buffer_load_dwordx4 v2, s[4:7], s21 offen sc1 lds
  s_add_u32 s20, s36, 10240
  s_mov_b32 m0, s20
  s_add_u32 s21, s26, 10240
  buffer_load_dwordx4 v2, s[4:7], s21 offen sc1 lds
  s_add_u32 s20, s36, 11264
  s_mov_b32 m0, s20
  s_add_u32 s21, s26, 11264
  buffer_load_dwordx4 v2, s[4:7], s21 offen sc1 lds
  s_add_u32 s20, s36, 12288
  s_mov_b32 m0, s20
  s_add_u32 s21, s26, 12288
  buffer_load_dwordx4 v2, s[4:7], s21 offen sc1 lds
  s_add_u32 s20, s36, 13312
  s_mov_b32 m0, s20
  s_add_u32 s21, s26, 13312
  buffer_load_dwordx4 v2, s[4:7], s21 offen sc1 lds
  s_add_u32 s20, s36, 14336
  s_mov_b32 m0, s20
  s_add_u32 s21, s26, 14336
  buffer_load_dwordx4 v2, s[4:7], s21 offen sc1 lds
  s_add_u32 s20, s36, 15360
  s_mov_b32 m0, s20
  s_add_u32 s21, s26, 15360
  buffer_load_dwordx4 v2, s[4:7], s21 offen sc1 lds
  s_add_u32 s20, s36, 16384
  s_mov_b32 m0, s20
  s_add_u32 s21, s26, 16384
  buffer_load_dwordx4 v2, s[4:7], s21 offen sc1 lds
  s_add_u32 s20, s36, 17408
  s_mov_b32 m0, s20
  s_add_u32 s21, s26, 17408
  buffer_load_dwordx4 v2, s[4:7], s21 offen sc1 lds
  s_add_u32 s20, s36, 18432
  s_mov_b32 m0, s20
  s_add_u32 s21, s26, 18432
  buffer_load_dwordx4 v2, s[4:7], s21 offen sc1 lds
  s_add_u32 s20, s36, 19456
  s_mov_b32 m0, s20
  s_add_u32 s21, s26, 19456
  buffer_load_dwordx4 v2, s[4:7], s21 offen sc1 lds
  s_add_u32 s20, s36, 20480
  s_mov_b32 m0, s20
  s_add_u32 s21, s26, 20480
  buffer_load_dwordx4 v2, s[4:7], s21 offen sc1 lds
  s_add_u32 s20, s36, 21504
  s_mov_b32 m0, s20
  s_add_u32 s21, s26, 21504
  buffer_load_dwordx4 v2, s[4:7], s21 offen sc1 lds
  s_add_u32 s20, s36, 22528
  s_mov_b32 m0, s20
  s_add_u32 s21, s26, 22528
  buffer_load_dwordx4 v2, s[4:7], s21 offen sc1 lds
  s_add_u32 s20, s36, 23552
  s_mov_b32 m0, s20
  s_add_u32 s21, s26, 23552
  buffer_load_dwordx4 v2, s[4:7], s21 offen sc1 lds
  s_mul_i32 s30, s18, 40960
  s_add_u32 s21, s30, 148373504
  buffer_load_dwordx2 v[64:65], v11, s[4:7], s21 offen sc1
  s_add_u32 s21, s21, 20480
  buffer_load_dwordx2 v[66:67], v11, s[4:7], s21 offen sc1
  s_waitcnt vmcnt(0)
  s_barrier
  v_mov_b32 v12, v2
  v_add_u32 v13, 49152, v2
  ds_read_b128 v[32:35], v12 offset:0
  ds_read_b128 v[36:39], v13 offset:0
  ds_read_b128 v[40:43], v12 offset:1024
  ds_read_b128 v[44:47], v13 offset:1024
  ds_read_b128 v[48:51], v12 offset:2048
  ds_read_b128 v[52:55], v13 offset:2048
  ds_read_b128 v[56:59], v12 offset:3072
  ds_read_b128 v[60:63], v13 offset:3072
  s_waitcnt lgkmcnt(6)
  v_mfma_f32_16x16x32_bf16 v[16:19], a[0:3], v[32:35], 0
  v_mfma_f32_16x16x32_bf16 v[20:23], a[0:3], v[36:39], 0
  ds_read_b128 v[32:35], v12 offset:4096
  ds_read_b128 v[36:39], v13 offset:4096
  s_waitcnt lgkmcnt(6)
  v_mfma_f32_16x16x32_bf16 v[16:19], a[4:7], v[40:43], v[16:19]
  v_mfma_f32_16x16x32_bf16 v[20:23], a[4:7], v[44:47], v[20:23]
  ds_read_b128 v[40:43], v12 offset:5120
  ds_read_b128 v[44:47], v13 offset:5120
  s_waitcnt lgkmcnt(6)
  v_mfma_f32_16x16x32_bf16 v[16:19], a[8:11], v[48:51], v[16:19]
  v_mfma_f32_16x16x32_bf16 v[20:23], a[8:11], v[52:55], v[20:23]
  ds_read_b128 v[48:51], v12 offset:6144
  ds_read_b128 v[52:55], v13 offset:6144
  s_waitcnt lgkmcnt(6)
  v_mfma_f32_16x16x32_bf16 v[16:19], a[12:15], v[56:59], v[16:19]
  v_mfma_f32_16x16x32_bf16 v[20:23], a[12:15], v[60:63], v[20:23]
  ds_read_b128 v[56:59], v12 offset:7168
  ds_read_b128 v[60:63], v13 offset:7168
  s_waitcnt lgkmcnt(6)
  v_mfma_f32_16x16x32_bf16 v[16:19], a[16:19], v[32:35], v[16:19]
  v_mfma_f32_16x16x32_bf16 v[20:23], a[16:19], v[36:39], v[20:23]
  ds_read_b128 v[32:35], v12 offset:8192
  ds_read_b128 v[36:39], v13 offset:8192
  s_waitcnt lgkmcnt(6)
  v_mfma_f32_16x16x32_bf16 v[16:19], a[20:23], v[40:43], v[16:19]
  v_mfma_f32_16x16x32_bf16 v[20:23], a[20:23], v[44:47], v[20:23]
  ds_read_b128 v[40:43], v12 offset:9216
  ds_read_b128 v[44:47], v13 offset:9216
  s_waitcnt lgkmcnt(6)
  v_mfma_f32_16x16x32_bf16 v[16:19], a[24:27], v[48:51], v[16:19]
  v_mfma_f32_16x16x32_bf16 v[20:23], a[24:27], v[52:55], v[20:23]
  ds_read_b128 v[48:51], v12 offset:10240
  ds_read_b128 v[52:55], v13 offset:10240
  s_waitcnt lgkmcnt(6)
  v_mfma_f32_16x16x32_bf16 v[16:19], a[28:31], v[56:59], v[16:19]
  v_mfma_f32_16x16x32_bf16 v[20:23], a[28:31], v[60:63], v[20:23]
  ds_read_b128 v[56:59], v12 offset:11264
  ds_read_b128 v[60:63], v13 offset:11264
  s_waitcnt lgkmcnt(6)
  v_mfma_f32_16x16x32_bf16 v[16:19], a[32:35], v[32:35], v[16:19]
  v_mfma_f32_16x16x32_bf16 v[20:23], a[32:35], v[36:39], v[20:23]
  ds_read_b128 v[32:35], v12 offset:12288
  ds_read_b128 v[36:39], v13 offset:12288
  s_waitcnt lgkmcnt(6)
  v_mfma_f32_16x16x32_bf16 v[16:19], a[36:39], v[40:43], v[16:19]
  v_mfma_f32_16x16x32_bf16 v[20:23], a[36:39], v[44:47], v[20:23]
  ds_read_b128 v[40:43], v12 offset:13312
  ds_read_b128 v[44:47], v13 offset:13312
  s_waitcnt lgkmcnt(6)
  v_mfma_f32_16x16x32_bf16 v[16:19], a[40:43], v[48:51], v[16:19]
  v_mfma_f32_16x16x32_bf16 v[20:23], a[40:43], v[52:55], v[20:23]
  ds_read_b128 v[48:51], v12 offset:14336
  ds_read_b128 v[52:55], v13 offset:14336
  s_waitcnt lgkmcnt(6)
  v_mfma_f32_16x16x32_bf16 v[16:19], a[44:47], v[56:59], v[16:19]
  v_mfma_f32_16x16x32_bf16 v[20:23], a[44:47], v[60:63], v[20:23]
  ds_read_b128 v[56:59], v12 offset:15360
  ds_read_b128 v[60:63], v13 offset:15360
  s_waitcnt lgkmcnt(6)
  v_mfma_f32_16x16x32_bf16 v[16:19], a[48:51], v[32:35], v[16:19]
  v_mfma_f32_16x16x32_bf16 v[20:23], a[48:51], v[36:39], v[20:23]
  ds_read_b128 v[32:35], v12 offset:16384
  ds_read_b128 v[36:39], v13 offset:16384
  s_waitcnt lgkmcnt(6)
  v_mfma_f32_16x16x32_bf16 v[16:19], a[52:55], v[40:43], v[16:19]
  v_mfma_f32_16x16x32_bf16 v[20:23], a[52:55], v[44:47], v[20:23]
  ds_read_b128 v[40:43], v12 offset:17408
  ds_read_b128 v[44:47], v13 offset:17408
  s_waitcnt lgkmcnt(6)
  v_mfma_f32_16x16x32_bf16 v[16:19], a[56:59], v[48:51], v[16:19]
  v_mfma_f32_16x16x32_bf16 v[20:23], a[56:59], v[52:55], v[20:23]
  ds_read_b128 v[48:51], v12 offset:18432
  ds_read_b128 v[52:55], v13 offset:18432
  s_waitcnt lgkmcnt(6)
  v_mfma_f32_16x16x32_bf16 v[16:19], a[60:63], v[56:59], v[16:19]
  v_mfma_f32_16x16x32_bf16 v[20:23], a[60:63], v[60:63], v[20:23]
  ds_read_b128 v[56:59], v12 offset:19456
  ds_read_b128 v[60:63], v13 offset:19456
  s_waitcnt lgkmcnt(6)
  v_mfma_f32_16x16x32_bf16 v[16:19], a[64:67], v[32:35], v[16:19]
  v_mfma_f32_16x16x32_bf16 v[20:23], a[64:67], v[36:39], v[20:23]
  ds_read_b128 v[32:35], v12 offset:20480
  ds_read_b128 v[36:39], v13 offset:20480
  s_waitcnt lgkmcnt(6)
  v_mfma_f32_16x16x32_bf16 v[16:19], a[68:71], v[40:43], v[16:19]
  v_mfma_f32_16x16x32_bf16 v[20:23], a[68:71], v[44:47], v[20:23]
  ds_read_b128 v[40:43], v12 offset:21504
  ds_read_b128 v[44:47], v13 offset:21504
  s_waitcnt lgkmcnt(6)
  v_mfma_f32_16x16x32_bf16 v[16:19], a[72:75], v[48:51], v[16:19]
  v_mfma_f32_16x16x32_bf16 v[20:23], a[72:75], v[52:55], v[20:23]
  ds_read_b128 v[48:51], v12 offset:22528
  ds_read_b128 v[52:55], v13 offset:22528
  s_waitcnt lgkmcnt(6)
  v_mfma_f32_16x16x32_bf16 v[16:19], a[76:79], v[56:59], v[16:19]
  v_mfma_f32_16x16x32_bf16 v[20:23], a[76:79], v[60:63], v[20:23]
  ds_read_b128 v[56:59], v12 offset:23552
  ds_read_b128 v[60:63], v13 offset:23552
  s_waitcnt lgkmcnt(6)
  v_mfma_f32_16x16x32_bf16 v[16:19], a[80:83], v[32:35], v[16:19]
  v_mfma_f32_16x16x32_bf16 v[20:23], a[80:83], v[36:39], v[20:23]
  ds_read_b128 v[32:35], v12 offset:24576
  ds_read_b128 v[36:39], v13 offset:24576
  s_waitcnt lgkmcnt(6)
  v_mfma_f32_16x16x32_bf16 v[16:19], a[84:87], v[40:43], v[16:19]
  v_mfma_f32_16x16x32_bf16 v[20:23], a[84:87], v[44:47], v[20:23]
  ds_read_b128 v[40:43], v12 offset:25600
  ds_read_b128 v[44:47], v13 offset:25600
  s_waitcnt lgkmcnt(6)
  v_mfma_f32_16x16x32_bf16 v[16:19], a[88:91], v[48:51], v[16:19]
  v_mfma_f32_16x16x32_bf16 v[20:23], a[88:91], v[52:55], v[20:23]
  ds_read_b128 v[48:51], v12 offset:26624
  ds_read_b128 v[52:55], v13 offset:26624
  s_waitcnt lgkmcnt(6)
  v_mfma_f32_16x16x32_bf16 v[16:19], a[92:95], v[56:59], v[16:19]
  v_mfma_f32_16x16x32_bf16 v[20:23], a[92:95], v[60:63], v[20:23]
  ds_read_b128 v[56:59], v12 offset:27648
  ds_read_b128 v[60:63], v13 offset:27648
  s_waitcnt lgkmcnt(6)
  v_mfma_f32_16x16x32_bf16 v[16:19], a[96:99], v[32:35], v[16:19]
  v_mfma_f32_16x16x32_bf16 v[20:23], a[96:99], v[36:39], v[20:23]
  ds_read_b128 v[32:35], v12 offset:28672
  ds_read_b128 v[36:39], v13 offset:28672
  s_waitcnt lgkmcnt(6)
  v_mfma_f32_16x16x32_bf16 v[16:19], a[100:103], v[40:43], v[16:19]
  v_mfma_f32_16x16x32_bf16 v[20:23], a[100:103], v[44:47], v[20:23]
  ds_read_b128 v[40:43], v12 offset:29696
  ds_read_b128 v[44:47], v13 offset:29696
  s_waitcnt lgkmcnt(6)
  v_mfma_f32_16x16x32_bf16 v[16:19], a[104:107], v[48:51], v[16:19]
  v_mfma_f32_16x16x32_bf16 v[20:23], a[104:107], v[52:55], v[20:23]
  ds_read_b128 v[48:51], v12 offset:30720
  ds_read_b128 v[52:55], v13 offset:30720
  s_waitcnt lgkmcnt(6)
  v_mfma_f32_16x16x32_bf16 v[16:19], a[108:111], v[56:59], v[16:19]
  v_mfma_f32_16x16x32_bf16 v[20:23], a[108:111], v[60:63], v[20:23]
  ds_read_b128 v[56:59], v12 offset:31744
  ds_read_b128 v[60:63], v13 offset:31744
  s_waitcnt lgkmcnt(6)
  v_mfma_f32_16x16x32_bf16 v[16:19], a[112:115], v[32:35], v[16:19]
  v_mfma_f32_16x16x32_bf16 v[20:23], a[112:115], v[36:39], v[20:23]
  ds_read_b128 v[32:35], v12 offset:32768
  ds_read_b128 v[36:39], v13 offset:32768
  s_waitcnt lgkmcnt(6)
  v_mfma_f32_16x16x32_bf16 v[16:19], a[116:119], v[40:43], v[16:19]
  v_mfma_f32_16x16x32_bf16 v[20:23], a[116:119], v[44:47], v[20:23]
  ds_read_b128 v[40:43], v12 offset:33792
  ds_read_b128 v[44:47], v13 offset:33792
  s_waitcnt lgkmcnt(6)
  v_mfma_f32_16x16x32_bf16 v[16:19], a[120:123], v[48:51], v[16:19]
  v_mfma_f32_16x16x32_bf16 v[20:23], a[120:123], v[52:55], v[20:23]
  ds_read_b128 v[48:51], v12 offset:34816
  ds_read_b128 v[52:55], v13 offset:34816
  s_waitcnt lgkmcnt(6)
  v_mfma_f32_16x16x32_bf16 v[16:19], a[124:127], v[56:59], v[16:19]
  v_mfma_f32_16x16x32_bf16 v[20:23], a[124:127], v[60:63], v[20:23]
  ds_read_b128 v[56:59], v12 offset:35840
  ds_read_b128 v[60:63], v13 offset:35840
  s_waitcnt lgkmcnt(6)
  v_mfma_f32_16x16x32_bf16 v[16:19], a[128:131], v[32:35], v[16:19]
  v_mfma_f32_16x16x32_bf16 v[20:23], a[128:131], v[36:39], v[20:23]
  ds_read_b128 v[32:35], v12 offset:36864
  ds_read_b128 v[36:39], v13 offset:36864
  s_waitcnt lgkmcnt(6)
  v_mfma_f32_16x16x32_bf16 v[16:19], a[132:135], v[40:43], v[16:19]
  v_mfma_f32_16x16x32_bf16 v[20:23], a[132:135], v[44:47], v[20:23]
  ds_read_b128 v[40:43], v12 offset:37888
  ds_read_b128 v[44:47], v13 offset:37888
  s_waitcnt lgkmcnt(6)
  v_mfma_f32_16x16x32_bf16 v[16:19], a[136:139], v[48:51], v[16:19]
  v_mfma_f32_16x16x32_bf16 v[20:23], a[136:139], v[52:55], v[20:23]
  ds_read_b128 v[48:51], v12 offset:38912
  ds_read_b128 v[52:55], v13 offset:38912
  s_waitcnt lgkmcnt(6)
  v_mfma_f32_16x16x32_bf16 v[16:19], a[140:143], v[56:59], v[16:19]
  v_mfma_f32_16x16x32_bf16 v[20:23], a[140:143], v[60:63], v[20:23]
  ds_read_b128 v[56:59], v12 offset:39936
  ds_read_b128 v[60:63], v13 offset:39936
  s_waitcnt lgkmcnt(6)
  v_mfma_f32_16x16x32_bf16 v[16:19], a[144:147], v[32:35], v[16:19]
  v_mfma_f32_16x16x32_bf16 v[20:23], a[144:147], v[36:39], v[20:23]
  ds_read_b128 v[32:35], v12 offset:40960
  ds_read_b128 v[36:39], v13 offset:40960
  s_waitcnt lgkmcnt(6)
  v_mfma_f32_16x16x32_bf16 v[16:19], a[148:151], v[40:43], v[16:19]
  v_mfma_f32_16x16x32_bf16 v[20:23], a[148:151], v[44:47], v[20:23]
  ds_read_b128 v[40:43], v12 offset:41984
  ds_read_b128 v[44:47], v13 offset:41984
  s_waitcnt lgkmcnt(6)
  v_mfma_f32_16x16x32_bf16 v[16:19], a[152:155], v[48:51], v[16:19]
  v_mfma_f32_16x16x32_bf16 v[20:23], a[152:155], v[52:55], v[20:23]
  ds_read_b128 v[48:51], v12 offset:43008
  ds_read_b128 v[52:55], v13 offset:43008
  s_waitcnt lgkmcnt(6)
  v_mfma_f32_16x16x32_bf16 v[16:19], a[156:159], v[56:59], v[16:19]
  v_mfma_f32_16x16x32_bf16 v[20:23], a[156:159], v[60:63], v[20:23]
  ds_read_b128 v[56:59], v12 offset:44032
  ds_read_b128 v[60:63], v13 offset:44032
  s_waitcnt lgkmcnt(6)
  v_mfma_f32_16x16x32_bf16 v[16:19], a[160:163], v[32:35], v[16:19]
  v_mfma_f32_16x16x32_bf16 v[20:23], a[160:163], v[36:39], v[20:23]
  ds_read_b128 v[32:35], v12 offset:45056
  ds_read_b128 v[36:39], v13 offset:45056
  s_waitcnt lgkmcnt(6)
  v_mfma_f32_16x16x32_bf16 v[16:19], a[164:167], v[40:43], v[16:19]
  v_mfma_f32_16x16x32_bf16 v[20:23], a[164:167], v[44:47], v[20:23]
  ds_read_b128 v[40:43], v12 offset:46080
  ds_read_b128 v[44:47], v13 offset:46080
  s_waitcnt lgkmcnt(6)
  v_mfma_f32_16x16x32_bf16 v[16:19], a[168:171], v[48:51], v[16:19]
  v_mfma_f32_16x16x32_bf16 v[20:23], a[168:171], v[52:55], v[20:23]
  ds_read_b128 v[48:51], v12 offset:47104
  ds_read_b128 v[52:55], v13 offset:47104
  s_waitcnt lgkmcnt(6)
  v_mfma_f32_16x16x32_bf16 v[16:19], a[172:175], v[56:59], v[16:19]
  v_mfma_f32_16x16x32_bf16 v[20:23], a[172:175], v[60:63], v[20:23]
  ds_read_b128 v[56:59], v12 offset:48128
  ds_read_b128 v[60:63], v13 offset:48128
  s_waitcnt lgkmcnt(6)
  v_mfma_f32_16x16x32_bf16 v[16:19], a[176:179], v[32:35], v[16:19]
  v_mfma_f32_16x16x32_bf16 v[20:23], a[176:179], v[36:39], v[20:23]
  s_waitcnt lgkmcnt(4)
  v_mfma_f32_16x16x32_bf16 v[16:19], a[180:183], v[40:43], v[16:19]
  v_mfma_f32_16x16x32_bf16 v[20:23], a[180:183], v[44:47], v[20:23]
  s_waitcnt lgkmcnt(2)
  v_mfma_f32_16x16x32_bf16 v[16:19], a[184:187], v[48:51], v[16:19]
  v_mfma_f32_16x16x32_bf16 v[20:23], a[184:187], v[52:55], v[20:23]
  s_waitcnt lgkmcnt(0)
  v_mfma_f32_16x16x32_bf16 v[16:19], a[188:191], v[56:59], v[16:19]
  v_mfma_f32_16x16x32_bf16 v[20:23], a[188:191], v[60:63], v[20:23]
  v_lshlrev_b32 v68, 16, v64
  v_and_b32 v69, 0xffff0000, v64
  v_lshlrev_b32 v70, 16, v65
  v_and_b32 v71, 0xffff0000, v65
  s_nop 0
  v_fmac_f32 v68, v24, v16
  v_fmac_f32 v69, v25, v17
  v_fmac_f32 v70, v26, v18
  v_fmac_f32 v71, v27, v19
  v_cvt_pk_bf16_f32 v64, v68, v69
  v_cvt_pk_bf16_f32 v65, v70, v71
  buffer_store_dwordx2 v[64:65], v11, s[12:15], s30 offen
  v_lshlrev_b32 v68, 16, v66
  v_and_b32 v69, 0xffff0000, v66
  v_lshlrev_b32 v70, 16, v67
  v_and_b32 v71, 0xffff0000, v67
  v_fmac_f32 v68, v24, v20
  v_fmac_f32 v69, v25, v21
  v_fmac_f32 v70, v26, v22
  v_fmac_f32 v71, v27, v23
  v_cvt_pk_bf16_f32 v66, v68, v69
  v_cvt_pk_bf16_f32 v67, v70, v71
  s_add_u32 s30, s30, 20480
  buffer_store_dwordx2 v[66:67], v11, s[12:15], s30 offen
  s_add_u32 s18, s18, 2
  s_cmp_lt_u32 s18, s31
  s_cbranch_scc1 LF2_163
  s_branch L_end
L_goL2:
  v_lshrrev_b32 v3, 6, v0
  v_and_b32 v1, 63, v0
  v_readfirstlane_b32 s16, v3
  v_lshlrev_b32 v2, 4, v1
  s_mov_b32 s19, 400000
  s_and_b32 s27, s17, 1
  s_lshr_b32 s45, s17, 1
  v_mov_b32 v8, 0
  v_mov_b32 v9, 0x7ff00000
  v_cmp_eq_u32 vcc, 0, v0
  s_nop 1
  v_cndmask_b32 v8, v9, v8, vcc
  s_lshl_b32 s20, s17, 7
  s_add_u32 s44, s20, 21504
  v_min_u32 v0, 39, v1
  v_lshlrev_b32 v0, 7, v0
  s_mov_b32 s52, s32
  s_mov_b32 s53, s33
  s_mov_b32 s54, 256
  s_mov_b32 s55, 0x00020000
  s_cmp_lg_u32 s16, 0
  s_cbranch_scc1 Lwr_167
  v_lshrrev_b32 v16, 4, v2
  v_lshlrev_b32 v16, 7, v16
  v_mov_b32 v17, 196
  s_mov_b32 s51, 106496
  s_mov_b32 s50, 114688
Lwrt_168:
  buffer_load_dword v18, v16, s[4:7], s51 offen sc1
  buffer_load_dword v19, v16, s[4:7], s50 offen sc1
  buffer_load_dword v20, v17, s[52:55], 0 offen sc1
  s_waitcnt vmcnt(0)
  v_cmp_ne_u32 vcc, s70, v18
  s_cbranch_vccnz Lwra_170
  v_cmp_ne_u32 vcc, s70, v19
  s_cbranch_vccnz Lwra_170
  v_cmp_eq_u32 vcc, 0, v20
  s_cbranch_vccnz Lwra_170
  s_branch Lwrd_169
Lwra_170:
  s_sleep 2
  s_cmp_eq_u32 s19, 0
  s_cbranch_scc1 Lwrd_169
  s_sub_u32 s19, s19, 1
  s_branch Lwrt_168
Lwrd_169:
  v_mov_b32 v16, 0
  ds_write_b32 v16, v20 offset:2048
  s_waitcnt lgkmcnt(0)
Lwr_167:
  s_barrier
  v_mov_b32 v16, 0
  ds_read_b32 v17, v16 offset:2048
  s_waitcnt lgkmcnt(0)
  v_readfirstlane_b32 s50, v17
  s_barrier
  s_nop 2
  s_and_b32 s51, s50, 1
  s_lshl_b32 s51, s51, 13
  s_add_u32 s43, s43, s51
  s_and_b32 s51, s50, 2
  s_lshl_b32 s51, s51, 12
  s_add_u32 s39, s39, s51
  v_and_b32 v4, 15, v1
  v_mul_u32_u24 v4, 1280, v4
  v_lshrrev_b32 v5, 4, v1
  v_lshlrev_b32 v5, 4, v5
  s_mul_i32 s20, s16, 320
  v_add_u32 v5, s20, v5
  v_add_u32 v4, v4, v5
  v_and_b32 v6, 15, v1
  v_lshlrev_b32 v6, 2, v6
  s_mov_b32 s20, 70656
  buffer_load_dwordx4 v[36:39], v5, s[4:7], s20 offen offset:0 sc1
  buffer_load_dwordx4 v[40:43], v5, s[4:7], s20 offen offset:64 sc1
  buffer_load_dwordx4 v[44:47], v5, s[4:7], s20 offen offset:128 sc1
  buffer_load_dwordx4 v[48:51], v5, s[4:7], s20 offen offset:192 sc1
  buffer_load_dwordx4 v[52:55], v5, s[4:7], s20 offen offset:256 sc1
  s_mov_b32 s20, 69376
  buffer_load_dwordx4 v[56:59], v5, s[4:7], s20 offen offset:0 sc1
  buffer_load_dwordx4 v[60:63], v5, s[4:7], s20 offen offset:64 sc1
  buffer_load_dwordx4 v[64:67], v5, s[4:7], s20 offen offset:128 sc1
  buffer_load_dwordx4 v[68:71], v5, s[4:7], s20 offen offset:192 sc1
  buffer_load_dwordx4 v[72:75], v5, s[4:7], s20 offen offset:256 sc1
  s_waitcnt vmcnt(0)
  v_lshlrev_b32 v76, 16, v36
  v_and_b32 v77, 0xffff0000, v36
  v_lshlrev_b32 v78, 16, v37
  v_and_b32 v79, 0xffff0000, v37
  v_lshlrev_b32 v80, 16, v38
  v_and_b32 v81, 0xffff0000, v38
  v_lshlrev_b32 v82, 16, v39
  v_and_b32 v83, 0xffff0000, v39
  v_lshlrev_b32 v84, 16, v40
  v_and_b32 v85, 0xffff0000, v40
  v_lshlrev_b32 v86, 16, v41
  v_and_b32 v87, 0xffff0000, v41
  v_lshlrev_b32 v88, 16, v42
  v_and_b32 v89, 0xffff0000, v42
  v_lshlrev_b32 v90, 16, v43
  v_and_b32 v91, 0xffff0000, v43
  v_lshlrev_b32 v92, 16, v44
  v_and_b32 v93, 0xffff0000, v44
  v_lshlrev_b32 v94, 16, v45
  v_and_b32 v95, 0xffff0000, v45
  v_lshlrev_b32 v96, 16, v46
  v_and_b32 v97, 0xffff0000, v46
  v_lshlrev_b32 v98, 16, v47
  v_and_b32 v99, 0xffff0000, v47
  v_lshlrev_b32 v100, 16, v48
  v_and_b32 v101, 0xffff0000, v48
  v_lshlrev_b32 v102, 16, v49
  v_and_b32 v103, 0xffff0000, v49
  v_lshlrev_b32 v104, 16, v50
  v_and_b32 v105, 0xffff0000, v50
  v_lshlrev_b32 v106, 16, v51
  v_and_b32 v107, 0xffff0000, v51
  v_lshlrev_b32 v108, 16, v52
  v_and_b32 v109, 0xffff0000, v52
  v_lshlrev_b32 v110, 16, v53
  v_and_b32 v111, 0xffff0000, v53
  v_lshlrev_b32 v112, 16, v54
  v_and_b32 v113, 0xffff0000, v54
  v_lshlrev_b32 v114, 16, v55
  v_and_b32 v115, 0xffff0000, v55
  v_lshlrev_b32 v116, 16, v56
  v_and_b32 v117, 0xffff0000, v56
  v_lshlrev_b32 v118, 16, v57
  v_and_b32 v119, 0xffff0000, v57
  v_lshlrev_b32 v120, 16, v58
  v_and_b32 v121, 0xffff0000, v58
  v_lshlrev_b32 v122, 16, v59
  v_and_b32 v123, 0xffff0000, v59
  v_lshlrev_b32 v124, 16, v60
  v_and_b32 v125, 0xffff0000, v60
  v_lshlrev_b32 v126, 16, v61
  v_and_b32 v127, 0xffff0000, v61
  v_lshlrev_b32 v128, 16, v62
  v_and_b32 v129, 0xffff0000, v62
  v_lshlrev_b32 v130, 16, v63
  v_and_b32 v131, 0xffff0000, v63
  v_lshlrev_b32 v132, 16, v64
  v_and_b32 v133, 0xffff0000, v64
  v_lshlrev_b32 v134, 16, v65
  v_and_b32 v135, 0xffff0000, v65
  v_lshlrev_b32 v136, 16, v66
  v_and_b32 v137, 0xffff0000, v66
  v_lshlrev_b32 v138, 16, v67
  v_and_b32 v139, 0xffff0000, v67
  v_lshlrev_b32 v140, 16, v68
  v_and_b32 v141, 0xffff0000, v68
  v_lshlrev_b32 v142, 16, v69
  v_and_b32 v143, 0xffff0000, v69
  v_lshlrev_b32 v144, 16, v70
  v_and_b32 v145, 0xffff0000, v70
  v_lshlrev_b32 v146, 16, v71
  v_and_b32 v147, 0xffff0000, v71
  v_lshlrev_b32 v148, 16, v72
  v_and_b32 v149, 0xffff0000, v72
  v_lshlrev_b32 v150, 16, v73
  v_and_b32 v151, 0xffff0000, v73
  v_lshlrev_b32 v152, 16, v74
  v_and_b32 v153, 0xffff0000, v74
  v_lshlrev_b32 v154, 16, v75
  v_and_b32 v155, 0xffff0000, v75
  s_mov_b32 s18, s45
LL2_171:
  s_add_u32 s23, s18, 1
  s_cmp_lg_u32 s16, 0
  s_cbranch_scc1 Lw0_172
  s_add_u32 s22, s43, 344064
Lwf_173:
  buffer_load_dword v7, v0, s[4:7], s22 offen sc1
  s_waitcnt vmcnt(0)
  v_cmp_gt_u32 vcc, s23, v7
  s_cbranch_vccz Lwfd_174
  s_sleep 1
  s_cmp_eq_u32 s19, 0
  s_cbranch_scc1 Lwfd_174
  s_sub_u32 s19, s19, 1
  s_branch Lwf_173
Lwfd_174:
Lw0_172:
  s_barrier
  s_lshl_b32 s20, s18, 1
  s_add_u32 s20, s20, s27
  s_mul_i32 s21, s20, 20480
  s_add_u32 s21, s21, 148373504
  buffer_load_dwordx4 v[16:19], v4, s[4:7], s21 offen offset:0 sc1
  buffer_load_dwordx4 v[20:23], v4, s[4:7], s21 offen offset:64 sc1
  buffer_load_dwordx4 v[24:27], v4, s[4:7], s21 offen offset:128 sc1
  buffer_load_dwordx4 v[28:31], v4, s[4:7], s21 offen offset:192 sc1
  buffer_load_dwordx4 v[32:35], v4, s[4:7], s21 offen offset:256 sc1
  s_mul_i32 s30, s20, 20480
  s_mul_i32 s21, s16, 5120
  s_add_u32 s30, s30, s21
  s_add_u32 s30, s30, 157286400
  s_waitcnt vmcnt(0)
  v_lshlrev_b32 v36, 16, v16
  v_and_b32 v37, 0xffff0000, v16
  v_lshlrev_b32 v38, 16, v17
  v_and_b32 v39, 0xffff0000, v17
  v_lshlrev_b32 v40, 16, v18
  v_and_b32 v41, 0xffff0000, v18
  v_lshlrev_b32 v42, 16, v19
  v_and_b32 v43, 0xffff0000, v19
  v_lshlrev_b32 v44, 16, v20
  v_and_b32 v45, 0xffff0000, v20
  v_lshlrev_b32 v46, 16, v21
  v_and_b32 v47, 0xffff0000, v21
  v_lshlrev_b32 v48, 16, v22
  v_and_b32 v49, 0xffff0000, v22
  v_lshlrev_b32 v50, 16, v23
  v_and_b32 v51, 0xffff0000, v23
  v_lshlrev_b32 v52, 16, v24
  v_and_b32 v53, 0xffff0000, v24
  v_lshlrev_b32 v54, 16, v25
  v_and_b32 v55, 0xffff0000, v25
  v_lshlrev_b32 v56, 16, v26
  v_and_b32 v57, 0xffff0000, v26
  v_lshlrev_b32 v58, 16, v27
  v_and_b32 v59, 0xffff0000, v27
  v_lshlrev_b32 v60, 16, v28
  v_and_b32 v61, 0xffff0000, v28
  v_lshlrev_b32 v62, 16, v29
  v_and_b32 v63, 0xffff0000, v29
  v_lshlrev_b32 v64, 16, v30
  v_and_b32 v65, 0xffff0000, v30
  v_lshlrev_b32 v66, 16, v31
  v_and_b32 v67, 0xffff0000, v31
  v_lshlrev_b32 v68, 16, v32
  v_and_b32 v69, 0xffff0000, v32
  v_lshlrev_b32 v70, 16, v33
  v_and_b32 v71, 0xffff0000, v33
  v_lshlrev_b32 v72, 16, v34
  v_and_b32 v73, 0xffff0000, v34
  v_lshlrev_b32 v74, 16, v35
  v_and_b32 v75, 0xffff0000, v35
  v_add_f32 v160, v36, v37
  v_add_f32 v161, v38, v39
  v_add_f32 v160, v160, v40
  v_add_f32 v161, v161, v41
  v_add_f32 v160, v160, v42
  v_add_f32 v161, v161, v43
  v_add_f32 v160, v160, v44
  v_add_f32 v161, v161, v45
  v_add_f32 v160, v160, v46
  v_add_f32 v161, v161, v47
  v_add_f32 v160, v160, v48
  v_add_f32 v161, v161, v49
  v_add_f32 v160, v160, v50
  v_add_f32 v161, v161, v51
  v_add_f32 v160, v160, v52
  v_add_f32 v161, v161, v53
  v_add_f32 v160, v160, v54
  v_add_f32 v161, v161, v55
  v_add_f32 v160, v160, v56
  v_add_f32 v161, v161, v57
  v_add_f32 v160, v160, v58
  v_add_f32 v161, v161, v59
  v_add_f32 v160, v160, v60
  v_add_f32 v161, v161, v61
  v_add_f32 v160, v160, v62
  v_add_f32 v161, v161, v63
  v_add_f32 v160, v160, v64
  v_add_f32 v161, v161, v65
  v_add_f32 v160, v160, v66
  v_add_f32 v161, v161, v67
  v_add_f32 v160, v160, v68
  v_add_f32 v161, v161, v69
  v_add_f32 v160, v160, v70
  v_add_f32 v161, v161, v71
  v_add_f32 v160, v160, v72
  v_add_f32 v161, v161, v73
  v_add_f32 v160, v160, v74
  v_add_f32 v161, v161, v75
  v_add_f32 v160, v160, v161
  v_mov_b32 v157, v160
  s_nop 1
  v_permlane16_swap_b32 v160, v157
  v_add_f32 v160, v160, v157
  v_mov_b32 v157, v160
  s_nop 1
  v_permlane32_swap_b32 v160, v157
  v_add_f32 v160, v160, v157
  s_lshl_b32 s20, s16, 6
  v_add_u32 v157, s20, v6
  ds_write_b32 v157, v160 offset:0
  s_waitcnt lgkmcnt(0)
  s_barrier
  ds_read_b32 v156, v6 offset:0
  ds_read_b32 v157, v6 offset:64
  ds_read_b32 v158, v6 offset:128
  ds_read_b32 v159, v6 offset:192
  s_waitcnt lgkmcnt(0)
  v_add_f32 v156, v156, v157
  v_add_f32 v158, v158, v159
  v_add_f32 v160, v156, v158
  v_mul_f32 v160, 0x3acccccd, v160
  v_sub_f32 v36, v36, v160
  v_sub_f32 v37, v37, v160
  v_sub_f32 v38, v38, v160
  v_sub_f32 v39, v39, v160
  v_sub_f32 v40, v40, v160
  v_sub_f32 v41, v41, v160
  v_sub_f32 v42, v42, v160
  v_sub_f32 v43, v43, v160
  v_sub_f32 v44, v44, v160
  v_sub_f32 v45, v45, v160
  v_sub_f32 v46, v46, v160
  v_sub_f32 v47, v47, v160
  v_sub_f32 v48, v48, v160
  v_sub_f32 v49, v49, v160
  v_sub_f32 v50, v50, v160
  v_sub_f32 v51, v51, v160
  v_sub_f32 v52, v52, v160
  v_sub_f32 v53, v53, v160
  v_sub_f32 v54, v54, v160
  v_sub_f32 v55, v55, v160
  v_sub_f32 v56, v56, v160
  v_sub_f32 v57, v57, v160
  v_sub_f32 v58, v58, v160
  v_sub_f32 v59, v59, v160
  v_sub_f32 v60, v60, v160
  v_sub_f32 v61, v61, v160
  v_sub_f32 v62, v62, v160
  v_sub_f32 v63, v63, v160
  v_sub_f32 v64, v64, v160
  v_sub_f32 v65, v65, v160
  v_sub_f32 v66, v66, v160
  v_sub_f32 v67, v67, v160
  v_sub_f32 v68, v68, v160
  v_sub_f32 v69, v69, v160
  v_sub_f32 v70, v70, v160
  v_sub_f32 v71, v71, v160
  v_sub_f32 v72, v72, v160
  v_sub_f32 v73, v73, v160
  v_sub_f32 v74, v74, v160
  v_sub_f32 v75, v75, v160
  v_mul_f32 v160, v36, v36
  v_mul_f32 v161, v37, v37
  v_fmac_f32 v160, v38, v38
  v_fmac_f32 v161, v39, v39
  v_fmac_f32 v160, v40, v40
  v_fmac_f32 v161, v41, v41
  v_fmac_f32 v160, v42, v42
  v_fmac_f32 v161, v43, v43
  v_fmac_f32 v160, v44, v44
  v_fmac_f32 v161, v45, v45
  v_fmac_f32 v160, v46, v46
  v_fmac_f32 v161, v47, v47
  v_fmac_f32 v160, v48, v48
  v_fmac_f32 v161, v49, v49
  v_fmac_f32 v160, v50, v50
  v_fmac_f32 v161, v51, v51
  v_fmac_f32 v160, v52, v52
  v_fmac_f32 v161, v53, v53
  v_fmac_f32 v160, v54, v54
  v_fmac_f32 v161, v55, v55
  v_fmac_f32 v160, v56, v56
  v_fmac_f32 v161, v57, v57
  v_fmac_f32 v160, v58, v58
  v_fmac_f32 v161, v59, v59
  v_fmac_f32 v160, v60, v60
  v_fmac_f32 v161, v61, v61
  v_fmac_f32 v160, v62, v62
  v_fmac_f32 v161, v63, v63
  v_fmac_f32 v160, v64, v64
  v_fmac_f32 v161, v65, v65
  v_fmac_f32 v160, v66, v66
  v_fmac_f32 v161, v67, v67
  v_fmac_f32 v160, v68, v68
  v_fmac_f32 v161, v69, v69
  v_fmac_f32 v160, v70, v70
  v_fmac_f32 v161, v71, v71
  v_fmac_f32 v160, v72, v72
  v_fmac_f32 v161, v73, v73
  v_fmac_f32 v160, v74, v74
  v_fmac_f32 v161, v75, v75
  v_add_f32 v160, v160, v161
  v_mov_b32 v157, v160
  s_nop 1
  v_permlane16_swap_b32 v160, v157
  v_add_f32 v160, v160, v157
  v_mov_b32 v157, v160
  s_nop 1
  v_permlane32_swap_b32 v160, v157
  v_add_f32 v160, v160, v157
  s_lshl_b32 s20, s16, 6
  v_add_u32 v157, s20, v6
  ds_write_b32 v157, v160 offset:256
  s_waitcnt lgkmcnt(0)
  s_barrier
  ds_read_b32 v156, v6 offset:256
  ds_read_b32 v157, v6 offset:320
  ds_read_b32 v158, v6 offset:384
  ds_read_b32 v159, v6 offset:448
  s_waitcnt lgkmcnt(0)
  v_add_f32 v156, v156, v157
  v_add_f32 v158, v158, v159
  v_add_f32 v160, v156, v158
  v_mov_b32 v161, 0x3727c5ac
  v_fmac_f32 v161, 0x3acccccd, v160
  v_rsq_f32 v161, v161
  s_nop 0
  v_mul_f32 v36, v36, v161
  v_fma_f32 v36, v36, v76, v116
  v_mul_f32 v37, v37, v161
  v_fma_f32 v37, v37, v77, v117
  v_mul_f32 v38, v38, v161
  v_fma_f32 v38, v38, v78, v118
  v_mul_f32 v39, v39, v161
  v_fma_f32 v39, v39, v79, v119
  v_mul_f32 v40, v40, v161
  v_fma_f32 v40, v40, v80, v120
  v_mul_f32 v41, v41, v161
  v_fma_f32 v41, v41, v81, v121
  v_mul_f32 v42, v42, v161
  v_fma_f32 v42, v42, v82, v122
  v_mul_f32 v43, v43, v161
  v_fma_f32 v43, v43, v83, v123
  v_mul_f32 v44, v44, v161
  v_fma_f32 v44, v44, v84, v124
  v_mul_f32 v45, v45, v161
  v_fma_f32 v45, v45, v85, v125
  v_mul_f32 v46, v46, v161
  v_fma_f32 v46, v46, v86, v126
  v_mul_f32 v47, v47, v161
  v_fma_f32 v47, v47, v87, v127
  v_mul_f32 v48, v48, v161
  v_fma_f32 v48, v48, v88, v128
  v_mul_f32 v49, v49, v161
  v_fma_f32 v49, v49, v89, v129
  v_mul_f32 v50, v50, v161
  v_fma_f32 v50, v50, v90, v130
  v_mul_f32 v51, v51, v161
  v_fma_f32 v51, v51, v91, v131
  v_mul_f32 v52, v52, v161
  v_fma_f32 v52, v52, v92, v132
  v_mul_f32 v53, v53, v161
  v_fma_f32 v53, v53, v93, v133
  v_mul_f32 v54, v54, v161
  v_fma_f32 v54, v54, v94, v134
  v_mul_f32 v55, v55, v161
  v_fma_f32 v55, v55, v95, v135
  v_mul_f32 v56, v56, v161
  v_fma_f32 v56, v56, v96, v136
  v_mul_f32 v57, v57, v161
  v_fma_f32 v57, v57, v97, v137
  v_mul_f32 v58, v58, v161
  v_fma_f32 v58, v58, v98, v138
  v_mul_f32 v59, v59, v161
  v_fma_f32 v59, v59, v99, v139
  v_mul_f32 v60, v60, v161
  v_fma_f32 v60, v60, v100, v140
  v_mul_f32 v61, v61, v161
  v_fma_f32 v61, v61, v101, v141
  v_mul_f32 v62, v62, v161
  v_fma_f32 v62, v62, v102, v142
  v_mul_f32 v63, v63, v161
  v_fma_f32 v63, v63, v103, v143
  v_mul_f32 v64, v64, v161
  v_fma_f32 v64, v64, v104, v144
  v_mul_f32 v65, v65, v161
  v_fma_f32 v65, v65, v105, v145
  v_mul_f32 v66, v66, v161
  v_fma_f32 v66, v66, v106, v146
  v_mul_f32 v67, v67, v161
  v_fma_f32 v67, v67, v107, v147
  v_mul_f32 v68, v68, v161
  v_fma_f32 v68, v68, v108, v148
  v_mul_f32 v69, v69, v161
  v_fma_f32 v69, v69, v109, v149
  v_mul_f32 v70, v70, v161
  v_fma_f32 v70, v70, v110, v150
  v_mul_f32 v71, v71, v161
  v_fma_f32 v71, v71, v111, v151
  v_mul_f32 v72, v72, v161
  v_fma_f32 v72, v72, v112, v152
  v_mul_f32 v73, v73, v161
  v_fma_f32 v73, v73, v113, v153
  v_mul_f32 v74, v74, v161
  v_fma_f32 v74, v74, v114, v154
  v_mul_f32 v75, v75, v161
  v_fma_f32 v75, v75, v115, v155
  v_cvt_pk_bf16_f32 v16, v36, v37
  v_cvt_pk_bf16_f32 v17, v38, v39
  v_cvt_pk_bf16_f32 v18, v40, v41
  v_cvt_pk_bf16_f32 v19, v42, v43
  v_cvt_pk_bf16_f32 v20, v44, v45
  v_cvt_pk_bf16_f32 v21, v46, v47
  v_cvt_pk_bf16_f32 v22, v48, v49
  v_cvt_pk_bf16_f32 v23, v50, v51
  v_cvt_pk_bf16_f32 v24, v52, v53
  v_cvt_pk_bf16_f32 v25, v54, v55
  v_cvt_pk_bf16_f32 v26, v56, v57
  v_cvt_pk_bf16_f32 v27, v58, v59
  v_cvt_pk_bf16_f32 v28, v60, v61
  v_cvt_pk_bf16_f32 v29, v62, v63
  v_cvt_pk_bf16_f32 v30, v64, v65
  v_cvt_pk_bf16_f32 v31, v66, v67
  v_cvt_pk_bf16_f32 v32, v68, v69
  v_cvt_pk_bf16_f32 v33, v70, v71
  v_cvt_pk_bf16_f32 v34, v72, v73
  v_cvt_pk_bf16_f32 v35, v74, v75
  buffer_store_dwordx4 v[16:19], v2, s[4:7], s30 offen offset:0 sc1
  buffer_store_dwordx4 v[20:23], v2, s[4:7], s30 offen offset:1024 sc1
  buffer_store_dwordx4 v[24:27], v2, s[4:7], s30 offen offset:2048 sc1
  buffer_store_dwordx4 v[28:31], v2, s[4:7], s30 offen offset:3072 sc1
  s_add_u32 s30, s30, 4096
  buffer_store_dwordx4 v[32:35], v2, s[4:7], s30 offen offset:0 sc1
  s_waitcnt vmcnt(0)
  s_barrier
  s_add_u32 s23, s18, 1
  v_mov_b32 v9, s23
  buffer_store_dword v9, v8, s[4:7], s44 offen sc1
  s_add_u32 s18, s18, 2
  s_cmp_lt_u32 s18, s31
  s_cbranch_scc1 LL2_171
  s_branch L_end
L_goF1:
  s_load_dwordx2 s[8:9], s[0:1], 64
  s_mov_b32 s10, 0x1e0000
  s_mov_b32 s11, 0x00020000
  s_load_dwordx2 s[12:13], s[0:1], 72
  s_mov_b32 s14, 0x1e0000
  s_mov_b32 s15, 0x00020000
  v_lshrrev_b32 v3, 6, v0
  v_and_b32 v1, 63, v0
  v_readfirstlane_b32 s16, v3
  v_lshlrev_b32 v2, 4, v1
  s_mov_b32 s19, 400000
  s_waitcnt lgkmcnt(0)
  s_cmp_ge_u32 s17, 24
  s_cselect_b32 s45, 1, 0
  s_mul_i32 s20, s45, 24
  s_sub_u32 s27, s17, s20
  v_mov_b32 v8, 0
  v_mov_b32 v9, 0x7ff00000
  v_cmp_eq_u32 vcc, 0, v0
  s_nop 1
  v_cndmask_b32 v8, v9, v8, vcc
  s_lshl_b32 s20, s17, 7
  s_add_u32 s44, s20, 22016
  v_and_b32 v0, 1, v1
  s_lshl_b32 s20, s45, 1
  v_add_u32 v0, s20, v0
  v_lshlrev_b32 v0, 7, v0
  s_lshl_b32 s34, s16, 14
  v_add_u32 v83, 0, v1
  s_mov_b32 s20, 262145
  v_mul_lo_u32 v84, v83, s20
  v_lshrrev_b32 v84, 20, v84
  v_mul_u32_u24 v80, 4, v84
  v_sub_u32 v80, v83, v80
  v_lshlrev_b32 v80, 4, v80
  s_mov_b32 s20, 3072
  v_mul_lo_u32 v84, v84, s20
  v_add_u32 v80, v80, v84
  v_add_u32 v83, 64, v1
  s_mov_b32 s20, 262145
  v_mul_lo_u32 v84, v83, s20
  v_lshrrev_b32 v84, 20, v84
  v_mul_u32_u24 v81, 4, v84
  v_sub_u32 v81, v83, v81
  v_lshlrev_b32 v81, 4, v81
  s_mov_b32 s20, 3072
  v_mul_lo_u32 v84, v84, s20
  v_add_u32 v81, v81, v84
  v_lshrrev_b32 v83, 4, v1
  v_mul_u32_u24 v83, 8, v83
  v_bfe_u32 v84, v1, 2, 2
  v_add_u32 v83, v83, v84
  v_mul_u32_u24 v83, 64, v83
  v_and_b32 v84, 3, v1
  v_lshlrev_b32 v84, 3, v84
  v_add_u32 v85, v83, v84
  v_add_u32 v85, s34, v85
  s_lshl_b32 s35, s27, 7
  s_lshr_b32 s20, s16, 1
  s_lshl_b32 s20, s20, 6
  s_add_u32 s35, s35, s20
  s_mov_b32 s52, s32
  s_mov_b32 s53, s33
  s_mov_b32 s54, 256
  s_mov_b32 s55, 0x00020000
  s_cmp_lg_u32 s16, 0
  s_cbranch_scc1 Lwr_175
  v_lshrrev_b32 v16, 4, v2
  v_lshlrev_b32 v16, 7, v16
  v_mov_b32 v17, 196
  s_mov_b32 s51, 106496
  s_mov_b32 s50, 114688
Lwrt_176:
  buffer_load_dword v18, v16, s[4:7], s51 offen sc1
  buffer_load_dword v19, v16, s[4:7], s50 offen sc1
  s_waitcnt vmcnt(0)
  v_cmp_ne_u32 vcc, s70, v18
  s_cbranch_vccnz Lwra_178
  v_cmp_ne_u32 vcc, s70, v19
  s_cbranch_vccnz Lwra_178
  s_branch Lwrd_177
Lwra_178:
  s_sleep 2
  s_cmp_eq_u32 s19, 0
  s_cbranch_scc1 Lwrd_177
  s_sub_u32 s19, s19, 1
  s_branch Lwrt_176
Lwrd_177:
Lwr_175:
  s_barrier
  s_sleep 100
  s_add_u32 s20, s35, 0
  s_add_u32 s21, s34, 0
  s_mov_b32 m0, s21
  s_nop 0
  buffer_load_dwordx4 v80, s[8:11], s20 offen lds
  s_add_u32 s21, s34, 1024
  s_mov_b32 m0, s21
  s_nop 0
  buffer_load_dwordx4 v81, s[8:11], s20 offen lds
  s_add_u32 s20, s35, 0
  s_add_u32 s21, s34, 2048
  s_mov_b32 m0, s21
  s_nop 0
  buffer_load_dwordx4 v80, s[12:15], s20 offen lds
  s_add_u32 s21, s34, 3072
  s_mov_b32 m0, s21
  s_nop 0
  buffer_load_dwordx4 v81, s[12:15], s20 offen lds
  s_add_u32 s20, s35, 98304
  s_add_u32 s21, s34, 4096
  s_mov_b32 m0, s21
  s_nop 0
  buffer_load_dwordx4 v80, s[8:11], s20 offen lds
  s_add_u32 s21, s34, 5120
  s_mov_b32 m0, s21
  s_nop 0
  buffer_load_dwordx4 v81, s[8:11], s20 offen lds
  s_add_u32 s20, s35, 98304
  s_add_u32 s21, s34, 6144
  s_mov_b32 m0, s21
  s_nop 0
  buffer_load_dwordx4 v80, s[12:15], s20 offen lds
  s_add_u32 s21, s34, 7168
  s_mov_b32 m0, s21
  s_nop 0
  buffer_load_dwordx4 v81, s[12:15], s20 offen lds
  s_add_u32 s20, s35, 196608
  s_add_u32 s21, s34, 8192
  s_mov_b32 m0, s21
  s_nop 0
  buffer_load_dwordx4 v80, s[8:11], s20 offen lds
  s_add_u32 s21, s34, 9216
  s_mov_b32 m0, s21
  s_nop 0
  buffer_load_dwordx4 v81, s[8:11], s20 offen lds
  s_add_u32 s20, s35, 196608
  s_add_u32 s21, s34, 10240
  s_mov_b32 m0, s21
  s_nop 0
  buffer_load_dwordx4 v80, s[12:15], s20 offen lds
  s_add_u32 s21, s34, 11264
  s_mov_b32 m0, s21
  s_nop 0
  buffer_load_dwordx4 v81, s[12:15], s20 offen lds
  s_add_u32 s20, s35, 294912
  s_add_u32 s21, s34, 12288
  s_mov_b32 m0, s21
  s_nop 0
  buffer_load_dwordx4 v80, s[8:11], s20 offen lds
  s_add_u32 s21, s34, 13312
  s_mov_b32 m0, s21
  s_nop 0
  buffer_load_dwordx4 v81, s[8:11], s20 offen lds
  s_waitcnt vmcnt(12)
  ds_read_b64_tr_b16 a[0:1], v85 offset:0
  ds_read_b64_tr_b16 a[2:3], v85 offset:256
  ds_read_b64_tr_b16 a[4:5], v85 offset:32
  ds_read_b64_tr_b16 a[6:7], v85 offset:288
  s_waitcnt lgkmcnt(0)
  s_add_u32 s20, s35, 294912
  s_add_u32 s21, s34, 14336
  s_mov_b32 m0, s21
  s_nop 0
  buffer_load_dwordx4 v80, s[12:15], s20 offen lds
  s_add_u32 s21, s34, 15360
  s_mov_b32 m0, s21
  s_nop 0
  buffer_load_dwordx4 v81, s[12:15], s20 offen lds
  s_waitcnt vmcnt(12)
  ds_read_b64_tr_b16 a[8:9], v85 offset:2048
  ds_read_b64_tr_b16 a[10:11], v85 offset:2304
  ds_read_b64_tr_b16 a[12:13], v85 offset:2080
  ds_read_b64_tr_b16 a[14:15], v85 offset:2336
  s_waitcnt lgkmcnt(0)
  s_add_u32 s20, s35, 393216
  s_add_u32 s21, s34, 0
  s_mov_b32 m0, s21
  s_nop 0
  buffer_load_dwordx4 v80, s[8:11], s20 offen lds
  s_add_u32 s21, s34, 1024
  s_mov_b32 m0, s21
  s_nop 0
  buffer_load_dwordx4 v81, s[8:11], s20 offen lds
  s_waitcnt vmcnt(12)
  ds_read_b64_tr_b16 a[16:17], v85 offset:4096
  ds_read_b64_tr_b16 a[18:19], v85 offset:4352
  ds_read_b64_tr_b16 a[20:21], v85 offset:4128
  ds_read_b64_tr_b16 a[22:23], v85 offset:4384
  s_waitcnt lgkmcnt(0)
  s_add_u32 s20, s35, 393216
  s_add_u32 s21, s34, 2048
  s_mov_b32 m0, s21
  s_nop 0
  buffer_load_dwordx4 v80, s[12:15], s20 offen lds
  s_add_u32 s21, s34, 3072
  s_mov_b32 m0, s21
  s_nop 0
  buffer_load_dwordx4 v81, s[12:15], s20 offen lds
  s_waitcnt vmcnt(12)
  ds_read_b64_tr_b16 a[24:25], v85 offset:6144
  ds_read_b64_tr_b16 a[26:27], v85 offset:6400
  ds_read_b64_tr_b16 a[28:29], v85 offset:6176
  ds_read_b64_tr_b16 a[30:31], v85 offset:6432
  s_waitcnt lgkmcnt(0)
  s_add_u32 s20, s35, 491520
  s_add_u32 s21, s34, 4096
  s_mov_b32 m0, s21
  s_nop 0
  buffer_load_dwordx4 v80, s[8:11], s20 offen lds
  s_add_u32 s21, s34, 5120
  s_mov_b32 m0, s21
  s_nop 0
  buffer_load_dwordx4 v81, s[8:11], s20 offen lds
  s_waitcnt vmcnt(12)
  ds_read_b64_tr_b16 a[32:33], v85 offset:8192
  ds_read_b64_tr_b16 a[34:35], v85 offset:8448
  ds_read_b64_tr_b16 a[36:37], v85 offset:8224
  ds_read_b64_tr_b16 a[38:39], v85 offset:8480
  s_waitcnt lgkmcnt(0)
  s_add_u32 s20, s35, 491520
  s_add_u32 s21, s34, 6144
  s_mov_b32 m0, s21
  s_nop 0
  buffer_load_dwordx4 v80, s[12:15], s20 offen lds
  s_add_u32 s21, s34, 7168
  s_mov_b32 m0, s21
  s_nop 0
  buffer_load_dwordx4 v81, s[12:15], s20 offen lds
  s_waitcnt vmcnt(12)
  ds_read_b64_tr_b16 a[40:41], v85 offset:10240
  ds_read_b64_tr_b16 a[42:43], v85 offset:10496
  ds_read_b64_tr_b16 a[44:45], v85 offset:10272
  ds_read_b64_tr_b16 a[46:47], v85 offset:10528
  s_waitcnt lgkmcnt(0)
  s_add_u32 s20, s35, 589824
  s_add_u32 s21, s34, 8192
  s_mov_b32 m0, s21
  s_nop 0
  buffer_load_dwordx4 v80, s[8:11], s20 offen lds
  s_add_u32 s21, s34, 9216
  s_mov_b32 m0, s21
  s_nop 0
  buffer_load_dwordx4 v81, s[8:11], s20 offen lds
  s_waitcnt vmcnt(12)
  ds_read_b64_tr_b16 a[48:49], v85 offset:12288
  ds_read_b64_tr_b16 a[50:51], v85 offset:12544
  ds_read_b64_tr_b16 a[52:53], v85 offset:12320
  ds_read_b64_tr_b16 a[54:55], v85 offset:12576
  s_waitcnt lgkmcnt(0)
  s_add_u32 s20, s35, 589824
  s_add_u32 s21, s34, 10240
  s_mov_b32 m0, s21
  s_nop 0
  buffer_load_dwordx4 v80, s[12:15], s20 offen lds
  s_add_u32 s21, s34, 11264
  s_mov_b32 m0, s21
  s_nop 0
  buffer_load_dwordx4 v81, s[12:15], s20 offen lds
  s_waitcnt vmcnt(12)
  ds_read_b64_tr_b16 a[56:57], v85 offset:14336
  ds_read_b64_tr_b16 a[58:59], v85 offset:14592
  ds_read_b64_tr_b16 a[60:61], v85 offset:14368
  ds_read_b64_tr_b16 a[62:63], v85 offset:14624
  s_waitcnt lgkmcnt(0)
  s_add_u32 s20, s35, 688128
  s_add_u32 s21, s34, 12288
  s_mov_b32 m0, s21
  s_nop 0
  buffer_load_dwordx4 v80, s[8:11], s20 offen lds
  s_add_u32 s21, s34, 13312
  s_mov_b32 m0, s21
  s_nop 0
  buffer_load_dwordx4 v81, s[8:11], s20 offen lds
  s_waitcnt vmcnt(12)
  ds_read_b64_tr_b16 a[64:65], v85 offset:0
  ds_read_b64_tr_b16 a[66:67], v85 offset:256
  ds_read_b64_tr_b16 a[68:69], v85 offset:32
  ds_read_b64_tr_b16 a[70:71], v85 offset:288
  s_waitcnt lgkmcnt(0)
  s_add_u32 s20, s35, 688128
  s_add_u32 s21, s34, 14336
  s_mov_b32 m0, s21
  s_nop 0
  buffer_load_dwordx4 v80, s[12:15], s20 offen lds
  s_add_u32 s21, s34, 15360
  s_mov_b32 m0, s21
  s_nop 0
  buffer_load_dwordx4 v81, s[12:15], s20 offen lds
  s_waitcnt vmcnt(12)
  ds_read_b64_tr_b16 a[72:73], v85 offset:2048
  ds_read_b64_tr_b16 a[74:75], v85 offset:2304
  ds_read_b64_tr_b16 a[76:77], v85 offset:2080
  ds_read_b64_tr_b16 a[78:79], v85 offset:2336
  s_waitcnt lgkmcnt(0)
  s_add_u32 s20, s35, 786432
  s_add_u32 s21, s34, 0
  s_mov_b32 m0, s21
  s_nop 0
  buffer_load_dwordx4 v80, s[8:11], s20 offen lds
  s_add_u32 s21, s34, 1024
  s_mov_b32 m0, s21
  s_nop 0
  buffer_load_dwordx4 v81, s[8:11], s20 offen lds
  s_waitcnt vmcnt(12)
  ds_read_b64_tr_b16 a[80:81], v85 offset:4096
  ds_read_b64_tr_b16 a[82:83], v85 offset:4352
  ds_read_b64_tr_b16 a[84:85], v85 offset:4128
  ds_read_b64_tr_b16 a[86:87], v85 offset:4384
  s_waitcnt lgkmcnt(0)
  s_add_u32 s20, s35, 786432
  s_add_u32 s21, s34, 2048
  s_mov_b32 m0, s21
  s_nop 0
  buffer_load_dwordx4 v80, s[12:15], s20 offen lds
  s_add_u32 s21, s34, 3072
  s_mov_b32 m0, s21
  s_nop 0
  buffer_load_dwordx4 v81, s[12:15], s20 offen lds
  s_waitcnt vmcnt(12)
  ds_read_b64_tr_b16 a[88:89], v85 offset:6144
  ds_read_b64_tr_b16 a[90:91], v85 offset:6400
  ds_read_b64_tr_b16 a[92:93], v85 offset:6176
  ds_read_b64_tr_b16 a[94:95], v85 offset:6432
  s_waitcnt lgkmcnt(0)
  s_add_u32 s20, s35, 884736
  s_add_u32 s21, s34, 4096
  s_mov_b32 m0, s21
  s_nop 0
  buffer_load_dwordx4 v80, s[8:11], s20 offen lds
  s_add_u32 s21, s34, 5120
  s_mov_b32 m0, s21
  s_nop 0
  buffer_load_dwordx4 v81, s[8:11], s20 offen lds
  s_waitcnt vmcnt(12)
  ds_read_b64_tr_b16 a[96:97], v85 offset:8192
  ds_read_b64_tr_b16 a[98:99], v85 offset:8448
  ds_read_b64_tr_b16 a[100:101], v85 offset:8224
  ds_read_b64_tr_b16 a[102:103], v85 offset:8480
  s_waitcnt lgkmcnt(0)
  s_add_u32 s20, s35, 884736
  s_add_u32 s21, s34, 6144
  s_mov_b32 m0, s21
  s_nop 0
  buffer_load_dwordx4 v80, s[12:15], s20 offen lds
  s_add_u32 s21, s34, 7168
  s_mov_b32 m0, s21
  s_nop 0
  buffer_load_dwordx4 v81, s[12:15], s20 offen lds
  s_waitcnt vmcnt(12)
  ds_read_b64_tr_b16 a[104:105], v85 offset:10240
  ds_read_b64_tr_b16 a[106:107], v85 offset:10496
  ds_read_b64_tr_b16 a[108:109], v85 offset:10272
  ds_read_b64_tr_b16 a[110:111], v85 offset:10528
  s_waitcnt lgkmcnt(0)
  s_add_u32 s20, s35, 983040
  s_add_u32 s21, s34, 8192
  s_mov_b32 m0, s21
  s_nop 0
  buffer_load_dwordx4 v80, s[8:11], s20 offen lds
  s_add_u32 s21, s34, 9216
  s_mov_b32 m0, s21
  s_nop 0
  buffer_load_dwordx4 v81, s[8:11], s20 offen lds
  s_waitcnt vmcnt(12)
  ds_read_b64_tr_b16 a[112:113], v85 offset:12288
  ds_read_b64_tr_b16 a[114:115], v85 offset:12544
  ds_read_b64_tr_b16 a[116:117], v85 offset:12320
  ds_read_b64_tr_b16 a[118:119], v85 offset:12576
  s_waitcnt lgkmcnt(0)
  s_add_u32 s20, s35, 983040
  s_add_u32 s21, s34, 10240
  s_mov_b32 m0, s21
  s_nop 0
  buffer_load_dwordx4 v80, s[12:15], s20 offen lds
  s_add_u32 s21, s34, 11264
  s_mov_b32 m0, s21
  s_nop 0
  buffer_load_dwordx4 v81, s[12:15], s20 offen lds
  s_waitcnt vmcnt(12)
  ds_read_b64_tr_b16 a[120:121], v85 offset:14336
  ds_read_b64_tr_b16 a[122:123], v85 offset:14592
  ds_read_b64_tr_b16 a[124:125], v85 offset:14368
  ds_read_b64_tr_b16 a[126:127], v85 offset:14624
  s_waitcnt lgkmcnt(0)
  s_add_u32 s20, s35, 1081344
  s_add_u32 s21, s34, 12288
  s_mov_b32 m0, s21
  s_nop 0
  buffer_load_dwordx4 v80, s[8:11], s20 offen lds
  s_add_u32 s21, s34, 13312
  s_mov_b32 m0, s21
  s_nop 0
  buffer_load_dwordx4 v81, s[8:11], s20 offen lds
  s_waitcnt vmcnt(12)
  ds_read_b64_tr_b16 a[128:129], v85 offset:0
  ds_read_b64_tr_b16 a[130:131], v85 offset:256
  ds_read_b64_tr_b16 a[132:133], v85 offset:32
  ds_read_b64_tr_b16 a[134:135], v85 offset:288
  s_waitcnt lgkmcnt(0)
  s_add_u32 s20, s35, 1081344
  s_add_u32 s21, s34, 14336
  s_mov_b32 m0, s21
  s_nop 0
  buffer_load_dwordx4 v80, s[12:15], s20 offen lds
  s_add_u32 s21, s34, 15360
  s_mov_b32 m0, s21
  s_nop 0
  buffer_load_dwordx4 v81, s[12:15], s20 offen lds
  s_waitcnt vmcnt(12)
  ds_read_b64_tr_b16 a[136:137], v85 offset:2048
  ds_read_b64_tr_b16 a[138:139], v85 offset:2304
  ds_read_b64_tr_b16 a[140:141], v85 offset:2080
  ds_read_b64_tr_b16 a[142:143], v85 offset:2336
  s_waitcnt lgkmcnt(0)
  s_add_u32 s20, s35, 1179648
  s_add_u32 s21, s34, 0
  s_mov_b32 m0, s21
  s_nop 0
  buffer_load_dwordx4 v80, s[8:11], s20 offen lds
  s_add_u32 s21, s34, 1024
  s_mov_b32 m0, s21
  s_nop 0
  buffer_load_dwordx4 v81, s[8:11], s20 offen lds
  s_waitcnt vmcnt(12)
  ds_read_b64_tr_b16 a[144:145], v85 offset:4096
  ds_read_b64_tr_b16 a[146:147], v85 offset:4352
  ds_read_b64_tr_b16 a[148:149], v85 offset:4128
  ds_read_b64_tr_b16 a[150:151], v85 offset:4384
  s_waitcnt lgkmcnt(0)
  s_add_u32 s20, s35, 1179648
  s_add_u32 s21, s34, 2048
  s_mov_b32 m0, s21
  s_nop 0
  buffer_load_dwordx4 v80, s[12:15], s20 offen lds
  s_add_u32 s21, s34, 3072
  s_mov_b32 m0, s21
  s_nop 0
  buffer_load_dwordx4 v81, s[12:15], s20 offen lds
  s_waitcnt vmcnt(12)
  ds_read_b64_tr_b16 a[152:153], v85 offset:6144
  ds_read_b64_tr_b16 a[154:155], v85 offset:6400
  ds_read_b64_tr_b16 a[156:157], v85 offset:6176
  ds_read_b64_tr_b16 a[158:159], v85 offset:6432
  s_waitcnt lgkmcnt(0)
  s_add_u32 s20, s35, 1277952
  s_add_u32 s21, s34, 4096
  s_mov_b32 m0, s21
  s_nop 0
  buffer_load_dwordx4 v80, s[8:11], s20 offen lds
  s_add_u32 s21, s34, 5120
  s_mov_b32 m0, s21
  s_nop 0
  buffer_load_dwordx4 v81, s[8:11], s20 offen lds
  s_waitcnt vmcnt(12)
  ds_read_b64_tr_b16 a[160:161], v85 offset:8192
  ds_read_b64_tr_b16 a[162:163], v85 offset:8448
  ds_read_b64_tr_b16 a[164:165], v85 offset:8224
  ds_read_b64_tr_b16 a[166:167], v85 offset:8480
  s_waitcnt lgkmcnt(0)
  s_add_u32 s20, s35, 1277952
  s_add_u32 s21, s34, 6144
  s_mov_b32 m0, s21
  s_nop 0
  buffer_load_dwordx4 v80, s[12:15], s20 offen lds
  s_add_u32 s21, s34, 7168
  s_mov_b32 m0, s21
  s_nop 0
  buffer_load_dwordx4 v81, s[12:15], s20 offen lds
  s_waitcnt vmcnt(12)
  ds_read_b64_tr_b16 a[168:169], v85 offset:10240
  ds_read_b64_tr_b16 a[170:171], v85 offset:10496
  ds_read_b64_tr_b16 a[172:173], v85 offset:10272
  ds_read_b64_tr_b16 a[174:175], v85 offset:10528
  s_waitcnt lgkmcnt(0)
  s_add_u32 s20, s35, 1376256
  s_add_u32 s21, s34, 8192
  s_mov_b32 m0, s21
  s_nop 0
  buffer_load_dwordx4 v80, s[8:11], s20 offen lds
  s_add_u32 s21, s34, 9216
  s_mov_b32 m0, s21
  s_nop 0
  buffer_load_dwordx4 v81, s[8:11], s20 offen lds
  s_waitcnt vmcnt(12)
  ds_read_b64_tr_b16 a[176:177], v85 offset:12288
  ds_read_b64_tr_b16 a[178:179], v85 offset:12544
  ds_read_b64_tr_b16 a[180:181], v85 offset:12320
  ds_read_b64_tr_b16 a[182:183], v85 offset:12576
  s_waitcnt lgkmcnt(0)
  s_add_u32 s20, s35, 1376256
  s_add_u32 s21, s34, 10240
  s_mov_b32 m0, s21
  s_nop 0
  buffer_load_dwordx4 v80, s[12:15], s20 offen lds
  s_add_u32 s21, s34, 11264
  s_mov_b32 m0, s21
  s_nop 0
  buffer_load_dwordx4 v81, s[12:15], s20 offen lds
  s_waitcnt vmcnt(12)
  ds_read_b64_tr_b16 a[184:185], v85 offset:14336
  ds_read_b64_tr_b16 a[186:187], v85 offset:14592
  ds_read_b64_tr_b16 a[188:189], v85 offset:14368
  ds_read_b64_tr_b16 a[190:191], v85 offset:14624
  s_waitcnt lgkmcnt(0)
  s_add_u32 s20, s35, 1474560
  s_add_u32 s21, s34, 12288
  s_mov_b32 m0, s21
  s_nop 0
  buffer_load_dwordx4 v80, s[8:11], s20 offen lds
  s_add_u32 s21, s34, 13312
  s_mov_b32 m0, s21
  s_nop 0
  buffer_load_dwordx4 v81, s[8:11], s20 offen lds
  s_waitcnt vmcnt(12)
  ds_read_b64_tr_b16 a[192:193], v85 offset:0
  ds_read_b64_tr_b16 a[194:195], v85 offset:256
  ds_read_b64_tr_b16 a[196:197], v85 offset:32
  ds_read_b64_tr_b16 a[198:199], v85 offset:288
  s_waitcnt lgkmcnt(0)
  s_add_u32 s20, s35, 1474560
  s_add_u32 s21, s34, 14336
  s_mov_b32 m0, s21
  s_nop 0
  buffer_load_dwordx4 v80, s[12:15], s20 offen lds
  s_add_u32 s21, s34, 15360
  s_mov_b32 m0, s21
  s_nop 0
  buffer_load_dwordx4 v81, s[12:15], s20 offen lds
  s_waitcnt vmcnt(12)
  ds_read_b64_tr_b16 a[200:201], v85 offset:2048
  ds_read_b64_tr_b16 a[202:203], v85 offset:2304
  ds_read_b64_tr_b16 a[204:205], v85 offset:2080
  ds_read_b64_tr_b16 a[206:207], v85 offset:2336
  s_waitcnt lgkmcnt(0)
  s_add_u32 s20, s35, 1572864
  s_add_u32 s21, s34, 0
  s_mov_b32 m0, s21
  s_nop 0
  buffer_load_dwordx4 v80, s[8:11], s20 offen lds
  s_add_u32 s21, s34, 1024
  s_mov_b32 m0, s21
  s_nop 0
  buffer_load_dwordx4 v81, s[8:11], s20 offen lds
  s_waitcnt vmcnt(12)
  ds_read_b64_tr_b16 a[208:209], v85 offset:4096
  ds_read_b64_tr_b16 a[210:211], v85 offset:4352
  ds_read_b64_tr_b16 a[212:213], v85 offset:4128
  ds_read_b64_tr_b16 a[214:215], v85 offset:4384
  s_waitcnt lgkmcnt(0)
  s_add_u32 s20, s35, 1572864
  s_add_u32 s21, s34, 2048
  s_mov_b32 m0, s21
  s_nop 0
  buffer_load_dwordx4 v80, s[12:15], s20 offen lds
  s_add_u32 s21, s34, 3072
  s_mov_b32 m0, s21
  s_nop 0
  buffer_load_dwordx4 v81, s[12:15], s20 offen lds
  s_waitcnt vmcnt(12)
  ds_read_b64_tr_b16 a[216:217], v85 offset:6144
  ds_read_b64_tr_b16 a[218:219], v85 offset:6400
  ds_read_b64_tr_b16 a[220:221], v85 offset:6176
  ds_read_b64_tr_b16 a[222:223], v85 offset:6432
  s_waitcnt lgkmcnt(0)
  s_add_u32 s20, s35, 1671168
  s_add_u32 s21, s34, 4096
  s_mov_b32 m0, s21
  s_nop 0
  buffer_load_dwordx4 v80, s[8:11], s20 offen lds
  s_add_u32 s21, s34, 5120
  s_mov_b32 m0, s21
  s_nop 0
  buffer_load_dwordx4 v81, s[8:11], s20 offen lds
  s_waitcnt vmcnt(12)
  ds_read_b64_tr_b16 a[224:225], v85 offset:8192
  ds_read_b64_tr_b16 a[226:227], v85 offset:8448
  ds_read_b64_tr_b16 a[228:229], v85 offset:8224
  ds_read_b64_tr_b16 a[230:231], v85 offset:8480
  s_waitcnt lgkmcnt(0)
  s_add_u32 s20, s35, 1671168
  s_add_u32 s21, s34, 6144
  s_mov_b32 m0, s21
  s_nop 0
  buffer_load_dwordx4 v80, s[12:15], s20 offen lds
  s_add_u32 s21, s34, 7168
  s_mov_b32 m0, s21
  s_nop 0
  buffer_load_dwordx4 v81, s[12:15], s20 offen lds
  s_waitcnt vmcnt(12)
  ds_read_b64_tr_b16 a[232:233], v85 offset:10240
  ds_read_b64_tr_b16 a[234:235], v85 offset:10496
  ds_read_b64_tr_b16 a[236:237], v85 offset:10272
  ds_read_b64_tr_b16 a[238:239], v85 offset:10528
  s_waitcnt lgkmcnt(0)
  s_add_u32 s20, s35, 1769472
  s_add_u32 s21, s34, 8192
  s_mov_b32 m0, s21
  s_nop 0
  buffer_load_dwordx4 v80, s[8:11], s20 offen lds
  s_add_u32 s21, s34, 9216
  s_mov_b32 m0, s21
  s_nop 0
  buffer_load_dwordx4 v81, s[8:11], s20 offen lds
  s_waitcnt vmcnt(12)
  ds_read_b64_tr_b16 a[240:241], v85 offset:12288
  ds_read_b64_tr_b16 a[242:243], v85 offset:12544
  ds_read_b64_tr_b16 a[244:245], v85 offset:12320
  ds_read_b64_tr_b16 a[246:247], v85 offset:12576
  s_waitcnt lgkmcnt(0)
  s_add_u32 s20, s35, 1769472
  s_add_u32 s21, s34, 10240
  s_mov_b32 m0, s21
  s_nop 0
  buffer_load_dwordx4 v80, s[12:15], s20 offen lds
  s_add_u32 s21, s34, 11264
  s_mov_b32 m0, s21
  s_nop 0
  buffer_load_dwordx4 v81, s[12:15], s20 offen lds
  s_waitcnt vmcnt(12)
  ds_read_b64_tr_b16 a[248:249], v85 offset:14336
  ds_read_b64_tr_b16 a[250:251], v85 offset:14592
  ds_read_b64_tr_b16 a[252:253], v85 offset:14368
  ds_read_b64_tr_b16 a[254:255], v85 offset:14624
  s_waitcnt lgkmcnt(0)
  s_add_u32 s20, s35, 1867776
  s_add_u32 s21, s34, 12288
  s_mov_b32 m0, s21
  s_nop 0
  buffer_load_dwordx4 v80, s[8:11], s20 offen lds
  s_add_u32 s21, s34, 13312
  s_mov_b32 m0, s21
  s_nop 0
  buffer_load_dwordx4 v81, s[8:11], s20 offen lds
  s_waitcnt vmcnt(12)
  ds_read_b64_tr_b16 v[128:129], v85 offset:0
  ds_read_b64_tr_b16 v[130:131], v85 offset:256
  ds_read_b64_tr_b16 v[132:133], v85 offset:32
  ds_read_b64_tr_b16 v[134:135], v85 offset:288
  s_waitcnt lgkmcnt(0)
  s_add_u32 s20, s35, 1867776
  s_add_u32 s21, s34, 14336
  s_mov_b32 m0, s21
  s_nop 0
  buffer_load_dwordx4 v80, s[12:15], s20 offen lds
  s_add_u32 s21, s34, 15360
  s_mov_b32 m0, s21
  s_nop 0
  buffer_load_dwordx4 v81, s[12:15], s20 offen lds
  s_waitcnt vmcnt(12)
  ds_read_b64_tr_b16 v[136:137], v85 offset:2048
  ds_read_b64_tr_b16 v[138:139], v85 offset:2304
  ds_read_b64_tr_b16 v[140:141], v85 offset:2080
  ds_read_b64_tr_b16 v[142:143], v85 offset:2336
  s_waitcnt lgkmcnt(0)
  s_waitcnt vmcnt(10)
  ds_read_b64_tr_b16 v[144:145], v85 offset:4096
  ds_read_b64_tr_b16 v[146:147], v85 offset:4352
  ds_read_b64_tr_b16 v[148:149], v85 offset:4128
  ds_read_b64_tr_b16 v[150:151], v85 offset:4384
  s_waitcnt lgkmcnt(0)
  s_waitcnt vmcnt(8)
  ds_read_b64_tr_b16 v[152:153], v85 offset:6144
  ds_read_b64_tr_b16 v[154:155], v85 offset:6400
  ds_read_b64_tr_b16 v[156:157], v85 offset:6176
  ds_read_b64_tr_b16 v[158:159], v85 offset:6432
  s_waitcnt lgkmcnt(0)
  s_waitcnt vmcnt(6)
  ds_read_b64_tr_b16 v[160:161], v85 offset:8192
  ds_read_b64_tr_b16 v[162:163], v85 offset:8448
  ds_read_b64_tr_b16 v[164:165], v85 offset:8224
  ds_read_b64_tr_b16 v[166:167], v85 offset:8480
  s_waitcnt lgkmcnt(0)
  s_waitcnt vmcnt(4)
  ds_read_b64_tr_b16 v[168:169], v85 offset:10240
  ds_read_b64_tr_b16 v[170:171], v85 offset:10496
  ds_read_b64_tr_b16 v[172:173], v85 offset:10272
  ds_read_b64_tr_b16 v[174:175], v85 offset:10528
  s_waitcnt lgkmcnt(0)
  s_waitcnt vmcnt(2)
  ds_read_b64_tr_b16 v[176:177], v85 offset:12288
  ds_read_b64_tr_b16 v[178:179], v85 offset:12544
  ds_read_b64_tr_b16 v[180:181], v85 offset:12320
  ds_read_b64_tr_b16 v[182:183], v85 offset:12576
  s_waitcnt lgkmcnt(0)
  s_waitcnt vmcnt(0)
  ds_read_b64_tr_b16 v[184:185], v85 offset:14336
  ds_read_b64_tr_b16 v[186:187], v85 offset:14592
  ds_read_b64_tr_b16 v[188:189], v85 offset:14368
  ds_read_b64_tr_b16 v[190:191], v85 offset:14624
  s_waitcnt lgkmcnt(0)
  s_waitcnt lgkmcnt(0)
  s_barrier
  s_mul_i32 s36, s16, 10240
  s_and_b32 s20, s16, 1
  s_mul_i32 s20, s20, 20480
  v_add_u32 v10, s20, v2
  s_mov_b32 s18, s45
LF1_179:
  s_add_u32 s23, s18, 1
  s_cmp_lg_u32 s16, 0
  s_cbranch_scc1 Lw0_180
  s_mov_b32 s22, 21504
Lwf_181:
  buffer_load_dword v7, v0, s[4:7], s22 offen sc1
  s_waitcnt vmcnt(0)
  v_cmp_gt_u32 vcc, s23, v7
  s_cbranch_vccz Lwfd_182
  s_sleep 1
  s_cmp_eq_u32 s19, 0
  s_cbranch_scc1 Lwfd_182
  s_sub_u32 s19, s19, 1
  s_branch Lwf_181
Lwfd_182:
Lw0_180:
  s_barrier
  s_mul_i32 s26, s18, 40960
  s_add_u32 s26, s26, s36
  s_add_u32 s26, s26, 157286400
  s_add_u32 s20, s36, 0
  s_mov_b32 m0, s20
  s_add_u32 s21, s26, 0
  buffer_load_dwordx4 v2, s[4:7], s21 offen sc1 lds
  s_add_u32 s20, s36, 1024
  s_mov_b32 m0, s20
  s_add_u32 s21, s26, 1024
  buffer_load_dwordx4 v2, s[4:7], s21 offen sc1 lds
  s_add_u32 s20, s36, 2048
  s_mov_b32 m0, s20
  s_add_u32 s21, s26, 2048
  buffer_load_dwordx4 v2, s[4:7], s21 offen sc1 lds
  s_add_u32 s20, s36, 3072
  s_mov_b32 m0, s20
  s_add_u32 s21, s26, 3072
  buffer_load_dwordx4 v2, s[4:7], s21 offen sc1 lds
  s_add_u32 s20, s36, 4096
  s_mov_b32 m0, s20
  s_add_u32 s21, s26, 4096
  buffer_load_dwordx4 v2, s[4:7], s21 offen sc1 lds
  s_add_u32 s20, s36, 5120
  s_mov_b32 m0, s20
  s_add_u32 s21, s26, 5120
  buffer_load_dwordx4 v2, s[4:7], s21 offen sc1 lds
  s_add_u32 s20, s36, 6144
  s_mov_b32 m0, s20
  s_add_u32 s21, s26, 6144
  buffer_load_dwordx4 v2, s[4:7], s21 offen sc1 lds
  s_add_u32 s20, s36, 7168
  s_mov_b32 m0, s20
  s_add_u32 s21, s26, 7168
  buffer_load_dwordx4 v2, s[4:7], s21 offen sc1 lds
  s_add_u32 s20, s36, 8192
  s_mov_b32 m0, s20
  s_add_u32 s21, s26, 8192
  buffer_load_dwordx4 v2, s[4:7], s21 offen sc1 lds
  s_add_u32 s20, s36, 9216
  s_mov_b32 m0, s20
  s_add_u32 s21, s26, 9216
  buffer_load_dwordx4 v2, s[4:7], s21 offen sc1 lds
  s_waitcnt vmcnt(0)
  s_barrier
  ds_read_b128 v[32:35], v10 offset:0
  ds_read_b128 v[36:39], v10 offset:1024
  ds_read_b128 v[40:43], v10 offset:2048
  ds_read_b128 v[44:47], v10 offset:3072
  s_waitcnt lgkmcnt(3)
  v_mfma_f32_16x16x32_bf16 v[16:19], a[0:3], v[32:35], 0
  v_mfma_f32_16x16x32_bf16 v[20:23], a[4:7], v[32:35], 0
  v_mfma_f32_16x16x32_bf16 v[24:27], a[8:11], v[32:35], 0
  v_mfma_f32_16x16x32_bf16 v[28:31], a[12:15], v[32:35], 0
  ds_read_b128 v[32:35], v10 offset:4096
  s_waitcnt lgkmcnt(3)
  v_mfma_f32_16x16x32_bf16 v[16:19], a[16:19], v[36:39], v[16:19]
  v_mfma_f32_16x16x32_bf16 v[20:23], a[20:23], v[36:39], v[20:23]
  v_mfma_f32_16x16x32_bf16 v[24:27], a[24:27], v[36:39], v[24:27]
  v_mfma_f32_16x16x32_bf16 v[28:31], a[28:31], v[36:39], v[28:31]
  ds_read_b128 v[36:39], v10 offset:5120
  s_waitcnt lgkmcnt(3)
  v_mfma_f32_16x16x32_bf16 v[16:19], a[32:35], v[40:43], v[16:19]
  v_mfma_f32_16x16x32_bf16 v[20:23], a[36:39], v[40:43], v[20:23]
  v_mfma_f32_16x16x32_bf16 v[24:27], a[40:43], v[40:43], v[24:27]
  v_mfma_f32_16x16x32_bf16 v[28:31], a[44:47], v[40:43], v[28:31]
  ds_read_b128 v[40:43], v10 offset:6144
  s_waitcnt lgkmcnt(3)
  v_mfma_f32_16x16x32_bf16 v[16:19], a[48:51], v[44:47], v[16:19]
  v_mfma_f32_16x16x32_bf16 v[20:23], a[52:55], v[44:47], v[20:23]
  v_mfma_f32_16x16x32_bf16 v[24:27], a[56:59], v[44:47], v[24:27]
  v_mfma_f32_16x16x32_bf16 v[28:31], a[60:63], v[44:47], v[28:31]
  ds_read_b128 v[44:47], v10 offset:7168
  s_waitcnt lgkmcnt(3)
  v_mfma_f32_16x16x32_bf16 v[16:19], a[64:67], v[32:35], v[16:19]
  v_mfma_f32_16x16x32_bf16 v[20:23], a[68:71], v[32:35], v[20:23]
  v_mfma_f32_16x16x32_bf16 v[24:27], a[72:75], v[32:35], v[24:27]
  v_mfma_f32_16x16x32_bf16 v[28:31], a[76:79], v[32:35], v[28:31]
  ds_read_b128 v[32:35], v10 offset:8192
  s_waitcnt lgkmcnt(3)
  v_mfma_f32_16x16x32_bf16 v[16:19], a[80:83], v[36:39], v[16:19]
  v_mfma_f32_16x16x32_bf16 v[20:23], a[84:87], v[36:39], v[20:23]
  v_mfma_f32_16x16x32_bf16 v[24:27], a[88:91], v[36:39], v[24:27]
  v_mfma_f32_16x16x32_bf16 v[28:31], a[92:95], v[36:39], v[28:31]
  ds_read_b128 v[36:39], v10 offset:9216
  s_waitcnt lgkmcnt(3)
  v_mfma_f32_16x16x32_bf16 v[16:19], a[96:99], v[40:43], v[16:19]
  v_mfma_f32_16x16x32_bf16 v[20:23], a[100:103], v[40:43], v[20:23]
  v_mfma_f32_16x16x32_bf16 v[24:27], a[104:107], v[40:43], v[24:27]
  v_mfma_f32_16x16x32_bf16 v[28:31], a[108:111], v[40:43], v[28:31]
  ds_read_b128 v[40:43], v10 offset:10240
  s_waitcnt lgkmcnt(3)
  v_mfma_f32_16x16x32_bf16 v[16:19], a[112:115], v[44:47], v[16:19]
  v_mfma_f32_16x16x32_bf16 v[20:23], a[116:119], v[44:47], v[20:23]
  v_mfma_f32_16x16x32_bf16 v[24:27], a[120:123], v[44:47], v[24:27]
  v_mfma_f32_16x16x32_bf16 v[28:31], a[124:127], v[44:47], v[28:31]
  ds_read_b128 v[44:47], v10 offset:11264
  s_waitcnt lgkmcnt(3)
  v_mfma_f32_16x16x32_bf16 v[16:19], a[128:131], v[32:35], v[16:19]
  v_mfma_f32_16x16x32_bf16 v[20:23], a[132:135], v[32:35], v[20:23]
  v_mfma_f32_16x16x32_bf16 v[24:27], a[136:139], v[32:35], v[24:27]
  v_mfma_f32_16x16x32_bf16 v[28:31], a[140:143], v[32:35], v[28:31]
  ds_read_b128 v[32:35], v10 offset:12288
  s_waitcnt lgkmcnt(3)
  v_mfma_f32_16x16x32_bf16 v[16:19], a[144:147], v[36:39], v[16:19]
  v_mfma_f32_16x16x32_bf16 v[20:23], a[148:151], v[36:39], v[20:23]
  v_mfma_f32_16x16x32_bf16 v[24:27], a[152:155], v[36:39], v[24:27]
  v_mfma_f32_16x16x32_bf16 v[28:31], a[156:159], v[36:39], v[28:31]
  ds_read_b128 v[36:39], v10 offset:13312
  s_waitcnt lgkmcnt(3)
  v_mfma_f32_16x16x32_bf16 v[16:19], a[160:163], v[40:43], v[16:19]
  v_mfma_f32_16x16x32_bf16 v[20:23], a[164:167], v[40:43], v[20:23]
  v_mfma_f32_16x16x32_bf16 v[24:27], a[168:171], v[40:43], v[24:27]
  v_mfma_f32_16x16x32_bf16 v[28:31], a[172:175], v[40:43], v[28:31]
  ds_read_b128 v[40:43], v10 offset:14336
  s_waitcnt lgkmcnt(3)
  v_mfma_f32_16x16x32_bf16 v[16:19], a[176:179], v[44:47], v[16:19]
  v_mfma_f32_16x16x32_bf16 v[20:23], a[180:183], v[44:47], v[20:23]
  v_mfma_f32_16x16x32_bf16 v[24:27], a[184:187], v[44:47], v[24:27]
  v_mfma_f32_16x16x32_bf16 v[28:31], a[188:191], v[44:47], v[28:31]
  ds_read_b128 v[44:47], v10 offset:15360
  s_waitcnt lgkmcnt(3)
  v_mfma_f32_16x16x32_bf16 v[16:19], a[192:195], v[32:35], v[16:19]
  v_mfma_f32_16x16x32_bf16 v[20:23], a[196:199], v[32:35], v[20:23]
  v_mfma_f32_16x16x32_bf16 v[24:27], a[200:203], v[32:35], v[24:27]
  v_mfma_f32_16x16x32_bf16 v[28:31], a[204:207], v[32:35], v[28:31]
  ds_read_b128 v[32:35], v10 offset:16384
  s_waitcnt lgkmcnt(3)
  v_mfma_f32_16x16x32_bf16 v[16:19], a[208:211], v[36:39], v[16:19]
  v_mfma_f32_16x16x32_bf16 v[20:23], a[212:215], v[36:39], v[20:23]
  v_mfma_f32_16x16x32_bf16 v[24:27], a[216:219], v[36:39], v[24:27]
  v_mfma_f32_16x16x32_bf16 v[28:31], a[220:223], v[36:39], v[28:31]
  ds_read_b128 v[36:39], v10 offset:17408
  s_waitcnt lgkmcnt(3)
  v_mfma_f32_16x16x32_bf16 v[16:19], a[224:227], v[40:43], v[16:19]
  v_mfma_f32_16x16x32_bf16 v[20:23], a[228:231], v[40:43], v[20:23]
  v_mfma_f32_16x16x32_bf16 v[24:27], a[232:235], v[40:43], v[24:27]
  v_mfma_f32_16x16x32_bf16 v[28:31], a[236:239], v[40:43], v[28:31]
  ds_read_b128 v[40:43], v10 offset:18432
  s_waitcnt lgkmcnt(3)
  v_mfma_f32_16x16x32_bf16 v[16:19], a[240:243], v[44:47], v[16:19]
  v_mfma_f32_16x16x32_bf16 v[20:23], a[244:247], v[44:47], v[20:23]
  v_mfma_f32_16x16x32_bf16 v[24:27], a[248:251], v[44:47], v[24:27]
  v_mfma_f32_16x16x32_bf16 v[28:31], a[252:255], v[44:47], v[28:31]
  ds_read_b128 v[44:47], v10 offset:19456
  s_waitcnt lgkmcnt(3)
  v_mfma_f32_16x16x32_bf16 v[16:19], v[128:131], v[32:35], v[16:19]
  v_mfma_f32_16x16x32_bf16 v[20:23], v[132:135], v[32:35], v[20:23]
  v_mfma_f32_16x16x32_bf16 v[24:27], v[136:139], v[32:35], v[24:27]
  v_mfma_f32_16x16x32_bf16 v[28:31], v[140:143], v[32:35], v[28:31]
  s_waitcnt lgkmcnt(2)
  v_mfma_f32_16x16x32_bf16 v[16:19], v[144:147], v[36:39], v[16:19]
  v_mfma_f32_16x16x32_bf16 v[20:23], v[148:151], v[36:39], v[20:23]
  v_mfma_f32_16x16x32_bf16 v[24:27], v[152:155], v[36:39], v[24:27]
  v_mfma_f32_16x16x32_bf16 v[28:31], v[156:159], v[36:39], v[28:31]
  s_waitcnt lgkmcnt(1)
  v_mfma_f32_16x16x32_bf16 v[16:19], v[160:163], v[40:43], v[16:19]
  v_mfma_f32_16x16x32_bf16 v[20:23], v[164:167], v[40:43], v[20:23]
  v_mfma_f32_16x16x32_bf16 v[24:27], v[168:171], v[40:43], v[24:27]
  v_mfma_f32_16x16x32_bf16 v[28:31], v[172:175], v[40:43], v[28:31]
  s_waitcnt lgkmcnt(0)
  v_mfma_f32_16x16x32_bf16 v[16:19], v[176:179], v[44:47], v[16:19]
  v_mfma_f32_16x16x32_bf16 v[20:23], v[180:183], v[44:47], v[20:23]
  v_mfma_f32_16x16x32_bf16 v[24:27], v[184:187], v[44:47], v[24:27]
  v_mfma_f32_16x16x32_bf16 v[28:31], v[188:191], v[44:47], v[28:31]
  s_nop 4
  v_mul_f32 v16, v16, v24
  v_mul_f32 v17, v17, v25
  v_mul_f32 v18, v18, v26
  v_mul_f32 v19, v19, v27
  v_mul_f32 v20, v20, v28
  v_mul_f32 v21, v21, v29
  v_mul_f32 v22, v22, v30
  v_mul_f32 v23, v23, v31
  v_cvt_pk_bf16_f32 v48, v16, v17
  v_cvt_pk_bf16_f32 v49, v18, v19
  v_cvt_pk_bf16_f32 v50, v20, v21
  v_cvt_pk_bf16_f32 v51, v22, v23
  s_mul_i32 s30, s18, 98304
  s_and_b32 s20, s16, 1
  s_mul_i32 s20, s20, 49152
  s_add_u32 s30, s30, s20
  s_lshl_b32 s20, s27, 1
  s_lshr_b32 s21, s16, 1
  s_add_u32 s20, s20, s21
  s_lshl_b32 s20, s20, 10
  s_add_u32 s30, s30, s20
  s_add_u32 s30, s30, 150994944
  buffer_store_dwordx4 v[48:51], v2, s[4:7], s30 offen sc1
  s_waitcnt vmcnt(0)
  s_barrier
  s_add_u32 s23, s18, 1
  v_mov_b32 v9, s23
  buffer_store_dword v9, v8, s[4:7], s44 offen sc1
  s_add_u32 s18, s18, 2
  s_cmp_lt_u32 s18, s31
  s_cbranch_scc1 LF1_179
  s_branch L_end
L_end:
  s_cmp_lg_u32 s19, 0
  s_cbranch_scc1 Lok_183
  v_mov_b32 v4, 4
  v_mov_b32 v5, s2
  v_add_u32 v5, 1, v5
  global_store_dword v4, v5, s[32:33]
Lok_183:
  s_waitcnt vmcnt(0)
  s_endpgm
.section .rodata,"a"
.p2align 6
.amdhsa_kernel adaLN_cond__memory_aug_recurrent_mem_tr__glu_gated_bilinear__prompt_kernel
  .amdhsa_next_free_vgpr 512
  .amdhsa_next_free_sgpr 96
  .amdhsa_accum_offset 256
  .amdhsa_group_segment_fixed_size 0
  .amdhsa_kernarg_size 128
  .amdhsa_user_sgpr_count 2
  .amdhsa_user_sgpr_kernarg_segment_ptr 1
  .amdhsa_system_sgpr_workgroup_id_x 1
.end_amdhsa_kernel
```
